```python
import torch

def _softmax(x, axis=-1):
    return torch.softmax(x, dim=axis)
def _gelu(x):
    return torch.nn.functional.gelu(x, approximate="tanh")
def _silu(x):
    return torch.nn.functional.silu(x)
def _sigmoid(x):
    return torch.sigmoid(x)
def _layernorm(x, axis=-1, eps=1e-5):
    m = x.mean(dim=axis, keepdim=True)
    v = x.var(dim=axis, keepdim=True, unbiased=False)
    return (x - m) / torch.sqrt(v + eps)
def _scatter_add(tgt, idx, src, axis=0):
    return tgt.clone().index_add_(axis, idx, src)
def _segment_sum(src, seg, n):
    out = torch.zeros((n,) + src.shape[1:], dtype=src.dtype)
    return out.index_add_(0, seg, src)
def _pad(x, pw):
    flat = tuple(v for pair in reversed(pw) for v in pair)
    return torch.nn.functional.pad(x, flat)

kernel_name = 'recurrent_scan__sliding_local_dilated__glu_gated_bilinear__prompt'

def setup_inputs():

    _w = (lambda a: (lambda t: t.to(torch.bfloat16) if t.is_floating_point() else t)(torch.as_tensor(a)))
    def _A_setup():
        B, S, D = 1, 2048, 512
        return {
            "x": _w((lambda *s: torch.randn(*s, dtype=torch.bfloat16) * 0.05)(B, S, D)),
            "wqkv": _w((lambda *s: torch.randn(*s, dtype=torch.bfloat16) * 0.2)(D, 3 * D)),
            "wo": _w((lambda *s: torch.randn(*s, dtype=torch.bfloat16) * 0.2)(D, D)),
        }
    _A_in = _A_setup()

    def _B_setup():
        B, S, D, F = 1, 2048, 512, 1792
        return {
            "x": _w((lambda *s: torch.randn(*s, dtype=torch.bfloat16) * 0.05)(B, S, D)),
            "w_gate": _w((lambda *s: torch.randn(*s, dtype=torch.bfloat16) * 0.1)(D, F) * (D ** -0.5)),
            "w_up": _w((lambda *s: torch.randn(*s, dtype=torch.bfloat16) * 0.1)(D, F) * (D ** -0.5)),
            "w_down": _w((lambda *s: torch.randn(*s, dtype=torch.bfloat16) * 0.1)(F, D) * (F ** -0.5)),
        }
    _B_in = _B_setup()

    return {
        "A_x": _A_in["x"],
        "A_wqkv": _A_in["wqkv"],
        "A_wo": _A_in["wo"],
        "B_x": _B_in["x"],
        "B_w_gate": _B_in["w_gate"],
        "B_w_up": _B_in["w_up"],
        "B_w_down": _B_in["w_down"],
    }

def reference(A_x, A_wqkv, A_wo, B_x, B_w_gate, B_w_up, B_w_down):
    def _A_ref(x, wqkv, wo):
        B, S, D = x.shape
        H = 32; Dh = D // H
        W, dil = 8, 2
        qkv = (lambda x, *d: x.permute(*d))((x @ wqkv).reshape(B, S, 3, H, Dh), 2, 0, 3, 1, 4)
        q, k, v = qkv[0], qkv[1], qkv[2]
        scale = Dh ** -0.5
        pos = torch.arange(S)
        off = torch.arange(W) * dil
        idx = pos[:, None] - off[None, :]
        mask = idx >= 0
        idx_c = torch.where(mask, idx, 0).reshape(-1)
        kg = k[:, :, idx_c, :].reshape(B, H, S, W, Dh)
        vg = v[:, :, idx_c, :].reshape(B, H, S, W, Dh)
        logits = torch.einsum("bhsd,bhswd->bhsw", q, kg) * scale
        logits = torch.where(mask[None, None, :, :], logits, -1e9)
        attn = _softmax(logits, axis=-1)
        o = torch.einsum("bhsw,bhswd->bhsd", attn, vg)
        return (lambda x, *d: x.permute(*d))(o, 0, 2, 1, 3).reshape(B, S, D) @ wo

    def _B_ref(x, w_gate, w_up, w_down):
        g = torch.einsum("bsd,df->bsf", x, w_gate)
        u = torch.einsum("bsd,df->bsf", x, w_up)
        h = g * u
        return torch.einsum("bsf,fd->bsd", h, w_down)

    x = A_x
    xn = _layernorm(x, axis=-1)
    s = _A_ref(xn, A_wqkv, A_wo)
    g = _silu(_B_ref(xn, B_w_gate, B_w_up, B_w_down))
    return x + s * g
```

```asm
; @launch grid=(256,1,1) block=(256,1,1) lds=163840
.amdgcn_target "amdgcn-amd-amdhsa--gfx950"
.text
.globl recurrent_scan__sliding_local_dilated__glu_gated_bilinear__prompt_kernel
.p2align 8
.type recurrent_scan__sliding_local_dilated__glu_gated_bilinear__prompt_kernel,@function
recurrent_scan__sliding_local_dilated__glu_gated_bilinear__prompt_kernel:
  s_load_dwordx2 s[4:5], s[0:1], 0
  s_load_dwordx16 s[48:63], s[0:1], 0
  s_load_dwordx4 s[64:67], s[0:1], 64
  s_cmp_ge_u32 s2, 256
  s_cbranch_scc1 L_end
  s_getpc_b64 s[88:89]
L_pc:
  v_lshrrev_b32 v2, 6, v0
  v_and_b32 v1, 63, v0
  s_lshr_b32 s83, s2, 3
  s_lshl_b32 s82, s83, 2
  v_add_u32 v3, s82, v2
  v_lshl_add_u32 v3, v1, 7, v3
  v_min_u32 v3, 338, v3
  v_lshlrev_b32 v3, 7, v3
  s_mov_b64 exec, 7
  global_load_dword a112, v3, s[88:89]
  s_mov_b64 exec, -1
  s_and_b32 s82, s2, 7
  v_readfirstlane_b32 s68, v2
  s_lshr_b32 s69, s82, 2
  s_lshl_b32 s69, s69, 3
  s_lshr_b32 s84, s83, 2
  s_add_u32 s69, s69, s84
  v_lshrrev_b32 v5, 3, v1
  v_lshrrev_b32 v3, 4, v1
  v_xor_b32 v4, v3, v1
  v_and_b32 v4, 7, v4
  v_lshlrev_b32 v4, 4, v4
  s_lshl_b32 s85, s69, 7
  s_lshl_b32 s84, s68, 5
  s_add_u32 s84, s84, s85
  v_add_u32 v6, s84, v5
  v_lshl_add_u32 v8, v6, 10, v4
  v_xor_b32 v9, 64, v8
  v_add_u32 v9, 0x2000, v9
  s_lshl_b32 s77, s68, 12
  s_add_u32 s77, s77, 2048
  s_lshl_b32 s93, s2, 1
  s_and_b32 s92, s2, 4
  s_add_u32 s93, s93, s92
  s_and_b32 s93, s93, 6
  s_lshl_b32 s81, s93, 1
  s_lshl_b32 s93, s93, 7
  s_mov_b32 s6, 2097152
  s_mov_b32 s7, 0x20000
  s_add_u32 s92, s93, 16384
  s_add_u32 m0, s77, 102400
  s_waitcnt lgkmcnt(0)
  buffer_load_dwordx4 v8, s[4:7], s93 offen lds
  s_add_u32 m0, m0, 1024
  s_lshl_b32 s76, s68, 10
  buffer_load_dwordx4 v9, s[4:7], s93 offen lds
  s_add_u32 m0, m0, 1024
  s_and_b32 s70, s82, 3
  buffer_load_dwordx4 v8, s[4:7], s92 offen lds
  s_add_u32 m0, m0, 1024
  s_lshl_b32 s79, s70, 1
  buffer_load_dwordx4 v9, s[4:7], s92 offen lds
  s_lshl_b32 s70, s70, 2
  s_and_b32 s84, s83, 3
  s_add_u32 s70, s70, s84
  s_lshr_b32 s80, s84, 1
  s_and_b32 s84, s84, 1
  s_add_u32 s79, s79, s84
  s_and_b32 s84, s68, 1
  s_lshl_b32 s85, s84, 2
  v_and_or_b32 v4, v5, 2, s85
  v_xor_b32 v4, v4, v1
  v_and_b32 v4, 7, v4
  v_lshlrev_b32 v4, 4, v4
  v_lshl_add_u32 v6, s68, 3, v5
  s_movk_i32 s87, 3584
  s_movk_i32 s86, 3072
  s_lshl_b32 s95, s79, 7
  s_lshl_b32 s85, s79, 8
  s_addk_i32 s85, 1024
  s_add_u32 s49, s95, 1024
  s_add_u32 s94, s95, 2048
  s_add_u32 s54, s85, 128
  s_lshl_b32 s55, s79, 6
  s_addk_i32 s55, 3072
  s_cmp_eq_u32 s80, 1
  s_cselect_b32 s86, s87, s86
  s_cselect_b32 s48, s85, s95
  s_cselect_b32 s49, s85, s49
  s_cselect_b32 s94, s54, s94
  s_cselect_b32 s55, s55, s95
  s_cselect_b32 s95, s54, s95
  s_cselect_b64 vcc, -1, 0
  s_cselect_b64 s[28:29], s[56:57], s[50:51]
  s_cselect_b64 s[32:33], s[58:59], s[50:51]
  s_cselect_b64 s[40:41], s[58:59], s[56:57]
  v_mad_u32_u24 v2, v6, s86, v4
  s_lshl_b32 s30, s86, 9
  s_lshl_b32 s75, s86, 5
  s_mov_b32 s31, s7
  v_add_u32 v12, s48, v2
  s_mul_i32 s73, s81, s75
  s_mov_b32 m0, s76
  v_add_u32 v13, s49, v2
  buffer_load_dwordx4 v12, s[28:31], s73 offen lds
  s_mov_b32 s34, s30
  s_mov_b32 s35, s7
  s_add_u32 m0, m0, 4096
  v_add_u32 v14, s94, v2
  buffer_load_dwordx4 v13, s[32:35], s73 offen lds
  s_mov_b64 s[36:37], s[28:29]
  s_mov_b32 s38, s30
  s_mov_b32 s39, s7
  s_add_u32 m0, m0, 4096
  v_mad_u32_u24 v3, v6, s87, v4
  buffer_load_dwordx4 v14, s[36:39], s73 offen lds
  s_mov_b32 s42, 1835008
  s_mov_b32 s43, s7
  s_mul_i32 s74, s81, 114688
  s_add_u32 m0, m0, 4096
  v_add_u32 v15, s95, v3
  buffer_load_dwordx4 v15, s[40:43], s74 offen lds
  v_lshrrev_b32 v4, 4, v1
  v_and_b32 v4, 2, v4
  v_xor_b32 v4, v4, v1
  v_and_b32 v4, 3, v4
  v_lshlrev_b32 v4, 4, v4
  v_lshrrev_b32 v6, 2, v1
  v_lshl_add_u32 v6, s84, 4, v6
  v_mad_u32_u24 v4, v6, s87, v4
  s_lshl_b32 s84, s80, 1
  s_cmp_lt_u32 s68, s84
  s_cselect_b64 s[44:45], s[56:57], s[58:59]
  s_mov_b32 s46, s42
  s_mov_b32 s47, s7
  v_cndmask_b32 v4, v3, v4, vcc
  s_add_u32 m0, m0, 4096
  v_add_u32 v16, s55, v4
  buffer_load_dwordx4 v16, s[44:47], s74 offen lds
  s_add_u32 s73, s73, s75
  s_add_u32 s74, s74, 114688
  s_lshl_b32 s84, s68, 2
  s_lshl_b32 s85, s69, 7
  s_add_u32 s84, s84, s85
  s_sub_u32 s84, s84, 16
  v_lshrrev_b32 v6, 5, v1
  v_add_u32 v6, s84, v6
  s_lshl_b32 s83, s68, 5
  v_lshlrev_b32 v4, 2, v1
  v_and_b32 v4, 0x7f, v4
  v_xor_b32 v4, s83, v4
  v_max_i32 v2, 0, v6
  v_lshl_add_u32 v10, v2, 10, v4
  v_add_u32 v6, 2, v6
  v_max_i32 v2, 0, v6
  v_xor_b32 v4, 16, v4
  v_lshl_add_u32 v11, v2, 10, v4
  s_lshl_b32 s78, s68, 9
  s_cmp_eq_u32 s68, 0
  s_cselect_b32 s3, 0x10000, s78
  s_cselect_b32 s84, 2147483648, 0
  v_or_b32 v10, s84, v10
  s_add_u32 m0, s3, 102400
  s_nop 0
  buffer_load_dword v10, s[4:7], s93 offen lds
  s_add_u32 m0, s78, 102656
  s_nop 0
  buffer_load_dword v11, s[4:7], s93 offen lds
  s_add_u32 s93, s93, 128
  s_and_b32 s93, s93, 1023
  v_lshrrev_b32 v2, 4, v1
  v_bfe_u32 v3, v1, 2, 2
  v_and_b32 v4, 3, v1
  v_and_b32 v6, 15, v1
  v_lshrrev_b32 v5, 1, v6
  v_xor_b32 v5, v5, v2
  v_lshlrev_b32 v5, 4, v5
  v_lshl_add_u32 v5, v6, 7, v5
  v_add_u32 v5, 102400, v5
  s_lshr_b32 s84, s68, 1
  s_and_b32 s84, s84, s80
  s_lshl_b32 s84, s84, 13
  v_add_u32 v18, s84, v5
  v_xor_b32 v19, 64, v18
  v_subrev_u32 v20, s84, v5
  v_xor_b32 v21, 64, v20
  v_and_b32 v6, 1, v2
  v_lshrrev_b32 v5, 1, v3
  v_lshl_or_b32 v5, v6, 1, v5
  v_xor_b32 v5, s68, v5
  v_lshlrev_b32 v5, 5, v5
  v_lshl_add_u32 v5, v2, 10, v5
  v_lshl_add_u32 v5, v3, 7, v5
  v_lshl_add_u32 v22, v4, 3, v5
  v_add_u32 v23, 61440, v22
  v_lshrrev_b32 v5, 1, v2
  v_lshlrev_b32 v5, 10, v5
  v_lshl_add_u32 v5, v6, 9, v5
  v_lshl_add_u32 v5, v3, 6, v5
  v_lshl_add_u32 v5, v4, 3, v5
  v_xor_b32 v6, s68, v6
  v_and_b32 v6, 1, v6
  v_lshl_add_u32 v24, v6, 5, v5
  v_add_u32 v25, 61440, v24
  v_mov_b32 v5, 0x3f803f80
  v_lshlrev_b32 v6, 2, v1
  v_add_u32 v6, 102400, v6
  ds_write_b32 v6, v5
  ds_write_b32 v6, v5 offset:18432
  ds_write_b32 v6, v5 offset:36864
  v_accvgpr_write_b32 a252, v5
  v_accvgpr_write_b32 a253, v5
  v_accvgpr_write_b32 a254, v5
  v_accvgpr_write_b32 a255, v5
  s_cmp_eq_u32 s68, 1
  s_cselect_b32 s54, s49, s48
  s_cselect_b32 s88, s32, s28
  s_cselect_b32 s89, s33, s29
  s_cmp_eq_u32 s68, 2
  s_cselect_b32 s54, s94, s54
  s_cmp_eq_u32 s68, 3
  s_cselect_b32 s54, s95, s54
  s_cselect_b32 s88, s40, s88
  s_cselect_b32 s89, s41, s89
  s_cselect_b32 s90, s42, s30
  s_cselect_b32 s86, s87, s86
  s_mov_b32 s91, 0x20000
  s_add_u32 s81, s81, -1
  v_lshrrev_b32 v5, 2, v1
  v_add_u32 v44, s81, v5
  s_and_b32 s84, s69, 7
  s_lshl_b32 s84, s84, 2
  v_and_b32 v45, 3, v1
  v_add_u32 v45, s84, v45
  v_lshrrev_b32 v46, 3, v1
  v_lshlrev_b32 v46, 28, v46
  s_lshl_b32 s84, s80, 1
  s_sub_u32 s84, 3, s84
  v_xor_b32 v5, s68, v1
  v_and_b32 v5, s84, v5
  v_lshl_or_b32 v47, v5, 26, v46
  s_mov_b32 s24, s64
  s_mov_b32 s25, s65
  s_mov_b32 s26, 256
  s_mov_b32 s27, 0x20000
  s_or_b32 s84, s2, s68
  s_cmp_lg_u32 s84, 0
  s_cbranch_scc1 L_nononce
  s_memrealtime s[94:95]
  s_waitcnt lgkmcnt(0)
  s_or_b32 s94, s94, 1
  v_mov_b32 v2, s94
  v_mov_b32 v3, s95
  v_mov_b32 v4, 0
  s_mov_b64 exec, 1
  buffer_store_dwordx2 v[2:3], v4, s[24:27], 0 offen sc1
  s_mov_b64 exec, -1
L_nononce:
  v_add_u32 v44, 2, v44
  v_and_b32 v44, 15, v44
  v_lshl_add_u32 v48, v44, 5, v45
  v_mad_u32_u24 v49, v48, s86, v46
  v_mad_u32_u24 v48, v48, s87, v47
  buffer_load_dword a222, v49, s[88:91], s54 offen
  buffer_load_dword a223, v48, s[44:47], s55 offen
  s_add_u32 m0, s76, 20480
  s_nop 0
  buffer_load_dwordx4 v12, s[28:31], s73 offen lds
  s_add_u32 m0, s76, 24576
  s_nop 0
  buffer_load_dwordx4 v13, s[32:35], s73 offen lds
  s_add_u32 m0, s76, 28672
  s_nop 0
  buffer_load_dwordx4 v14, s[36:39], s73 offen lds
  s_add_u32 m0, s76, 32768
  s_nop 0
  buffer_load_dwordx4 v15, s[40:43], s74 offen lds
  s_add_u32 m0, s76, 36864
  s_nop 0
  buffer_load_dwordx4 v16, s[44:47], s74 offen lds
  s_add_u32 s73, s73, s75
  s_add_u32 s74, s74, 114688
  s_add_u32 s92, s93, 0
  s_add_u32 m0, s77, 120832
  s_nop 0
  buffer_load_dwordx4 v8, s[4:7], s92 offen lds
  s_add_u32 m0, s77, 121856
  s_nop 0
  buffer_load_dwordx4 v9, s[4:7], s92 offen lds
  s_add_u32 m0, s3, 120832
  s_nop 0
  buffer_load_dword v10, s[4:7], s93 offen lds
  s_add_u32 s92, s93, 16384
  s_add_u32 m0, s77, 122880
  s_nop 0
  buffer_load_dwordx4 v8, s[4:7], s92 offen lds
  s_add_u32 m0, s77, 123904
  s_nop 0
  buffer_load_dwordx4 v9, s[4:7], s92 offen lds
  s_add_u32 m0, s78, 121088
  s_nop 0
  buffer_load_dword v11, s[4:7], s93 offen lds
  s_add_u32 s93, s93, 128
  s_and_b32 s93, s93, 1023
  v_add_u32 v44, 2, v44
  v_and_b32 v44, 15, v44
  v_lshl_add_u32 v48, v44, 5, v45
  v_mad_u32_u24 v49, v48, s86, v46
  v_mad_u32_u24 v48, v48, s87, v47
  buffer_load_dword a224, v49, s[88:91], s54 offen
  buffer_load_dword a225, v48, s[44:47], s55 offen
  s_add_u32 s81, s93, 0
  s_cmp_eq_u32 s80, 1
  s_cbranch_scc1 L_t10
L_t00:
  s_waitcnt vmcnt(15) lgkmcnt(0)
  s_barrier
  ds_read_b128 a[0:3], v18 offset:0
  ds_read_b128 a[4:7], v18 offset:2048
  ds_read_b128 a[8:11], v18 offset:4096
  ds_read_b128 a[12:15], v18 offset:6144
  ds_read_b128 a[16:19], v18 offset:8192
  ds_read_b128 a[20:23], v18 offset:10240
  ds_read_b128 a[24:27], v18 offset:12288
  ds_read_b128 a[28:31], v18 offset:14336
  ds_read_b128 a[32:35], v18 offset:16384
  ds_read_b64_tr_b16 a[36:37], v22 offset:0
  ds_read_b64_tr_b16 a[38:39], v22 offset:512
  ds_read_b64_tr_b16 a[40:41], v22 offset:4096
  ds_read_b64_tr_b16 a[42:43], v22 offset:4608
  ds_read_b64_tr_b16 a[44:45], v22 offset:8192
  ds_read_b64_tr_b16 a[46:47], v22 offset:8704
  ds_read_b64_tr_b16 a[48:49], v22 offset:12288
  ds_read_b64_tr_b16 a[50:51], v22 offset:12800
  ds_read_b64_tr_b16 a[52:53], v22 offset:16384
  ds_read_b64_tr_b16 a[54:55], v22 offset:16896
  s_waitcnt vmcnt(8) lgkmcnt(0)
  s_barrier
  v_mfma_f32_16x16x32_bf16 v[88:91], a[36:39], a[4:7], 0
  ds_read_b128 a[56:59], v19 offset:0
  s_add_u32 m0, s76, 40960
  v_mfma_f32_16x16x32_bf16 v[92:95], a[36:39], a[8:11], 0
  ds_read_b128 a[60:63], v19 offset:2048
  buffer_load_dwordx4 v12, s[28:31], s73 offen lds
  v_mfma_f32_16x16x32_bf16 v[96:99], a[36:39], a[12:15], 0
  ds_read_b128 a[64:67], v19 offset:4096
  s_add_u32 m0, s76, 45056
  v_mfma_f32_16x16x32_bf16 v[100:103], a[36:39], a[16:19], 0
  ds_read_b128 a[68:71], v19 offset:6144
  buffer_load_dwordx4 v13, s[32:35], s73 offen lds
  v_mfma_f32_16x16x32_bf16 v[104:107], a[36:39], a[20:23], 0
  ds_read_b128 a[72:75], v19 offset:8192
  s_add_u32 m0, s76, 49152
  v_mfma_f32_16x16x32_bf16 v[108:111], a[36:39], a[24:27], 0
  ds_read_b128 a[76:79], v19 offset:10240
  buffer_load_dwordx4 v14, s[36:39], s73 offen lds
  v_mfma_f32_16x16x32_bf16 v[112:115], a[36:39], a[28:31], 0
  ds_read_b128 a[80:83], v19 offset:12288
  s_add_u32 m0, s76, 53248
  v_mfma_f32_16x16x32_bf16 v[116:119], a[36:39], a[32:35], 0
  ds_read_b128 a[84:87], v19 offset:14336
  buffer_load_dwordx4 v15, s[40:43], s74 offen lds
  v_mfma_f32_16x16x32_bf16 a[228:231], a[36:39], a[252:255], 0
  ds_read_b128 a[88:91], v19 offset:16384
  s_add_u32 m0, s76, 57344
  v_mfma_f32_16x16x32_bf16 v[120:123], a[40:43], a[0:3], 0
  ds_read_b64_tr_b16 a[92:93], v22 offset:20480
  buffer_load_dwordx4 v16, s[44:47], s74 offen lds
  v_mfma_f32_16x16x32_bf16 v[124:127], a[40:43], a[4:7], 0
  ds_read_b64_tr_b16 a[94:95], v22 offset:20992
  s_add_u32 s73, s73, s75
  v_mfma_f32_16x16x32_bf16 v[128:131], a[40:43], a[8:11], 0
  ds_read_b64_tr_b16 a[96:97], v22 offset:24576
  s_add_u32 s74, s74, 114688
  v_mfma_f32_16x16x32_bf16 v[132:135], a[40:43], a[12:15], 0
  ds_read_b64_tr_b16 a[98:99], v22 offset:25088
  s_add_u32 m0, s76, 61440
  v_mfma_f32_16x16x32_bf16 v[136:139], a[40:43], a[16:19], 0
  ds_read_b64_tr_b16 a[100:101], v22 offset:28672
  buffer_load_dwordx4 v12, s[28:31], s73 offen lds
  v_mfma_f32_16x16x32_bf16 v[140:143], a[40:43], a[20:23], 0
  ds_read_b64_tr_b16 a[102:103], v22 offset:29184
  s_add_u32 m0, s76, 65536
  v_mfma_f32_16x16x32_bf16 v[144:147], a[40:43], a[24:27], 0
  ds_read_b64_tr_b16 a[104:105], v22 offset:32768
  buffer_load_dwordx4 v13, s[32:35], s73 offen lds
  v_mfma_f32_16x16x32_bf16 v[148:151], a[40:43], a[28:31], 0
  ds_read_b64_tr_b16 a[106:107], v22 offset:33280
  s_add_u32 m0, s76, 69632
  v_mfma_f32_16x16x32_bf16 v[152:155], a[40:43], a[32:35], 0
  ds_read_b64_tr_b16 a[108:109], v22 offset:36864
  buffer_load_dwordx4 v14, s[36:39], s73 offen lds
  v_mfma_f32_16x16x32_bf16 v[156:159], a[0:3], a[44:47], 0
  ds_read_b64_tr_b16 a[110:111], v22 offset:37376
  s_add_u32 m0, s76, 73728
  v_mfma_f32_16x16x32_bf16 v[160:163], a[4:7], a[44:47], 0
  buffer_load_dwordx4 v15, s[40:43], s74 offen lds
  s_add_u32 m0, s76, 77824
  v_mfma_f32_16x16x32_bf16 v[164:167], a[8:11], a[44:47], 0
  buffer_load_dwordx4 v16, s[44:47], s74 offen lds
  s_add_u32 s73, s73, s75
  v_mfma_f32_16x16x32_bf16 v[168:171], a[12:15], a[44:47], 0
  s_add_u32 s74, s74, 114688
  s_cmp_eq_u32 s74, 1835008
  s_cselect_b32 s73, 0, s73
  s_cselect_b32 s74, 0, s74
  v_mfma_f32_16x16x32_bf16 v[172:175], a[16:19], a[44:47], 0
  s_add_u32 s92, s93, 0
  s_add_u32 m0, s77, 139264
  v_mfma_f32_16x16x32_bf16 v[176:179], a[20:23], a[44:47], 0
  buffer_load_dwordx4 v8, s[4:7], s92 offen lds
  s_lshl_b32 s84, s69, 7
  v_mfma_f32_16x16x32_bf16 v[180:183], a[24:27], a[44:47], 0
  s_lshl_b32 s83, s70, 3
  s_add_u32 s83, s83, s84
  v_mfma_f32_16x16x32_bf16 v[184:187], a[28:31], a[44:47], 0
  s_lshl_b32 s84, s68, 1
  s_add_u32 s83, s83, s84
  v_mfma_f32_16x16x32_bf16 v[188:191], a[32:35], a[44:47], 0
  s_lshl_b32 s83, s83, 10
  v_lshlrev_b32 v76, 4, v1
  v_mfma_f32_16x16x32_bf16 v[192:195], a[48:51], a[4:7], 0
  buffer_load_dwordx4 v[60:63], v76, s[4:7], s83 offen
  buffer_load_dwordx4 v[64:67], v76, s[4:7], s83 offen offset:1024
  v_mfma_f32_16x16x32_bf16 v[196:199], a[48:51], a[8:11], 0
  v_add_u32 v44, 2, v44
  v_mfma_f32_16x16x32_bf16 v[200:203], a[48:51], a[12:15], 0
  v_and_b32 v44, 15, v44
  v_lshl_add_u32 v48, v44, 5, v45
  v_mfma_f32_16x16x32_bf16 v[204:207], a[48:51], a[16:19], 0
  v_mad_u32_u24 v49, v48, s86, v46
  v_mfma_f32_16x16x32_bf16 v[208:211], a[48:51], a[20:23], 0
  v_mad_u32_u24 v48, v48, s87, v47
  buffer_load_dword a220, v49, s[88:91], s54 offen
  v_mfma_f32_16x16x32_bf16 v[212:215], a[48:51], a[24:27], 0
  buffer_load_dword a221, v48, s[44:47], s55 offen
  v_mfma_f32_16x16x32_bf16 v[216:219], a[48:51], a[28:31], 0
  s_mov_b32 s8, s52
  v_mfma_f32_16x16x32_bf16 v[220:223], a[48:51], a[32:35], 0
  s_mov_b32 s9, s53
  s_mov_b32 s10, 524288
  v_mfma_f32_16x16x32_bf16 a[240:243], a[48:51], a[252:255], 0
  s_mov_b32 s11, 0x20000
  v_mfma_f32_16x16x32_bf16 v[224:227], a[52:55], a[4:7], 0
  s_mov_b32 s12, s60
  v_mfma_f32_16x16x32_bf16 v[228:231], a[52:55], a[8:11], 0
  s_mov_b32 s13, s61
  s_mov_b32 s14, 1835008
  v_mfma_f32_16x16x32_bf16 v[232:235], a[52:55], a[12:15], 0
  s_mov_b32 s15, 0x20000
  v_mfma_f32_16x16x32_bf16 v[236:239], a[52:55], a[16:19], 0
  s_mov_b32 s20, s66
  s_mov_b32 s21, s67
  v_mfma_f32_16x16x32_bf16 v[240:243], a[52:55], a[20:23], 0
  s_mov_b32 s22, 9568256
  v_mfma_f32_16x16x32_bf16 v[244:247], a[52:55], a[24:27], 0
  s_mov_b32 s23, 0x20000
  v_mfma_f32_16x16x32_bf16 v[248:251], a[52:55], a[28:31], 0
  s_mov_b32 s16, s62
  s_mov_b32 s17, s63
  v_mfma_f32_16x16x32_bf16 v[252:255], a[52:55], a[32:35], 0
  s_mov_b32 s18, 2097152
  v_mfma_f32_16x16x32_bf16 a[244:247], a[52:55], a[252:255], 0
  s_mov_b32 s19, 0x20000
  s_waitcnt vmcnt(10) lgkmcnt(0)
  s_barrier
  v_mfma_f32_16x16x32_bf16 v[88:91], a[92:95], a[60:63], v[88:91]
  ds_read_b128 a[0:3], v18 offset:18432
  s_add_u32 m0, s77, 140288
  v_mfma_f32_16x16x32_bf16 v[92:95], a[92:95], a[64:67], v[92:95]
  ds_read_b128 a[4:7], v18 offset:20480
  buffer_load_dwordx4 v9, s[4:7], s92 offen lds
  v_mfma_f32_16x16x32_bf16 v[96:99], a[92:95], a[68:71], v[96:99]
  ds_read_b128 a[8:11], v18 offset:22528
  v_mov_b32 v56, 0
  v_mfma_f32_16x16x32_bf16 v[100:103], a[92:95], a[72:75], v[100:103]
  ds_read_b128 a[12:15], v18 offset:24576
  buffer_load_dwordx2 v[56:57], v56, s[24:27], 0 offen sc1
  v_mfma_f32_16x16x32_bf16 v[104:107], a[92:95], a[76:79], v[104:107]
  ds_read_b128 a[16:19], v18 offset:26624
  v_add_u32 v44, 2, v44
  v_mfma_f32_16x16x32_bf16 v[108:111], a[92:95], a[80:83], v[108:111]
  ds_read_b128 a[20:23], v18 offset:28672
  s_add_u32 m0, s3, 139264
  v_mfma_f32_16x16x32_bf16 v[112:115], a[92:95], a[84:87], v[112:115]
  ds_read_b128 a[24:27], v18 offset:30720
  buffer_load_dword v10, s[4:7], s93 offen lds
  v_mfma_f32_16x16x32_bf16 v[116:119], a[92:95], a[88:91], v[116:119]
  ds_read_b128 a[28:31], v18 offset:32768
  v_and_b32 v44, 15, v44
  v_mfma_f32_16x16x32_bf16 a[228:231], a[92:95], a[252:255], a[228:231]
  ds_read_b128 a[32:35], v18 offset:34816
  v_lshl_add_u32 v48, v44, 5, v45
  v_mfma_f32_16x16x32_bf16 v[120:123], a[96:99], a[56:59], v[120:123]
  ds_read_b64_tr_b16 a[36:37], v22 offset:40960
  v_mad_u32_u24 v49, v48, s86, v46
  v_mfma_f32_16x16x32_bf16 v[124:127], a[96:99], a[60:63], v[124:127]
  ds_read_b64_tr_b16 a[38:39], v22 offset:41472
  s_add_u32 s92, s93, 16384
  v_mfma_f32_16x16x32_bf16 v[128:131], a[96:99], a[64:67], v[128:131]
  ds_read_b64_tr_b16 a[40:41], v22 offset:45056
  s_add_u32 m0, s77, 141312
  v_mfma_f32_16x16x32_bf16 v[132:135], a[96:99], a[68:71], v[132:135]
  ds_read_b64_tr_b16 a[42:43], v22 offset:45568
  buffer_load_dwordx4 v8, s[4:7], s92 offen lds
  v_mfma_f32_16x16x32_bf16 v[136:139], a[96:99], a[72:75], v[136:139]
  ds_read_b64_tr_b16 a[44:45], v22 offset:49152
  v_mad_u32_u24 v48, v48, s87, v47
  v_mfma_f32_16x16x32_bf16 v[140:143], a[96:99], a[76:79], v[140:143]
  ds_read_b64_tr_b16 a[46:47], v22 offset:49664
  buffer_load_dword a222, v49, s[88:91], s54 offen
  v_mfma_f32_16x16x32_bf16 v[144:147], a[96:99], a[80:83], v[144:147]
  ds_read_b64_tr_b16 a[48:49], v22 offset:53248
  buffer_load_dword a223, v48, s[44:47], s55 offen
  v_mfma_f32_16x16x32_bf16 v[148:151], a[96:99], a[84:87], v[148:151]
  ds_read_b64_tr_b16 a[50:51], v22 offset:53760
  s_add_u32 m0, s77, 142336
  v_mfma_f32_16x16x32_bf16 v[152:155], a[96:99], a[88:91], v[152:155]
  ds_read_b64_tr_b16 a[52:53], v22 offset:57344
  buffer_load_dwordx4 v9, s[4:7], s92 offen lds
  v_mfma_f32_16x16x32_bf16 v[156:159], a[56:59], a[100:103], v[156:159]
  ds_read_b64_tr_b16 a[54:55], v22 offset:57856
  s_lshr_b32 s83, s2, 3
  v_mfma_f32_16x16x32_bf16 v[160:163], a[60:63], a[100:103], v[160:163]
  s_add_u32 m0, s78, 139520
  s_nop 0
  buffer_load_dword v11, s[4:7], s93 offen lds
  v_mfma_f32_16x16x32_bf16 v[164:167], a[64:67], a[100:103], v[164:167]
  s_add_u32 s93, s93, 128
  s_and_b32 s93, s93, 1023
  v_mfma_f32_16x16x32_bf16 v[168:171], a[68:71], a[100:103], v[168:171]
  s_and_b32 s84, s2, 7
  s_lshr_b32 s71, s84, 1
  v_mfma_f32_16x16x32_bf16 v[172:175], a[72:75], a[100:103], v[172:175]
  s_lshl_b32 s71, s71, 3
  s_add_u32 m0, s76, 81920
  v_mfma_f32_16x16x32_bf16 v[176:179], a[76:79], a[100:103], v[176:179]
  buffer_load_dwordx4 v12, s[28:31], s73 offen lds
  v_mfma_f32_16x16x32_bf16 v[180:183], a[80:83], a[100:103], v[180:183]
  s_lshr_b32 s64, s83, 2
  v_mfma_f32_16x16x32_bf16 v[184:187], a[84:87], a[100:103], v[184:187]
  s_add_u32 s71, s71, s64
  s_and_b32 s72, s83, 3
  v_mfma_f32_16x16x32_bf16 v[188:191], a[88:91], a[100:103], v[188:191]
  s_add_u32 m0, s76, 86016
  v_mfma_f32_16x16x32_bf16 v[192:195], a[104:107], a[60:63], v[192:195]
  buffer_load_dwordx4 v13, s[32:35], s73 offen lds
  v_mfma_f32_16x16x32_bf16 v[196:199], a[104:107], a[64:67], v[196:199]
  s_and_b32 s84, s84, 1
  v_mfma_f32_16x16x32_bf16 v[200:203], a[104:107], a[68:71], v[200:203]
  s_xor_b32 s84, s84, 0
  v_mfma_f32_16x16x32_bf16 v[204:207], a[104:107], a[72:75], v[204:207]
  s_lshl_b32 s84, s84, 2
  v_mfma_f32_16x16x32_bf16 v[208:211], a[104:107], a[76:79], v[208:211]
  s_add_u32 s72, s72, s84
  v_mfma_f32_16x16x32_bf16 v[212:215], a[104:107], a[80:83], v[212:215]
  s_add_u32 m0, s76, 90112
  s_nop 0
  buffer_load_dwordx4 v14, s[36:39], s73 offen lds
  v_mfma_f32_16x16x32_bf16 v[216:219], a[104:107], a[84:87], v[216:219]
  s_lshl_b32 s85, s68, 11
  v_mfma_f32_16x16x32_bf16 v[220:223], a[104:107], a[88:91], v[220:223]
  s_mul_i32 s62, s72, 0
  v_mfma_f32_16x16x32_bf16 a[240:243], a[104:107], a[252:255], a[240:243]
  s_mul_i32 s63, s71, 1
  v_mfma_f32_16x16x32_bf16 v[224:227], a[108:111], a[60:63], v[224:227]
  s_add_u32 m0, s76, 94208
  v_mfma_f32_16x16x32_bf16 v[228:231], a[108:111], a[64:67], v[228:231]
  buffer_load_dwordx4 v15, s[40:43], s74 offen lds
  v_mfma_f32_16x16x32_bf16 v[232:235], a[108:111], a[68:71], v[232:235]
  s_add_u32 s62, s62, s63
  s_add_u32 m0, s76, 98304
  v_mfma_f32_16x16x32_bf16 v[236:239], a[108:111], a[72:75], v[236:239]
  buffer_load_dwordx4 v16, s[44:47], s74 offen lds
  v_mfma_f32_16x16x32_bf16 v[240:243], a[108:111], a[76:79], v[240:243]
  s_add_u32 s73, s73, s75
  v_mfma_f32_16x16x32_bf16 v[244:247], a[108:111], a[80:83], v[244:247]
  s_add_u32 s74, s74, 114688
  v_mfma_f32_16x16x32_bf16 v[248:251], a[108:111], a[84:87], v[248:251]
  s_and_b32 s62, s62, 7
  v_mfma_f32_16x16x32_bf16 v[252:255], a[108:111], a[88:91], v[252:255]
  s_lshl_b32 s63, s62, 12
  v_mfma_f32_16x16x32_bf16 a[244:247], a[108:111], a[252:255], a[244:247]
  s_lshl_b32 s62, s62, 16
  s_waitcnt vmcnt(15) lgkmcnt(0)
  s_barrier
  v_mfma_f32_16x16x32_bf16 v[88:91], a[36:39], a[4:7], v[88:91]
  ds_read_b128 a[56:59], v19 offset:18432
  s_and_b32 s65, s70, 7
  v_mfma_f32_16x16x32_bf16 v[92:95], a[36:39], a[8:11], v[92:95]
  ds_read_b128 a[60:63], v19 offset:20480
  s_lshl_b32 s65, s65, 2
  v_mfma_f32_16x16x32_bf16 v[96:99], a[36:39], a[12:15], v[96:99]
  ds_read_b128 a[64:67], v19 offset:22528
  s_add_u32 m0, s76, 0
  v_mfma_f32_16x16x32_bf16 v[100:103], a[36:39], a[16:19], v[100:103]
  ds_read_b128 a[68:71], v19 offset:24576
  buffer_load_dwordx4 v12, s[28:31], s73 offen lds
  v_mfma_f32_16x16x32_bf16 v[104:107], a[36:39], a[20:23], v[104:107]
  ds_read_b128 a[72:75], v19 offset:26624
  s_lshr_b32 s64, 0x11061133, s65
  v_mfma_f32_16x16x32_bf16 v[108:111], a[36:39], a[24:27], v[108:111]
  ds_read_b128 a[76:79], v19 offset:28672
  s_and_b32 s64, s64, 15
  v_mfma_f32_16x16x32_bf16 v[112:115], a[36:39], a[28:31], v[112:115]
  ds_read_b128 a[80:83], v19 offset:30720
  s_lshr_b32 s65, 0x76607630, s65
  v_mfma_f32_16x16x32_bf16 v[116:119], a[36:39], a[32:35], v[116:119]
  ds_read_b128 a[84:87], v19 offset:32768
  s_and_b32 s65, s65, 15
  v_mfma_f32_16x16x32_bf16 a[228:231], a[36:39], a[252:255], a[228:231]
  ds_read_b128 a[88:91], v19 offset:34816
  s_lshr_b32 s59, s2, 5
  v_mfma_f32_16x16x32_bf16 v[120:123], a[40:43], a[0:3], v[120:123]
  ds_read_b64_tr_b16 a[92:93], v23 offset:0
  s_lshl_b32 s59, s59, 2
  v_mfma_f32_16x16x32_bf16 v[124:127], a[40:43], a[4:7], v[124:127]
  ds_read_b64_tr_b16 a[94:95], v23 offset:512
  s_add_u32 s59, s59, s68
  v_mfma_f32_16x16x32_bf16 v[128:131], a[40:43], a[8:11], v[128:131]
  ds_read_b64_tr_b16 a[96:97], v23 offset:4096
  s_add_u32 m0, s76, 4096
  v_mfma_f32_16x16x32_bf16 v[132:135], a[40:43], a[12:15], v[132:135]
  ds_read_b64_tr_b16 a[98:99], v23 offset:4608
  buffer_load_dwordx4 v13, s[32:35], s73 offen lds
  v_mfma_f32_16x16x32_bf16 v[136:139], a[40:43], a[16:19], v[136:139]
  ds_read_b64_tr_b16 a[100:101], v23 offset:8192
  s_lshl_b32 s59, s59, 3
  v_mfma_f32_16x16x32_bf16 v[140:143], a[40:43], a[20:23], v[140:143]
  ds_read_b64_tr_b16 a[102:103], v23 offset:8704
  s_add_u32 s59, s59, s65
  v_mfma_f32_16x16x32_bf16 v[144:147], a[40:43], a[24:27], v[144:147]
  ds_read_b64_tr_b16 a[104:105], v23 offset:12288
  s_lshl_b32 s59, s59, 10
  v_mfma_f32_16x16x32_bf16 v[148:151], a[40:43], a[28:31], v[148:151]
  ds_read_b64_tr_b16 a[106:107], v23 offset:12800
  s_and_b32 s65, s2, 1
  v_mfma_f32_16x16x32_bf16 v[152:155], a[40:43], a[32:35], v[152:155]
  ds_read_b64_tr_b16 a[108:109], v23 offset:16384
  s_lshl_b32 s65, s65, 9
  v_mfma_f32_16x16x32_bf16 v[156:159], a[0:3], a[44:47], v[156:159]
  ds_read_b64_tr_b16 a[110:111], v23 offset:16896
  s_add_u32 s59, s59, s65
  v_mfma_f32_16x16x32_bf16 v[160:163], a[4:7], a[44:47], v[160:163]
  v_and_b32 v2, 3, v1
  s_add_u32 m0, s76, 8192
  v_mfma_f32_16x16x32_bf16 v[164:167], a[8:11], a[44:47], v[164:167]
  buffer_load_dwordx4 v14, s[36:39], s73 offen lds
  v_lshlrev_b32 v2, 7, v2
  v_mfma_f32_16x16x32_bf16 v[168:171], a[12:15], a[44:47], v[168:171]
  v_lshrrev_b32 v3, 2, v1
  v_cmp_le_u32 vcc, s64, v3
  v_mfma_f32_16x16x32_bf16 v[172:175], a[16:19], a[44:47], v[172:175]
  v_lshl_add_u32 v2, v3, 10, v2
  v_add_u32 v2, s59, v2
  v_mfma_f32_16x16x32_bf16 v[176:179], a[20:23], a[44:47], v[176:179]
  v_mov_b32 v3, 0x80000000
  v_cndmask_b32 v2, v2, v3, vcc
  v_mfma_f32_16x16x32_bf16 v[180:183], a[24:27], a[44:47], v[180:183]
  s_add_u32 m0, s76, 12288
  s_nop 0
  buffer_load_dwordx4 v15, s[40:43], s74 offen lds
  v_mfma_f32_16x16x32_bf16 v[184:187], a[28:31], a[44:47], v[184:187]
  s_lshr_b32 s59, s2, 1
  s_add_u32 s65, s59, 0
  v_mfma_f32_16x16x32_bf16 v[188:191], a[32:35], a[44:47], v[188:191]
  s_and_b32 s65, s65, 3
  s_lshl_b32 s65, s65, 18
  v_mfma_f32_16x16x32_bf16 v[192:195], a[48:51], a[4:7], v[192:195]
  s_add_u32 s65, s65, 524288
  s_add_u32 m0, s76, 16384
  v_mfma_f32_16x16x32_bf16 v[196:199], a[48:51], a[8:11], v[196:199]
  buffer_load_dwordx4 v16, s[44:47], s74 offen lds
  s_add_u32 s73, s73, s75
  v_mfma_f32_16x16x32_bf16 v[200:203], a[48:51], a[12:15], v[200:203]
  s_add_u32 s74, s74, 114688
  buffer_load_dword a216, v2, s[12:15], s65 offen
  v_mfma_f32_16x16x32_bf16 v[204:207], a[48:51], a[16:19], v[204:207]
  v_lshlrev_b32 v68, 16, v60
  v_lshlrev_b32 v76, 16, v64
  v_mfma_f32_16x16x32_bf16 v[208:211], a[48:51], a[20:23], v[208:211]
  v_and_b32 v69, 0xffff0000, v60
  v_and_b32 v77, 0xffff0000, v64
  v_mfma_f32_16x16x32_bf16 v[212:215], a[48:51], a[24:27], v[212:215]
  s_add_u32 s92, s93, 0
  s_add_u32 m0, s77, 102400
  v_mfma_f32_16x16x32_bf16 v[216:219], a[48:51], a[28:31], v[216:219]
  buffer_load_dwordx4 v8, s[4:7], s92 offen lds
  v_lshlrev_b32 v70, 16, v61
  v_mfma_f32_16x16x32_bf16 v[220:223], a[48:51], a[32:35], v[220:223]
  v_lshlrev_b32 v78, 16, v65
  v_and_b32 v71, 0xffff0000, v61
  v_mfma_f32_16x16x32_bf16 a[240:243], a[48:51], a[252:255], a[240:243]
  v_and_b32 v79, 0xffff0000, v65
  v_lshlrev_b32 v72, 16, v62
  v_mfma_f32_16x16x32_bf16 v[224:227], a[52:55], a[4:7], v[224:227]
  v_lshlrev_b32 v80, 16, v66
  v_and_b32 v73, 0xffff0000, v62
  v_mfma_f32_16x16x32_bf16 v[228:231], a[52:55], a[8:11], v[228:231]
  s_add_u32 m0, s77, 103424
  s_nop 0
  buffer_load_dwordx4 v9, s[4:7], s92 offen lds
  v_mfma_f32_16x16x32_bf16 v[232:235], a[52:55], a[12:15], v[232:235]
  v_and_b32 v81, 0xffff0000, v66
  v_lshlrev_b32 v74, 16, v63
  v_mfma_f32_16x16x32_bf16 v[236:239], a[52:55], a[16:19], v[236:239]
  v_lshlrev_b32 v82, 16, v67
  v_and_b32 v75, 0xffff0000, v63
  v_mfma_f32_16x16x32_bf16 v[240:243], a[52:55], a[20:23], v[240:243]
  v_and_b32 v83, 0xffff0000, v67
  v_add_f32 v60, v68, v69
  v_mfma_f32_16x16x32_bf16 v[244:247], a[52:55], a[24:27], v[244:247]
  v_add_f32 v64, v76, v77
  s_add_u32 m0, s3, 102400
  v_mfma_f32_16x16x32_bf16 v[248:251], a[52:55], a[28:31], v[248:251]
  buffer_load_dword v10, s[4:7], s93 offen lds
  v_add_f32 v61, v70, v71
  v_mfma_f32_16x16x32_bf16 v[252:255], a[52:55], a[32:35], v[252:255]
  v_add_f32 v65, v78, v79
  v_add_f32 v62, v72, v73
  v_mfma_f32_16x16x32_bf16 a[244:247], a[52:55], a[252:255], a[244:247]
  v_add_f32 v66, v80, v81
  v_add_f32 v63, v74, v75
  v_add_f32 v67, v82, v83
  s_add_u32 s92, s93, 16384
  s_add_u32 m0, s77, 104448
  s_nop 0
  buffer_load_dwordx4 v8, s[4:7], s92 offen lds
  v_add_f32 v60, v60, v61
  v_add_f32 v64, v64, v65
  v_add_f32 v62, v62, v63
  v_add_f32 v66, v66, v67
  v_add_f32 v60, v60, v62
  v_add_f32 v64, v64, v66
  s_nop 0
  v_add_f32_dpp v60, v60, v60 row_ror:8 row_mask:0xf bank_mask:0xf
  s_add_u32 m0, s77, 105472
  s_nop 0
  buffer_load_dwordx4 v9, s[4:7], s92 offen lds
  v_add_f32_dpp v64, v64, v64 row_ror:8 row_mask:0xf bank_mask:0xf
  v_add_f32_dpp v60, v60, v60 row_ror:4 row_mask:0xf bank_mask:0xf
  s_nop 0
  v_add_f32_dpp v64, v64, v64 row_ror:4 row_mask:0xf bank_mask:0xf
  v_add_f32_dpp v60, v60, v60 row_ror:2 row_mask:0xf bank_mask:0xf
  s_nop 0
  v_add_f32_dpp v64, v64, v64 row_ror:2 row_mask:0xf bank_mask:0xf
  s_waitcnt vmcnt(11) lgkmcnt(0)
  s_barrier
  v_mfma_f32_16x16x32_bf16 v[88:91], a[92:95], a[60:63], v[88:91]
  ds_read_b128 a[0:3], v18 offset:36864
  s_add_u32 m0, s78, 102656
  v_mfma_f32_16x16x32_bf16 v[92:95], a[92:95], a[64:67], v[92:95]
  ds_read_b128 a[4:7], v18 offset:38912
  buffer_load_dword v11, s[4:7], s93 offen lds
  v_mfma_f32_16x16x32_bf16 v[96:99], a[92:95], a[68:71], v[96:99]
  ds_read_b128 a[8:11], v18 offset:40960
  s_add_u32 s93, s93, 128
  v_mfma_f32_16x16x32_bf16 v[100:103], a[92:95], a[72:75], v[100:103]
  ds_read_b128 a[12:15], v18 offset:43008
  s_and_b32 s93, s93, 1023
  v_mfma_f32_16x16x32_bf16 v[104:107], a[92:95], a[76:79], v[104:107]
  ds_read_b128 a[16:19], v18 offset:45056
  s_add_u32 s65, s59, 1
  v_mfma_f32_16x16x32_bf16 v[108:111], a[92:95], a[80:83], v[108:111]
  ds_read_b128 a[20:23], v18 offset:47104
  s_add_u32 m0, s76, 20480
  v_mfma_f32_16x16x32_bf16 v[112:115], a[92:95], a[84:87], v[112:115]
  ds_read_b128 a[24:27], v18 offset:49152
  buffer_load_dwordx4 v12, s[28:31], s73 offen lds
  v_mfma_f32_16x16x32_bf16 v[116:119], a[92:95], a[88:91], v[116:119]
  ds_read_b128 a[28:31], v18 offset:51200
  s_and_b32 s65, s65, 3
  v_mfma_f32_16x16x32_bf16 a[228:231], a[92:95], a[252:255], a[228:231]
  ds_read_b128 a[32:35], v18 offset:53248
  s_lshl_b32 s65, s65, 18
  v_mfma_f32_16x16x32_bf16 v[120:123], a[96:99], a[56:59], v[120:123]
  ds_read_b64_tr_b16 a[36:37], v23 offset:20480
  s_add_u32 s65, s65, 524288
  v_mfma_f32_16x16x32_bf16 v[124:127], a[96:99], a[60:63], v[124:127]
  ds_read_b64_tr_b16 a[38:39], v23 offset:20992
  s_add_u32 m0, s76, 24576
  v_mfma_f32_16x16x32_bf16 v[128:131], a[96:99], a[64:67], v[128:131]
  ds_read_b64_tr_b16 a[40:41], v23 offset:24576
  buffer_load_dwordx4 v13, s[32:35], s73 offen lds
  v_mfma_f32_16x16x32_bf16 v[132:135], a[96:99], a[68:71], v[132:135]
  ds_read_b64_tr_b16 a[42:43], v23 offset:25088
  buffer_load_dword a217, v2, s[12:15], s65 offen
  v_mfma_f32_16x16x32_bf16 v[136:139], a[96:99], a[72:75], v[136:139]
  ds_read_b64_tr_b16 a[44:45], v23 offset:28672
  v_add_f32_dpp v60, v60, v60 row_ror:1 row_mask:0xf bank_mask:0xf
  v_mfma_f32_16x16x32_bf16 v[140:143], a[96:99], a[76:79], v[140:143]
  ds_read_b64_tr_b16 a[46:47], v23 offset:29184
  v_add_f32_dpp v64, v64, v64 row_ror:1 row_mask:0xf bank_mask:0xf
  v_mfma_f32_16x16x32_bf16 v[144:147], a[96:99], a[80:83], v[144:147]
  ds_read_b64_tr_b16 a[48:49], v23 offset:32768
  s_add_u32 m0, s76, 28672
  v_mfma_f32_16x16x32_bf16 v[148:151], a[96:99], a[84:87], v[148:151]
  ds_read_b64_tr_b16 a[50:51], v23 offset:33280
  buffer_load_dwordx4 v14, s[36:39], s73 offen lds
  v_mfma_f32_16x16x32_bf16 v[152:155], a[96:99], a[88:91], v[152:155]
  ds_read_b64_tr_b16 a[52:53], v23 offset:36864
  v_mov_b32 v61, v60
  v_mfma_f32_16x16x32_bf16 v[156:159], a[56:59], a[100:103], v[156:159]
  ds_read_b64_tr_b16 a[54:55], v23 offset:37376
  v_mov_b32 v65, v64
  v_mfma_f32_16x16x32_bf16 v[160:163], a[60:63], a[100:103], v[160:163]
  v_permlane16_swap_b32 v60, v61
  s_add_u32 m0, s76, 32768
  v_mfma_f32_16x16x32_bf16 v[164:167], a[64:67], a[100:103], v[164:167]
  buffer_load_dwordx4 v15, s[40:43], s74 offen lds
  s_add_u32 m0, s76, 36864
  v_mfma_f32_16x16x32_bf16 v[168:171], a[68:71], a[100:103], v[168:171]
  buffer_load_dwordx4 v16, s[44:47], s74 offen lds
  v_mfma_f32_16x16x32_bf16 v[172:175], a[72:75], a[100:103], v[172:175]
  s_add_u32 s73, s73, s75
  s_add_u32 s74, s74, 114688
  v_mfma_f32_16x16x32_bf16 v[176:179], a[76:79], a[100:103], v[176:179]
  v_permlane16_swap_b32 v64, v65
  v_mfma_f32_16x16x32_bf16 v[180:183], a[80:83], a[100:103], v[180:183]
  v_add_f32 v60, v60, v61
  v_mfma_f32_16x16x32_bf16 v[184:187], a[84:87], a[100:103], v[184:187]
  v_add_f32 v64, v64, v65
  v_mfma_f32_16x16x32_bf16 v[188:191], a[88:91], a[100:103], v[188:191]
  s_add_u32 m0, s76, 40960
  v_mfma_f32_16x16x32_bf16 v[192:195], a[104:107], a[60:63], v[192:195]
  buffer_load_dwordx4 v12, s[28:31], s73 offen lds
  v_mfma_f32_16x16x32_bf16 v[196:199], a[104:107], a[64:67], v[196:199]
  v_mov_b32 v61, v60
  v_mfma_f32_16x16x32_bf16 v[200:203], a[104:107], a[68:71], v[200:203]
  v_mov_b32 v65, v64
  v_mfma_f32_16x16x32_bf16 v[204:207], a[104:107], a[72:75], v[204:207]
  v_permlane32_swap_b32 v60, v61
  v_mfma_f32_16x16x32_bf16 v[208:211], a[104:107], a[76:79], v[208:211]
  s_add_u32 m0, s76, 45056
  v_mfma_f32_16x16x32_bf16 v[212:215], a[104:107], a[80:83], v[212:215]
  buffer_load_dwordx4 v13, s[32:35], s73 offen lds
  v_mfma_f32_16x16x32_bf16 v[216:219], a[104:107], a[84:87], v[216:219]
  v_permlane32_swap_b32 v64, v65
  v_add_f32 v60, v60, v61
  v_mfma_f32_16x16x32_bf16 v[220:223], a[104:107], a[88:91], v[220:223]
  v_add_f32 v64, v64, v65
  v_mfma_f32_16x16x32_bf16 a[240:243], a[104:107], a[252:255], a[240:243]
  s_add_u32 m0, s76, 49152
  v_mfma_f32_16x16x32_bf16 v[224:227], a[108:111], a[60:63], v[224:227]
  buffer_load_dwordx4 v14, s[36:39], s73 offen lds
  v_mfma_f32_16x16x32_bf16 v[228:231], a[108:111], a[64:67], v[228:231]
  v_mul_f32 v85, 0x3b000000, v60
  v_mfma_f32_16x16x32_bf16 v[232:235], a[108:111], a[68:71], v[232:235]
  v_mul_f32 v87, 0x3b000000, v64
  v_mfma_f32_16x16x32_bf16 v[236:239], a[108:111], a[72:75], v[236:239]
  v_sub_f32 v68, v68, v85
  v_mfma_f32_16x16x32_bf16 v[240:243], a[108:111], a[76:79], v[240:243]
  s_add_u32 m0, s76, 53248
  v_mfma_f32_16x16x32_bf16 v[244:247], a[108:111], a[80:83], v[244:247]
  buffer_load_dwordx4 v15, s[40:43], s74 offen lds
  v_mfma_f32_16x16x32_bf16 v[248:251], a[108:111], a[84:87], v[248:251]
  v_sub_f32 v76, v76, v87
  v_mfma_f32_16x16x32_bf16 v[252:255], a[108:111], a[88:91], v[252:255]
  v_sub_f32 v69, v69, v85
  v_mfma_f32_16x16x32_bf16 a[244:247], a[108:111], a[252:255], a[244:247]
  v_sub_f32 v77, v77, v87
  s_waitcnt vmcnt(17) lgkmcnt(0)
  s_barrier
  v_mfma_f32_16x16x32_bf16 v[88:91], a[36:39], a[4:7], v[88:91]
  ds_read_b128 a[56:59], v19 offset:36864
  s_add_u32 m0, s76, 57344
  v_mfma_f32_16x16x32_bf16 v[92:95], a[36:39], a[8:11], v[92:95]
  ds_read_b128 a[60:63], v19 offset:38912
  buffer_load_dwordx4 v16, s[44:47], s74 offen lds
  v_mfma_f32_16x16x32_bf16 v[96:99], a[36:39], a[12:15], v[96:99]
  ds_read_b128 a[64:67], v19 offset:40960
  s_add_u32 s73, s73, s75
  v_mfma_f32_16x16x32_bf16 v[100:103], a[36:39], a[16:19], v[100:103]
  ds_read_b128 a[68:71], v19 offset:43008
  s_add_u32 s74, s74, 114688
  v_mfma_f32_16x16x32_bf16 v[104:107], a[36:39], a[20:23], v[104:107]
  ds_read_b128 a[72:75], v19 offset:45056
  s_cmp_eq_u32 s74, 1835008
  s_cselect_b32 s73, 0, s73
  s_cselect_b32 s74, 0, s74
  v_mfma_f32_16x16x32_bf16 v[108:111], a[36:39], a[24:27], v[108:111]
  ds_read_b128 a[76:79], v19 offset:47104
  s_add_u32 s65, s59, 2
  v_mfma_f32_16x16x32_bf16 v[112:115], a[36:39], a[28:31], v[112:115]
  ds_read_b128 a[80:83], v19 offset:49152
  s_add_u32 s92, s93, 0
  v_mfma_f32_16x16x32_bf16 v[116:119], a[36:39], a[32:35], v[116:119]
  ds_read_b128 a[84:87], v19 offset:51200
  s_add_u32 m0, s77, 120832
  v_mfma_f32_16x16x32_bf16 a[228:231], a[36:39], a[252:255], a[228:231]
  ds_read_b128 a[88:91], v19 offset:53248
  buffer_load_dwordx4 v8, s[4:7], s92 offen lds
  v_mfma_f32_16x16x32_bf16 v[120:123], a[40:43], a[0:3], v[120:123]
  ds_read_b64_tr_b16 a[92:93], v22 offset:0
  s_and_b32 s65, s65, 3
  v_mfma_f32_16x16x32_bf16 v[124:127], a[40:43], a[4:7], v[124:127]
  ds_read_b64_tr_b16 a[94:95], v22 offset:512
  s_lshl_b32 s65, s65, 18
  v_mfma_f32_16x16x32_bf16 v[128:131], a[40:43], a[8:11], v[128:131]
  ds_read_b64_tr_b16 a[96:97], v22 offset:4096
  s_add_u32 s65, s65, 524288
  v_mfma_f32_16x16x32_bf16 v[132:135], a[40:43], a[12:15], v[132:135]
  ds_read_b64_tr_b16 a[98:99], v22 offset:4608
  buffer_load_dword a218, v2, s[12:15], s65 offen
  v_mfma_f32_16x16x32_bf16 v[136:139], a[40:43], a[16:19], v[136:139]
  ds_read_b64_tr_b16 a[100:101], v22 offset:8192
  s_add_u32 m0, s77, 121856
  v_mfma_f32_16x16x32_bf16 v[140:143], a[40:43], a[20:23], v[140:143]
  ds_read_b64_tr_b16 a[102:103], v22 offset:8704
  buffer_load_dwordx4 v9, s[4:7], s92 offen lds
  v_mfma_f32_16x16x32_bf16 v[144:147], a[40:43], a[24:27], v[144:147]
  ds_read_b64_tr_b16 a[104:105], v22 offset:12288
  v_sub_f32 v70, v70, v85
  v_mfma_f32_16x16x32_bf16 v[148:151], a[40:43], a[28:31], v[148:151]
  ds_read_b64_tr_b16 a[106:107], v22 offset:12800
  v_sub_f32 v78, v78, v87
  v_mfma_f32_16x16x32_bf16 v[152:155], a[40:43], a[32:35], v[152:155]
  ds_read_b64_tr_b16 a[108:109], v22 offset:16384
  v_sub_f32 v71, v71, v85
  v_mfma_f32_16x16x32_bf16 v[156:159], a[0:3], a[44:47], v[156:159]
  ds_read_b64_tr_b16 a[110:111], v22 offset:16896
  v_sub_f32 v79, v79, v87
  v_mfma_f32_16x16x32_bf16 v[160:163], a[4:7], a[44:47], v[160:163]
  s_add_u32 m0, s3, 120832
  s_nop 0
  buffer_load_dword v10, s[4:7], s93 offen lds
  v_mfma_f32_16x16x32_bf16 v[164:167], a[8:11], a[44:47], v[164:167]
  v_sub_f32 v72, v72, v85
  v_sub_f32 v80, v80, v87
  v_mfma_f32_16x16x32_bf16 v[168:171], a[12:15], a[44:47], v[168:171]
  v_sub_f32 v73, v73, v85
  s_add_u32 s92, s93, 16384
  v_mfma_f32_16x16x32_bf16 v[172:175], a[16:19], a[44:47], v[172:175]
  s_add_u32 m0, s77, 122880
  s_nop 0
  buffer_load_dwordx4 v8, s[4:7], s92 offen lds
  v_mfma_f32_16x16x32_bf16 v[176:179], a[20:23], a[44:47], v[176:179]
  v_sub_f32 v81, v81, v87
  v_sub_f32 v74, v74, v85
  v_mfma_f32_16x16x32_bf16 v[180:183], a[24:27], a[44:47], v[180:183]
  v_sub_f32 v82, v82, v87
  v_sub_f32 v75, v75, v85
  v_mfma_f32_16x16x32_bf16 v[184:187], a[28:31], a[44:47], v[184:187]
  v_sub_f32 v83, v83, v87
  s_add_u32 m0, s77, 123904
  v_mfma_f32_16x16x32_bf16 v[188:191], a[32:35], a[44:47], v[188:191]
  buffer_load_dwordx4 v9, s[4:7], s92 offen lds
  v_mul_f32 v60, v68, v68
  v_mfma_f32_16x16x32_bf16 v[192:195], a[48:51], a[4:7], v[192:195]
  v_mul_f32 v64, v76, v76
  s_add_u32 m0, s78, 121088
  v_mfma_f32_16x16x32_bf16 v[196:199], a[48:51], a[8:11], v[196:199]
  buffer_load_dword v11, s[4:7], s93 offen lds
  s_add_u32 s93, s93, 128
  v_mfma_f32_16x16x32_bf16 v[200:203], a[48:51], a[12:15], v[200:203]
  s_and_b32 s93, s93, 1023
  v_mul_f32 v61, v69, v69
  v_mfma_f32_16x16x32_bf16 v[204:207], a[48:51], a[16:19], v[204:207]
  v_mul_f32 v65, v77, v77
  v_fmac_f32 v60, v70, v70
  v_mfma_f32_16x16x32_bf16 v[208:211], a[48:51], a[20:23], v[208:211]
  v_fmac_f32 v64, v78, v78
  v_mfma_f32_16x16x32_bf16 v[212:215], a[48:51], a[24:27], v[212:215]
  s_add_u32 m0, s76, 61440
  v_mfma_f32_16x16x32_bf16 v[216:219], a[48:51], a[28:31], v[216:219]
  buffer_load_dwordx4 v12, s[28:31], s73 offen lds
  v_fmac_f32 v61, v71, v71
  v_mfma_f32_16x16x32_bf16 v[220:223], a[48:51], a[32:35], v[220:223]
  v_fmac_f32 v65, v79, v79
  v_mfma_f32_16x16x32_bf16 a[240:243], a[48:51], a[252:255], a[240:243]
  v_fmac_f32 v60, v72, v72
  v_fmac_f32 v64, v80, v80
  v_mfma_f32_16x16x32_bf16 v[224:227], a[52:55], a[4:7], v[224:227]
  s_add_u32 m0, s76, 65536
  v_mfma_f32_16x16x32_bf16 v[228:231], a[52:55], a[8:11], v[228:231]
  buffer_load_dwordx4 v13, s[32:35], s73 offen lds
  v_fmac_f32 v61, v73, v73
  v_mfma_f32_16x16x32_bf16 v[232:235], a[52:55], a[12:15], v[232:235]
  v_fmac_f32 v65, v81, v81
  v_mfma_f32_16x16x32_bf16 v[236:239], a[52:55], a[16:19], v[236:239]
  v_fmac_f32 v60, v74, v74
  v_mfma_f32_16x16x32_bf16 v[240:243], a[52:55], a[20:23], v[240:243]
  v_fmac_f32 v64, v82, v82
  s_add_u32 m0, s76, 69632
  v_mfma_f32_16x16x32_bf16 v[244:247], a[52:55], a[24:27], v[244:247]
  buffer_load_dwordx4 v14, s[36:39], s73 offen lds
  v_mfma_f32_16x16x32_bf16 v[248:251], a[52:55], a[28:31], v[248:251]
  v_fmac_f32 v61, v75, v75
  v_fmac_f32 v65, v83, v83
  v_mfma_f32_16x16x32_bf16 v[252:255], a[52:55], a[32:35], v[252:255]
  v_add_f32 v60, v60, v61
  v_mfma_f32_16x16x32_bf16 a[244:247], a[52:55], a[252:255], a[244:247]
  v_add_f32 v64, v64, v65
  s_waitcnt vmcnt(15) lgkmcnt(0)
  s_barrier
  v_mfma_f32_16x16x32_bf16 v[88:91], a[92:95], a[60:63], v[88:91]
  ds_read_b128 a[0:3], v18 offset:0
  s_add_u32 m0, s76, 73728
  v_mfma_f32_16x16x32_bf16 v[92:95], a[92:95], a[64:67], v[92:95]
  ds_read_b128 a[4:7], v18 offset:2048
  buffer_load_dwordx4 v15, s[40:43], s74 offen lds
  v_mfma_f32_16x16x32_bf16 v[96:99], a[92:95], a[68:71], v[96:99]
  ds_read_b128 a[8:11], v18 offset:4096
  s_add_u32 s65, s59, 3
  v_mfma_f32_16x16x32_bf16 v[100:103], a[92:95], a[72:75], v[100:103]
  ds_read_b128 a[12:15], v18 offset:6144
  s_and_b32 s65, s65, 3
  v_mfma_f32_16x16x32_bf16 v[104:107], a[92:95], a[76:79], v[104:107]
  ds_read_b128 a[16:19], v18 offset:8192
  s_add_u32 m0, s76, 77824
  v_mfma_f32_16x16x32_bf16 v[108:111], a[92:95], a[80:83], v[108:111]
  ds_read_b128 a[20:23], v18 offset:10240
  buffer_load_dwordx4 v16, s[44:47], s74 offen lds
  v_mfma_f32_16x16x32_bf16 v[112:115], a[92:95], a[84:87], v[112:115]
  ds_read_b128 a[24:27], v18 offset:12288
  s_add_u32 s73, s73, s75
  v_mfma_f32_16x16x32_bf16 v[116:119], a[92:95], a[88:91], v[116:119]
  ds_read_b128 a[28:31], v18 offset:14336
  s_add_u32 s74, s74, 114688
  v_mfma_f32_16x16x32_bf16 a[228:231], a[92:95], a[252:255], a[228:231]
  ds_read_b128 a[32:35], v18 offset:16384
  s_lshl_b32 s65, s65, 18
  v_mfma_f32_16x16x32_bf16 v[120:123], a[96:99], a[56:59], v[120:123]
  ds_read_b64_tr_b16 a[36:37], v22 offset:20480
  s_add_u32 s65, s65, 524288
  v_mfma_f32_16x16x32_bf16 v[124:127], a[96:99], a[60:63], v[124:127]
  ds_read_b64_tr_b16 a[38:39], v22 offset:20992
  buffer_load_dword a219, v2, s[12:15], s65 offen
  v_mfma_f32_16x16x32_bf16 v[128:131], a[96:99], a[64:67], v[128:131]
  ds_read_b64_tr_b16 a[40:41], v22 offset:24576
  v_add_f32_dpp v60, v60, v60 row_ror:8 row_mask:0xf bank_mask:0xf
  v_mfma_f32_16x16x32_bf16 v[132:135], a[96:99], a[68:71], v[132:135]
  ds_read_b64_tr_b16 a[42:43], v22 offset:25088
  s_add_u32 m0, s76, 81920
  v_mfma_f32_16x16x32_bf16 v[136:139], a[96:99], a[72:75], v[136:139]
  ds_read_b64_tr_b16 a[44:45], v22 offset:28672
  buffer_load_dwordx4 v12, s[28:31], s73 offen lds
  v_mfma_f32_16x16x32_bf16 v[140:143], a[96:99], a[76:79], v[140:143]
  ds_read_b64_tr_b16 a[46:47], v22 offset:29184
  v_add_f32_dpp v64, v64, v64 row_ror:8 row_mask:0xf bank_mask:0xf
  v_mfma_f32_16x16x32_bf16 v[144:147], a[96:99], a[80:83], v[144:147]
  ds_read_b64_tr_b16 a[48:49], v22 offset:32768
  v_add_f32_dpp v60, v60, v60 row_ror:4 row_mask:0xf bank_mask:0xf
  v_mfma_f32_16x16x32_bf16 v[148:151], a[96:99], a[84:87], v[148:151]
  ds_read_b64_tr_b16 a[50:51], v22 offset:33280
  v_add_f32_dpp v64, v64, v64 row_ror:4 row_mask:0xf bank_mask:0xf
  v_mfma_f32_16x16x32_bf16 v[152:155], a[96:99], a[88:91], v[152:155]
  ds_read_b64_tr_b16 a[52:53], v22 offset:36864
  s_add_u32 m0, s76, 86016
  v_mfma_f32_16x16x32_bf16 v[156:159], a[56:59], a[100:103], v[156:159]
  ds_read_b64_tr_b16 a[54:55], v22 offset:37376
  buffer_load_dwordx4 v13, s[32:35], s73 offen lds
  v_mfma_f32_16x16x32_bf16 v[160:163], a[60:63], a[100:103], v[160:163]
  v_add_f32_dpp v60, v60, v60 row_ror:2 row_mask:0xf bank_mask:0xf
  v_add_f32_dpp v64, v64, v64 row_ror:2 row_mask:0xf bank_mask:0xf
  v_mfma_f32_16x16x32_bf16 v[164:167], a[64:67], a[100:103], v[164:167]
  v_add_f32_dpp v60, v60, v60 row_ror:1 row_mask:0xf bank_mask:0xf
  v_add_f32_dpp v64, v64, v64 row_ror:1 row_mask:0xf bank_mask:0xf
  v_mfma_f32_16x16x32_bf16 v[168:171], a[68:71], a[100:103], v[168:171]
  s_add_u32 m0, s76, 90112
  s_nop 0
  buffer_load_dwordx4 v14, s[36:39], s73 offen lds
  v_mfma_f32_16x16x32_bf16 v[172:175], a[72:75], a[100:103], v[172:175]
  v_mov_b32 v61, v60
  v_mov_b32 v65, v64
  v_mfma_f32_16x16x32_bf16 v[176:179], a[76:79], a[100:103], v[176:179]
  v_permlane16_swap_b32 v60, v61
  s_add_u32 m0, s76, 94208
  v_mfma_f32_16x16x32_bf16 v[180:183], a[80:83], a[100:103], v[180:183]
  buffer_load_dwordx4 v15, s[40:43], s74 offen lds
  v_permlane16_swap_b32 v64, v65
  v_mfma_f32_16x16x32_bf16 v[184:187], a[84:87], a[100:103], v[184:187]
  v_add_f32 v60, v60, v61
  s_add_u32 m0, s76, 98304
  v_mfma_f32_16x16x32_bf16 v[188:191], a[88:91], a[100:103], v[188:191]
  buffer_load_dwordx4 v16, s[44:47], s74 offen lds
  v_mfma_f32_16x16x32_bf16 v[192:195], a[104:107], a[60:63], v[192:195]
  s_add_u32 s73, s73, s75
  v_mfma_f32_16x16x32_bf16 v[196:199], a[104:107], a[64:67], v[196:199]
  s_add_u32 s74, s74, 114688
  v_add_f32 v64, v64, v65
  v_mfma_f32_16x16x32_bf16 v[200:203], a[104:107], a[68:71], v[200:203]
  v_mov_b32 v61, v60
  v_mfma_f32_16x16x32_bf16 v[204:207], a[104:107], a[72:75], v[204:207]
  v_mov_b32 v65, v64
  v_mfma_f32_16x16x32_bf16 v[208:211], a[104:107], a[76:79], v[208:211]
  s_add_u32 s92, s93, 0
  v_mfma_f32_16x16x32_bf16 v[212:215], a[104:107], a[80:83], v[212:215]
  s_add_u32 m0, s77, 139264
  s_nop 0
  buffer_load_dwordx4 v8, s[4:7], s92 offen lds
  v_mfma_f32_16x16x32_bf16 v[216:219], a[104:107], a[84:87], v[216:219]
  v_permlane32_swap_b32 v60, v61
  v_mfma_f32_16x16x32_bf16 v[220:223], a[104:107], a[88:91], v[220:223]
  v_permlane32_swap_b32 v64, v65
  v_mfma_f32_16x16x32_bf16 a[240:243], a[104:107], a[252:255], a[240:243]
  v_add_f32 v60, v60, v61
  v_mfma_f32_16x16x32_bf16 v[224:227], a[108:111], a[60:63], v[224:227]
  s_add_u32 m0, s77, 140288
  s_nop 0
  buffer_load_dwordx4 v9, s[4:7], s92 offen lds
  v_mfma_f32_16x16x32_bf16 v[228:231], a[108:111], a[64:67], v[228:231]
  v_add_f32 v64, v64, v65
  v_mfma_f32_16x16x32_bf16 v[232:235], a[108:111], a[68:71], v[232:235]
  v_mov_b32 v61, 0x3727c5ac
  v_mfma_f32_16x16x32_bf16 v[236:239], a[108:111], a[72:75], v[236:239]
  v_mov_b32 v65, 0x3727c5ac
  v_mfma_f32_16x16x32_bf16 v[240:243], a[108:111], a[76:79], v[240:243]
  v_fmac_f32 v61, 0x3b000000, v60
  s_add_u32 m0, s3, 139264
  v_mfma_f32_16x16x32_bf16 v[244:247], a[108:111], a[80:83], v[244:247]
  buffer_load_dword v10, s[4:7], s93 offen lds
  v_mfma_f32_16x16x32_bf16 v[248:251], a[108:111], a[84:87], v[248:251]
  v_fmac_f32 v65, 0x3b000000, v64
  v_mfma_f32_16x16x32_bf16 v[252:255], a[108:111], a[88:91], v[252:255]
  v_rsq_f32 v84, v61
  v_mfma_f32_16x16x32_bf16 a[244:247], a[108:111], a[252:255], a[244:247]
  v_rsq_f32 v86, v65
  s_waitcnt vmcnt(21) lgkmcnt(0)
  s_barrier
  v_mfma_f32_16x16x32_bf16 v[88:91], a[36:39], a[4:7], v[88:91]
  ds_read_b128 a[56:59], v19 offset:0
  s_add_u32 s92, s93, 16384
  v_mfma_f32_16x16x32_bf16 v[92:95], a[36:39], a[8:11], v[92:95]
  ds_read_b128 a[60:63], v19 offset:2048
  s_add_u32 m0, s77, 141312
  v_mfma_f32_16x16x32_bf16 v[96:99], a[36:39], a[12:15], v[96:99]
  ds_read_b128 a[64:67], v19 offset:4096
  buffer_load_dwordx4 v8, s[4:7], s92 offen lds
  v_mfma_f32_16x16x32_bf16 v[100:103], a[36:39], a[16:19], v[100:103]
  ds_read_b128 a[68:71], v19 offset:6144
  s_add_u32 s65, s59, 0
  v_mfma_f32_16x16x32_bf16 v[104:107], a[36:39], a[20:23], v[104:107]
  ds_read_b128 a[72:75], v19 offset:8192
  s_and_b32 s65, s65, 0
  v_mfma_f32_16x16x32_bf16 v[108:111], a[36:39], a[24:27], v[108:111]
  ds_read_b128 a[76:79], v19 offset:10240
  s_add_u32 m0, s77, 142336
  v_mfma_f32_16x16x32_bf16 v[112:115], a[36:39], a[28:31], v[112:115]
  ds_read_b128 a[80:83], v19 offset:12288
  buffer_load_dwordx4 v9, s[4:7], s92 offen lds
  v_mfma_f32_16x16x32_bf16 v[116:119], a[36:39], a[32:35], v[116:119]
  ds_read_b128 a[84:87], v19 offset:14336
  s_lshl_b32 s65, s65, 18
  v_mfma_f32_16x16x32_bf16 a[228:231], a[36:39], a[252:255], a[228:231]
  ds_read_b128 a[88:91], v19 offset:16384
  s_add_u32 m0, s78, 139520
  v_mfma_f32_16x16x32_bf16 v[120:123], a[40:43], a[0:3], v[120:123]
  ds_read_b64_tr_b16 a[92:93], v22 offset:40960
  buffer_load_dword v11, s[4:7], s93 offen lds
  v_mfma_f32_16x16x32_bf16 v[124:127], a[40:43], a[4:7], v[124:127]
  ds_read_b64_tr_b16 a[94:95], v22 offset:41472
  s_add_u32 s93, s93, 128
  v_mfma_f32_16x16x32_bf16 v[128:131], a[40:43], a[8:11], v[128:131]
  ds_read_b64_tr_b16 a[96:97], v22 offset:45056
  s_and_b32 s93, s93, 1023
  v_mfma_f32_16x16x32_bf16 v[132:135], a[40:43], a[12:15], v[132:135]
  ds_read_b64_tr_b16 a[98:99], v22 offset:45568
  s_add_u32 s65, s65, 1572864
  v_mfma_f32_16x16x32_bf16 v[136:139], a[40:43], a[16:19], v[136:139]
  ds_read_b64_tr_b16 a[100:101], v22 offset:49152
  buffer_load_dword a220, v2, s[12:15], s65 offen
  v_mfma_f32_16x16x32_bf16 v[140:143], a[40:43], a[20:23], v[140:143]
  ds_read_b64_tr_b16 a[102:103], v22 offset:49664
  v_readfirstlane_b32 s86, v56
  v_mfma_f32_16x16x32_bf16 v[144:147], a[40:43], a[24:27], v[144:147]
  ds_read_b64_tr_b16 a[104:105], v22 offset:53248
  s_add_u32 m0, s76, 0
  v_mfma_f32_16x16x32_bf16 v[148:151], a[40:43], a[28:31], v[148:151]
  ds_read_b64_tr_b16 a[106:107], v22 offset:53760
  buffer_load_dwordx4 v12, s[28:31], s73 offen lds
  v_mfma_f32_16x16x32_bf16 v[152:155], a[40:43], a[32:35], v[152:155]
  ds_read_b64_tr_b16 a[108:109], v22 offset:57344
  v_readfirstlane_b32 s87, v57
  v_mfma_f32_16x16x32_bf16 v[156:159], a[0:3], a[44:47], v[156:159]
  ds_read_b64_tr_b16 a[110:111], v22 offset:57856
  v_cmp_eq_u32 vcc, 1, v1
  v_mfma_f32_16x16x32_bf16 v[160:163], a[4:7], a[44:47], v[160:163]
  s_lshl_b32 s83, s69, 7
  s_add_u32 m0, s76, 4096
  v_mfma_f32_16x16x32_bf16 v[164:167], a[8:11], a[44:47], v[164:167]
  buffer_load_dwordx4 v13, s[32:35], s73 offen lds
  s_lshl_b32 s84, s70, 3
  v_mfma_f32_16x16x32_bf16 v[168:171], a[12:15], a[44:47], v[168:171]
  s_cmp_eq_u32 s86, 0
  s_cbranch_scc1 L_slow_nonce00
L_back_nonce00:
  v_mfma_f32_16x16x32_bf16 v[172:175], a[16:19], a[44:47], v[172:175]
  v_cndmask_b32 v60, v84, v86, vcc
  s_add_u32 m0, s76, 8192
  v_mfma_f32_16x16x32_bf16 v[176:179], a[20:23], a[44:47], v[176:179]
  buffer_load_dwordx4 v14, s[36:39], s73 offen lds
  v_mfma_f32_16x16x32_bf16 v[180:183], a[24:27], a[44:47], v[180:183]
  v_cndmask_b32 v61, v85, v87, vcc
  v_mfma_f32_16x16x32_bf16 v[184:187], a[28:31], a[44:47], v[184:187]
  v_mov_b32 v62, s86
  v_mfma_f32_16x16x32_bf16 v[188:191], a[32:35], a[44:47], v[188:191]
  v_mov_b32 v63, s87
  v_mfma_f32_16x16x32_bf16 v[192:195], a[48:51], a[4:7], v[192:195]
  s_add_u32 m0, s76, 12288
  v_mfma_f32_16x16x32_bf16 v[196:199], a[48:51], a[8:11], v[196:199]
  buffer_load_dwordx4 v15, s[40:43], s74 offen lds
  v_mfma_f32_16x16x32_bf16 v[200:203], a[48:51], a[12:15], v[200:203]
  s_add_u32 s83, s83, s84
  v_mfma_f32_16x16x32_bf16 v[204:207], a[48:51], a[16:19], v[204:207]
  s_add_u32 m0, s76, 16384
  s_nop 0
  buffer_load_dwordx4 v16, s[44:47], s74 offen lds
  v_mfma_f32_16x16x32_bf16 v[208:211], a[48:51], a[20:23], v[208:211]
  s_add_u32 s73, s73, s75
  v_mfma_f32_16x16x32_bf16 v[212:215], a[48:51], a[24:27], v[212:215]
  s_add_u32 s74, s74, 114688
  v_mfma_f32_16x16x32_bf16 v[216:219], a[48:51], a[28:31], v[216:219]
  s_lshl_b32 s84, s68, 1
  v_mfma_f32_16x16x32_bf16 v[220:223], a[48:51], a[32:35], v[220:223]
  s_add_u32 s83, s83, s84
  v_mfma_f32_16x16x32_bf16 a[240:243], a[48:51], a[252:255], a[240:243]
  s_lshl_b32 s83, s83, 4
  v_mfma_f32_16x16x32_bf16 v[224:227], a[52:55], a[4:7], v[224:227]
  s_add_u32 m0, s76, 20480
  v_mfma_f32_16x16x32_bf16 v[228:231], a[52:55], a[8:11], v[228:231]
  buffer_load_dwordx4 v12, s[28:31], s73 offen lds
  s_add_u32 s83, s83, 9437184
  v_mfma_f32_16x16x32_bf16 v[232:235], a[52:55], a[12:15], v[232:235]
  v_lshlrev_b32 v64, 4, v1
  v_mfma_f32_16x16x32_bf16 v[236:239], a[52:55], a[16:19], v[236:239]
  v_cmp_lt_u32 vcc, 1, v1
  v_mfma_f32_16x16x32_bf16 v[240:243], a[52:55], a[20:23], v[240:243]
  s_add_u32 m0, s76, 24576
  v_mfma_f32_16x16x32_bf16 v[244:247], a[52:55], a[24:27], v[244:247]
  buffer_load_dwordx4 v13, s[32:35], s73 offen lds
  v_mfma_f32_16x16x32_bf16 v[248:251], a[52:55], a[28:31], v[248:251]
  v_mov_b32 v65, 0x80000000
  v_mfma_f32_16x16x32_bf16 v[252:255], a[52:55], a[32:35], v[252:255]
  v_cndmask_b32 v64, v64, v65, vcc
  v_mfma_f32_16x16x32_bf16 a[244:247], a[52:55], a[252:255], a[244:247]
  buffer_store_dwordx4 v[60:63], v64, s[20:23], s83 offen sc1
  s_waitcnt vmcnt(21) lgkmcnt(0)
  s_barrier
  v_mfma_f32_16x16x32_bf16 v[88:91], a[92:95], a[60:63], v[88:91]
  ds_read_b128 a[0:3], v18 offset:18432
  s_add_u32 s65, s59, 0
  v_mfma_f32_16x16x32_bf16 v[92:95], a[92:95], a[64:67], v[92:95]
  ds_read_b128 a[4:7], v18 offset:20480
  s_add_u32 m0, s76, 28672
  v_mfma_f32_16x16x32_bf16 v[96:99], a[92:95], a[68:71], v[96:99]
  ds_read_b128 a[8:11], v18 offset:22528
  buffer_load_dwordx4 v14, s[36:39], s73 offen lds
  v_mfma_f32_16x16x32_bf16 v[100:103], a[92:95], a[72:75], v[100:103]
  ds_read_b128 a[12:15], v18 offset:24576
  s_and_b32 s65, s65, 1
  v_mfma_f32_16x16x32_bf16 v[104:107], a[92:95], a[76:79], v[104:107]
  ds_read_b128 a[16:19], v18 offset:26624
  s_lshl_b32 s65, s65, 18
  v_mfma_f32_16x16x32_bf16 v[108:111], a[92:95], a[80:83], v[108:111]
  ds_read_b128 a[20:23], v18 offset:28672
  s_add_u32 s65, s65, 0
  v_mfma_f32_16x16x32_bf16 v[112:115], a[92:95], a[84:87], v[112:115]
  ds_read_b128 a[24:27], v18 offset:30720
  buffer_load_dword a221, v2, s[12:15], s65 offen
  v_mfma_f32_16x16x32_bf16 v[116:119], a[92:95], a[88:91], v[116:119]
  ds_read_b128 a[28:31], v18 offset:32768
  s_add_u32 m0, s76, 32768
  v_mfma_f32_16x16x32_bf16 a[228:231], a[92:95], a[252:255], a[228:231]
  ds_read_b128 a[32:35], v18 offset:34816
  buffer_load_dwordx4 v15, s[40:43], s74 offen lds
  v_mfma_f32_16x16x32_bf16 v[120:123], a[96:99], a[56:59], v[120:123]
  ds_read_b64_tr_b16 a[36:37], v23 offset:0
  v_lshrrev_b32 v5, 2, v1
  v_mfma_f32_16x16x32_bf16 v[124:127], a[96:99], a[60:63], v[124:127]
  ds_read_b64_tr_b16 a[38:39], v23 offset:512
  v_and_b32 v5, 4, v5
  v_mfma_f32_16x16x32_bf16 v[128:131], a[96:99], a[64:67], v[128:131]
  ds_read_b64_tr_b16 a[40:41], v23 offset:4096
  s_add_u32 m0, s76, 36864
  v_mfma_f32_16x16x32_bf16 v[132:135], a[96:99], a[68:71], v[132:135]
  ds_read_b64_tr_b16 a[42:43], v23 offset:4608
  buffer_load_dwordx4 v16, s[44:47], s74 offen lds
  v_mfma_f32_16x16x32_bf16 v[136:139], a[96:99], a[72:75], v[136:139]
  ds_read_b64_tr_b16 a[44:45], v23 offset:8192
  s_add_u32 s73, s73, s75
  v_mfma_f32_16x16x32_bf16 v[140:143], a[96:99], a[76:79], v[140:143]
  ds_read_b64_tr_b16 a[46:47], v23 offset:8704
  s_add_u32 s74, s74, 114688
  v_mfma_f32_16x16x32_bf16 v[144:147], a[96:99], a[80:83], v[144:147]
  ds_read_b64_tr_b16 a[48:49], v23 offset:12288
  s_cmp_eq_u32 s74, 1835008
  s_cselect_b32 s73, 0, s73
  s_cselect_b32 s74, 0, s74
  v_mfma_f32_16x16x32_bf16 v[148:151], a[96:99], a[84:87], v[148:151]
  ds_read_b64_tr_b16 a[50:51], v23 offset:12800
  v_xor_b32 v5, v5, v1
  v_mfma_f32_16x16x32_bf16 v[152:155], a[96:99], a[88:91], v[152:155]
  ds_read_b64_tr_b16 a[52:53], v23 offset:16384
  v_and_b32 v5, 7, v5
  v_mfma_f32_16x16x32_bf16 v[156:159], a[56:59], a[100:103], v[156:159]
  ds_read_b64_tr_b16 a[54:55], v23 offset:16896
  v_lshlrev_b32 v5, 4, v5
  v_mfma_f32_16x16x32_bf16 v[160:163], a[60:63], a[100:103], v[160:163]
  s_add_u32 s92, s93, 0
  s_add_u32 m0, s77, 102400
  v_mfma_f32_16x16x32_bf16 v[164:167], a[64:67], a[100:103], v[164:167]
  buffer_load_dwordx4 v8, s[4:7], s92 offen lds
  v_lshrrev_b32 v6, 3, v1
  v_mfma_f32_16x16x32_bf16 v[168:171], a[68:71], a[100:103], v[168:171]
  v_lshl_add_u32 v5, v6, 10, v5
  s_lshl_b32 s84, s72, 7
  v_mfma_f32_16x16x32_bf16 v[172:175], a[72:75], a[100:103], v[172:175]
  v_add_u32 v17, s84, v5
  s_add_u32 m0, s77, 103424
  v_mfma_f32_16x16x32_bf16 v[176:179], a[76:79], a[100:103], v[176:179]
  buffer_load_dwordx4 v9, s[4:7], s92 offen lds
  s_and_b32 s83, s68, 1
  v_mfma_f32_16x16x32_bf16 v[180:183], a[80:83], a[100:103], v[180:183]
  s_lshr_b32 s84, s68, 1
  s_lshl_b32 s84, s84, 14
  v_mfma_f32_16x16x32_bf16 v[184:187], a[84:87], a[100:103], v[184:187]
  s_lshl_b32 s52, s83, 18
  s_add_u32 s52, s52, s84
  v_mfma_f32_16x16x32_bf16 v[188:191], a[88:91], a[100:103], v[188:191]
  s_add_u32 m0, s3, 102400
  s_nop 0
  buffer_load_dword v10, s[4:7], s93 offen lds
  v_mfma_f32_16x16x32_bf16 v[192:195], a[104:107], a[60:63], v[192:195]
  s_mov_b32 s53, s52
  s_lshl_b32 s64, s83, 19
  v_mfma_f32_16x16x32_bf16 v[196:199], a[104:107], a[64:67], v[196:199]
  s_add_u32 s64, s64, s84
  s_add_u32 s92, s93, 16384
  v_mfma_f32_16x16x32_bf16 v[200:203], a[104:107], a[68:71], v[200:203]
  s_add_u32 m0, s77, 104448
  s_nop 0
  buffer_load_dwordx4 v8, s[4:7], s92 offen lds
  v_mfma_f32_16x16x32_bf16 v[204:207], a[104:107], a[72:75], v[204:207]
  s_add_u32 s56, s64, 524288
  s_lshl_b32 s64, s83, 17
  v_mfma_f32_16x16x32_bf16 v[208:211], a[104:107], a[76:79], v[208:211]
  s_add_u32 s64, s64, s84
  s_add_u32 s57, s64, 1572864
  v_mfma_f32_16x16x32_bf16 v[212:215], a[104:107], a[80:83], v[212:215]
  s_lshl_b32 s83, s69, 7
  s_add_u32 m0, s77, 105472
  v_mfma_f32_16x16x32_bf16 v[216:219], a[104:107], a[84:87], v[216:219]
  buffer_load_dwordx4 v9, s[4:7], s92 offen lds
  v_mfma_f32_16x16x32_bf16 v[220:223], a[104:107], a[88:91], v[220:223]
  s_sub_u32 s84, s83, 16
  v_add_u32 v5, s84, v1
  v_mfma_f32_16x16x32_bf16 a[240:243], a[104:107], a[252:255], a[240:243]
  s_add_u32 m0, s78, 102656
  v_mfma_f32_16x16x32_bf16 v[224:227], a[108:111], a[60:63], v[224:227]
  buffer_load_dword v11, s[4:7], s93 offen lds
  s_add_u32 s93, s93, 128
  v_mfma_f32_16x16x32_bf16 v[228:231], a[108:111], a[64:67], v[228:231]
  s_and_b32 s93, s93, 1023
  v_mfma_f32_16x16x32_bf16 v[232:235], a[108:111], a[68:71], v[232:235]
  v_max_i32 v58, 0, v5
  v_lshlrev_b32 v58, 4, v58
  v_mfma_f32_16x16x32_bf16 v[236:239], a[108:111], a[72:75], v[236:239]
  v_add_u32 v5, 64, v5
  v_mfma_f32_16x16x32_bf16 v[240:243], a[108:111], a[76:79], v[240:243]
  v_lshlrev_b32 v59, 4, v5
  s_add_u32 m0, s76, 40960
  v_mfma_f32_16x16x32_bf16 v[244:247], a[108:111], a[80:83], v[244:247]
  buffer_load_dwordx4 v12, s[28:31], s73 offen lds
  v_mfma_f32_16x16x32_bf16 v[248:251], a[108:111], a[84:87], v[248:251]
  s_add_u32 s83, s83, 112
  v_and_b32 v5, 15, v1
  v_mfma_f32_16x16x32_bf16 v[252:255], a[108:111], a[88:91], v[252:255]
  v_add_u32 v5, s83, v5
  v_mfma_f32_16x16x32_bf16 a[244:247], a[108:111], a[252:255], a[244:247]
  v_lshlrev_b32 v42, 4, v5
  s_waitcnt vmcnt(26) lgkmcnt(0)
  s_barrier
  v_mfma_f32_16x16x32_bf16 v[88:91], a[36:39], a[4:7], v[88:91]
  ds_read_b128 a[56:59], v19 offset:18432
  s_add_u32 m0, s76, 45056
  v_mfma_f32_16x16x32_bf16 v[92:95], a[36:39], a[8:11], v[92:95]
  ds_read_b128 a[60:63], v19 offset:20480
  buffer_load_dwordx4 v13, s[32:35], s73 offen lds
  v_mfma_f32_16x16x32_bf16 v[96:99], a[36:39], a[12:15], v[96:99]
  ds_read_b128 a[64:67], v19 offset:22528
  s_add_u32 s65, s59, 1
  v_mfma_f32_16x16x32_bf16 v[100:103], a[36:39], a[16:19], v[100:103]
  ds_read_b128 a[68:71], v19 offset:24576
  s_and_b32 s65, s65, 1
  v_mfma_f32_16x16x32_bf16 v[104:107], a[36:39], a[20:23], v[104:107]
  ds_read_b128 a[72:75], v19 offset:26624
  s_add_u32 m0, s76, 49152
  v_mfma_f32_16x16x32_bf16 v[108:111], a[36:39], a[24:27], v[108:111]
  ds_read_b128 a[76:79], v19 offset:28672
  buffer_load_dwordx4 v14, s[36:39], s73 offen lds
  v_mfma_f32_16x16x32_bf16 v[112:115], a[36:39], a[28:31], v[112:115]
  ds_read_b128 a[80:83], v19 offset:30720
  v_mfma_f32_16x16x32_bf16 v[116:119], a[36:39], a[32:35], v[116:119]
  ds_read_b128 a[84:87], v19 offset:32768
  s_lshl_b32 s65, s65, 18
  v_mfma_f32_16x16x32_bf16 a[228:231], a[36:39], a[252:255], a[228:231]
  ds_read_b128 a[88:91], v19 offset:34816
  s_add_u32 s65, s65, 0
  v_mfma_f32_16x16x32_bf16 v[120:123], a[40:43], a[0:3], v[120:123]
  ds_read_b64_tr_b16 a[92:93], v23 offset:20480
  s_add_u32 m0, s76, 53248
  v_mfma_f32_16x16x32_bf16 v[124:127], a[40:43], a[4:7], v[124:127]
  ds_read_b64_tr_b16 a[94:95], v23 offset:20992
  buffer_load_dwordx4 v15, s[40:43], s74 offen lds
  v_mfma_f32_16x16x32_bf16 v[128:131], a[40:43], a[8:11], v[128:131]
  ds_read_b64_tr_b16 a[96:97], v23 offset:24576
  s_add_u32 m0, s76, 57344
  v_mfma_f32_16x16x32_bf16 v[132:135], a[40:43], a[12:15], v[132:135]
  ds_read_b64_tr_b16 a[98:99], v23 offset:25088
  v_mfma_f32_16x16x32_bf16 v[136:139], a[40:43], a[16:19], v[136:139]
  ds_read_b64_tr_b16 a[100:101], v23 offset:28672
  buffer_load_dwordx4 v16, s[44:47], s74 offen lds
  v_mfma_f32_16x16x32_bf16 v[140:143], a[40:43], a[20:23], v[140:143]
  ds_read_b64_tr_b16 a[102:103], v23 offset:29184
  s_add_u32 s73, s73, s75
  v_mfma_f32_16x16x32_bf16 v[144:147], a[40:43], a[24:27], v[144:147]
  ds_read_b64_tr_b16 a[104:105], v23 offset:32768
  s_add_u32 s74, s74, 114688
  v_mfma_f32_16x16x32_bf16 v[148:151], a[40:43], a[28:31], v[148:151]
  ds_read_b64_tr_b16 a[106:107], v23 offset:33280
  buffer_load_dword a222, v2, s[12:15], s65 offen
  v_mfma_f32_16x16x32_bf16 v[152:155], a[40:43], a[32:35], v[152:155]
  ds_read_b64_tr_b16 a[108:109], v23 offset:36864
  v_lshlrev_b32 v26, 4, v1
  v_mfma_f32_16x16x32_bf16 v[156:159], a[0:3], a[44:47], v[156:159]
  ds_read_b64_tr_b16 a[110:111], v23 offset:37376
  v_add_u32 v27, 147456, v26
  v_mfma_f32_16x16x32_bf16 v[160:163], a[4:7], a[44:47], v[160:163]
  v_mfma_f32_16x16x32_bf16 v[164:167], a[8:11], a[44:47], v[164:167]
  s_add_u32 m0, s76, 61440
  v_mfma_f32_16x16x32_bf16 v[168:171], a[12:15], a[44:47], v[168:171]
  buffer_load_dwordx4 v12, s[28:31], s73 offen lds
  v_mfma_f32_16x16x32_bf16 v[172:175], a[16:19], a[44:47], v[172:175]
  v_add_u32 v28, 294912, v26
  v_mfma_f32_16x16x32_bf16 v[176:179], a[20:23], a[44:47], v[176:179]
  v_add_u32 v29, 442368, v26
  v_mfma_f32_16x16x32_bf16 v[180:183], a[24:27], a[44:47], v[180:183]
  s_add_u32 m0, s76, 65536
  v_mfma_f32_16x16x32_bf16 v[184:187], a[28:31], a[44:47], v[184:187]
  v_mfma_f32_16x16x32_bf16 v[188:191], a[32:35], a[44:47], v[188:191]
  buffer_load_dwordx4 v13, s[32:35], s73 offen lds
  v_mfma_f32_16x16x32_bf16 v[192:195], a[48:51], a[4:7], v[192:195]
  s_mul_i32 s83, s69, 576
  v_mfma_f32_16x16x32_bf16 v[196:199], a[48:51], a[8:11], v[196:199]
  s_lshl_b32 s84, s79, 2
  v_mfma_f32_16x16x32_bf16 v[200:203], a[48:51], a[12:15], v[200:203]
  s_add_u32 m0, s76, 69632
  v_mfma_f32_16x16x32_bf16 v[204:207], a[48:51], a[16:19], v[204:207]
  buffer_load_dwordx4 v14, s[36:39], s73 offen lds
  v_mfma_f32_16x16x32_bf16 v[208:211], a[48:51], a[20:23], v[208:211]
  s_add_u32 s84, s84, s68
  v_mfma_f32_16x16x32_bf16 v[212:215], a[48:51], a[24:27], v[212:215]
  v_mfma_f32_16x16x32_bf16 v[216:219], a[48:51], a[28:31], v[216:219]
  s_add_u32 s89, s83, s84
  v_mfma_f32_16x16x32_bf16 v[220:223], a[48:51], a[32:35], v[220:223]
  s_add_u32 m0, s76, 73728
  v_mfma_f32_16x16x32_bf16 a[240:243], a[48:51], a[252:255], a[240:243]
  buffer_load_dwordx4 v15, s[40:43], s74 offen lds
  v_mfma_f32_16x16x32_bf16 v[224:227], a[52:55], a[4:7], v[224:227]
  s_add_u32 m0, s76, 77824
  v_mfma_f32_16x16x32_bf16 v[228:231], a[52:55], a[8:11], v[228:231]
  buffer_load_dwordx4 v16, s[44:47], s74 offen lds
  v_mfma_f32_16x16x32_bf16 v[232:235], a[52:55], a[12:15], v[232:235]
  v_mfma_f32_16x16x32_bf16 v[236:239], a[52:55], a[16:19], v[236:239]
  s_add_u32 s73, s73, s75
  v_mfma_f32_16x16x32_bf16 v[240:243], a[52:55], a[20:23], v[240:243]
  s_add_u32 s74, s74, 114688
  v_mfma_f32_16x16x32_bf16 v[244:247], a[52:55], a[24:27], v[244:247]
  s_add_u32 s88, s89, 32
  v_mfma_f32_16x16x32_bf16 v[248:251], a[52:55], a[28:31], v[248:251]
  s_lshl_b32 s88, s88, 10
  v_mfma_f32_16x16x32_bf16 v[252:255], a[52:55], a[32:35], v[252:255]
  s_lshl_b32 s89, s89, 10
  v_mfma_f32_16x16x32_bf16 a[244:247], a[52:55], a[252:255], a[244:247]
  s_waitcnt vmcnt(24) lgkmcnt(0)
  s_barrier
  v_mfma_f32_16x16x32_bf16 v[88:91], a[92:95], a[60:63], v[88:91]
  ds_read_b128 a[0:3], v18 offset:36864
  s_add_u32 s92, s93, 0
  v_mfma_f32_16x16x32_bf16 v[92:95], a[92:95], a[64:67], v[92:95]
  ds_read_b128 a[4:7], v18 offset:38912
  s_add_u32 m0, s77, 120832
  v_mfma_f32_16x16x32_bf16 v[96:99], a[92:95], a[68:71], v[96:99]
  ds_read_b128 a[8:11], v18 offset:40960
  buffer_load_dwordx4 v8, s[4:7], s92 offen lds
  v_mfma_f32_16x16x32_bf16 v[100:103], a[92:95], a[72:75], v[100:103]
  ds_read_b128 a[12:15], v18 offset:43008
  s_add_u32 s65, s59, 0
  v_mfma_f32_16x16x32_bf16 v[104:107], a[92:95], a[76:79], v[104:107]
  ds_read_b128 a[16:19], v18 offset:45056
  s_and_b32 s65, s65, 1
  v_mfma_f32_16x16x32_bf16 v[108:111], a[92:95], a[80:83], v[108:111]
  ds_read_b128 a[20:23], v18 offset:47104
  s_lshl_b32 s65, s65, 18
  v_mfma_f32_16x16x32_bf16 v[112:115], a[92:95], a[84:87], v[112:115]
  ds_read_b128 a[24:27], v18 offset:49152
  s_add_u32 s65, s65, 0
  v_mfma_f32_16x16x32_bf16 v[116:119], a[92:95], a[88:91], v[116:119]
  ds_read_b128 a[28:31], v18 offset:51200
  s_add_u32 m0, s77, 121856
  v_mfma_f32_16x16x32_bf16 a[228:231], a[92:95], a[252:255], a[228:231]
  ds_read_b128 a[32:35], v18 offset:53248
  buffer_load_dwordx4 v9, s[4:7], s92 offen lds
  v_mfma_f32_16x16x32_bf16 v[120:123], a[96:99], a[56:59], v[120:123]
  ds_read_b64_tr_b16 a[36:37], v22 offset:0
  buffer_load_dword a223, v2, s[8:11], s65 offen
  v_mfma_f32_16x16x32_bf16 v[124:127], a[96:99], a[60:63], v[124:127]
  ds_read_b64_tr_b16 a[38:39], v22 offset:512
  v_lshrrev_b32 v4, 4, v1
  v_mfma_f32_16x16x32_bf16 v[128:131], a[96:99], a[64:67], v[128:131]
  ds_read_b64_tr_b16 a[40:41], v22 offset:4096
  v_and_b32 v6, 15, v1
  v_mfma_f32_16x16x32_bf16 v[132:135], a[96:99], a[68:71], v[132:135]
  ds_read_b64_tr_b16 a[42:43], v22 offset:4608
  v_lshlrev_b32 v4, 2, v4
  v_mfma_f32_16x16x32_bf16 v[136:139], a[96:99], a[72:75], v[136:139]
  ds_read_b64_tr_b16 a[44:45], v22 offset:8192
  v_sub_u32 v4, v6, v4
  v_mfma_f32_16x16x32_bf16 v[140:143], a[96:99], a[76:79], v[140:143]
  ds_read_b64_tr_b16 a[46:47], v22 offset:8704
  s_add_u32 m0, s3, 120832
  v_mfma_f32_16x16x32_bf16 v[144:147], a[96:99], a[80:83], v[144:147]
  ds_read_b64_tr_b16 a[48:49], v22 offset:12288
  buffer_load_dword v10, s[4:7], s93 offen lds
  v_mfma_f32_16x16x32_bf16 v[148:151], a[96:99], a[84:87], v[148:151]
  ds_read_b64_tr_b16 a[50:51], v22 offset:12800
  v_mov_b32 v3, 0xff800000
  v_mfma_f32_16x16x32_bf16 v[152:155], a[96:99], a[88:91], v[152:155]
  ds_read_b64_tr_b16 a[52:53], v22 offset:16384
  v_mov_b32 v6, 0x80000000
  v_mfma_f32_16x16x32_bf16 v[156:159], a[56:59], a[100:103], v[156:159]
  ds_read_b64_tr_b16 a[54:55], v22 offset:16896
  v_subrev_u32 v5, 0, v4
  v_mfma_f32_16x16x32_bf16 v[160:163], a[60:63], a[100:103], v[160:163]
  s_add_u32 s92, s93, 16384
  s_add_u32 m0, s77, 122880
  v_mfma_f32_16x16x32_bf16 v[164:167], a[64:67], a[100:103], v[164:167]
  buffer_load_dwordx4 v8, s[4:7], s92 offen lds
  v_and_b32 v5, 0x80000001, v5
  v_mfma_f32_16x16x32_bf16 v[168:171], a[68:71], a[100:103], v[168:171]
  v_cmp_eq_u32 vcc, 0, v5
  v_cmp_eq_u32 s[94:95], v6, v5
  v_mfma_f32_16x16x32_bf16 v[172:175], a[72:75], a[100:103], v[172:175]
  v_cndmask_b32_e64 v34, v3, 0, vcc
  s_add_u32 m0, s77, 123904
  v_mfma_f32_16x16x32_bf16 v[176:179], a[76:79], a[100:103], v[176:179]
  buffer_load_dwordx4 v9, s[4:7], s92 offen lds
  v_cndmask_b32_e64 v30, v3, 0, s[94:95]
  v_mfma_f32_16x16x32_bf16 v[180:183], a[80:83], a[100:103], v[180:183]
  v_subrev_u32 v5, 1, v4
  v_and_b32 v5, 0x80000001, v5
  v_mfma_f32_16x16x32_bf16 v[184:187], a[84:87], a[100:103], v[184:187]
  s_add_u32 m0, s78, 121088
  s_nop 0
  buffer_load_dword v11, s[4:7], s93 offen lds
  v_mfma_f32_16x16x32_bf16 v[188:191], a[88:91], a[100:103], v[188:191]
  s_add_u32 s93, s93, 128
  s_and_b32 s93, s93, 1023
  v_mfma_f32_16x16x32_bf16 v[192:195], a[104:107], a[60:63], v[192:195]
  v_cmp_eq_u32 vcc, 0, v5
  v_cmp_eq_u32 s[94:95], v6, v5
  v_mfma_f32_16x16x32_bf16 v[196:199], a[104:107], a[64:67], v[196:199]
  v_cndmask_b32_e64 v35, v3, 0, vcc
  v_cndmask_b32_e64 v31, v3, 0, s[94:95]
  v_mfma_f32_16x16x32_bf16 v[200:203], a[104:107], a[68:71], v[200:203]
  s_add_u32 m0, s76, 81920
  s_nop 0
  buffer_load_dwordx4 v12, s[28:31], s73 offen lds
  v_mfma_f32_16x16x32_bf16 v[204:207], a[104:107], a[72:75], v[204:207]
  v_subrev_u32 v5, 2, v4
  v_and_b32 v5, 0x80000001, v5
  v_mfma_f32_16x16x32_bf16 v[208:211], a[104:107], a[76:79], v[208:211]
  v_cmp_eq_u32 vcc, 0, v5
  v_cmp_eq_u32 s[94:95], v6, v5
  v_mfma_f32_16x16x32_bf16 v[212:215], a[104:107], a[80:83], v[212:215]
  v_cndmask_b32_e64 v36, v3, 0, vcc
  s_add_u32 m0, s76, 86016
  v_mfma_f32_16x16x32_bf16 v[216:219], a[104:107], a[84:87], v[216:219]
  buffer_load_dwordx4 v13, s[32:35], s73 offen lds
  v_cndmask_b32_e64 v32, v3, 0, s[94:95]
  v_mfma_f32_16x16x32_bf16 v[220:223], a[104:107], a[88:91], v[220:223]
  v_subrev_u32 v5, 3, v4
  v_and_b32 v5, 0x80000001, v5
  v_mfma_f32_16x16x32_bf16 a[240:243], a[104:107], a[252:255], a[240:243]
  v_cmp_eq_u32 vcc, 0, v5
  v_mfma_f32_16x16x32_bf16 v[224:227], a[108:111], a[60:63], v[224:227]
  s_add_u32 m0, s76, 90112
  s_nop 0
  buffer_load_dwordx4 v14, s[36:39], s73 offen lds
  v_mfma_f32_16x16x32_bf16 v[228:231], a[108:111], a[64:67], v[228:231]
  v_cmp_eq_u32 s[94:95], v6, v5
  v_mfma_f32_16x16x32_bf16 v[232:235], a[108:111], a[68:71], v[232:235]
  v_cndmask_b32_e64 v37, v3, 0, vcc
  v_cndmask_b32_e64 v33, v3, 0, s[94:95]
  v_mfma_f32_16x16x32_bf16 v[236:239], a[108:111], a[72:75], v[236:239]
  s_cmp_eq_u32 s69, 0
  s_cselect_b64 vcc, -1, 0
  v_mfma_f32_16x16x32_bf16 v[240:243], a[108:111], a[76:79], v[240:243]
  s_add_u32 m0, s76, 94208
  v_mfma_f32_16x16x32_bf16 v[244:247], a[108:111], a[80:83], v[244:247]
  buffer_load_dwordx4 v15, s[40:43], s74 offen lds
  v_mfma_f32_16x16x32_bf16 v[248:251], a[108:111], a[84:87], v[248:251]
  v_cndmask_b32 v38, v30, v3, vcc
  v_cndmask_b32 v39, v31, v3, vcc
  v_mfma_f32_16x16x32_bf16 v[252:255], a[108:111], a[88:91], v[252:255]
  v_cndmask_b32 v40, v32, v3, vcc
  v_mfma_f32_16x16x32_bf16 a[244:247], a[108:111], a[252:255], a[244:247]
  v_cndmask_b32 v41, v33, v3, vcc
  s_waitcnt vmcnt(28) lgkmcnt(0)
  s_barrier
  v_mfma_f32_16x16x32_bf16 v[88:91], a[36:39], a[4:7], v[88:91]
  ds_read_b128 a[56:59], v19 offset:36864
  s_add_u32 m0, s76, 98304
  v_mfma_f32_16x16x32_bf16 v[92:95], a[36:39], a[8:11], v[92:95]
  ds_read_b128 a[60:63], v19 offset:38912
  buffer_load_dwordx4 v16, s[44:47], s74 offen lds
  v_mfma_f32_16x16x32_bf16 v[96:99], a[36:39], a[12:15], v[96:99]
  ds_read_b128 a[64:67], v19 offset:40960
  s_add_u32 s73, s73, s75
  v_mfma_f32_16x16x32_bf16 v[100:103], a[36:39], a[16:19], v[100:103]
  ds_read_b128 a[68:71], v19 offset:43008
  s_add_u32 s74, s74, 114688
  v_mfma_f32_16x16x32_bf16 v[104:107], a[36:39], a[20:23], v[104:107]
  ds_read_b128 a[72:75], v19 offset:45056
  s_mov_b32 s83, 9437184
  v_mfma_f32_16x16x32_bf16 v[108:111], a[36:39], a[24:27], v[108:111]
  ds_read_b128 a[76:79], v19 offset:47104
  buffer_load_dwordx4 v[76:79], v58, s[20:23], s83 offen sc1
  v_mfma_f32_16x16x32_bf16 v[112:115], a[36:39], a[28:31], v[112:115]
  ds_read_b128 a[80:83], v19 offset:49152
  buffer_load_dwordx4 v[80:83], v59, s[20:23], s83 offen sc1
  v_mfma_f32_16x16x32_bf16 v[116:119], a[36:39], a[32:35], v[116:119]
  ds_read_b128 a[84:87], v19 offset:51200
  buffer_load_dwordx4 v[84:87], v42, s[20:23], s83 offen sc1
  v_mfma_f32_16x16x32_bf16 a[228:231], a[36:39], a[252:255], a[228:231]
  ds_read_b128 a[88:91], v19 offset:53248
  s_add_u32 s65, s59, 1
  v_mfma_f32_16x16x32_bf16 v[120:123], a[40:43], a[0:3], v[120:123]
  ds_read_b64_tr_b16 a[92:93], v22 offset:20480
  s_add_u32 m0, s76, 0
  v_mfma_f32_16x16x32_bf16 v[124:127], a[40:43], a[4:7], v[124:127]
  ds_read_b64_tr_b16 a[94:95], v22 offset:20992
  buffer_load_dwordx4 v12, s[28:31], s73 offen lds
  v_mfma_f32_16x16x32_bf16 v[128:131], a[40:43], a[8:11], v[128:131]
  ds_read_b64_tr_b16 a[96:97], v22 offset:24576
  s_and_b32 s65, s65, 1
  v_mfma_f32_16x16x32_bf16 v[132:135], a[40:43], a[12:15], v[132:135]
  ds_read_b64_tr_b16 a[98:99], v22 offset:25088
  s_lshl_b32 s65, s65, 18
  v_mfma_f32_16x16x32_bf16 v[136:139], a[40:43], a[16:19], v[136:139]
  ds_read_b64_tr_b16 a[100:101], v22 offset:28672
  s_add_u32 s65, s65, 0
  v_mfma_f32_16x16x32_bf16 v[140:143], a[40:43], a[20:23], v[140:143]
  ds_read_b64_tr_b16 a[102:103], v22 offset:29184
  buffer_load_dword a224, v2, s[8:11], s65 offen
  v_mfma_f32_16x16x32_bf16 v[144:147], a[40:43], a[24:27], v[144:147]
  ds_read_b64_tr_b16 a[104:105], v22 offset:32768
  v_and_b32 v4, 15, v1
  v_mfma_f32_16x16x32_bf16 v[148:151], a[40:43], a[28:31], v[148:151]
  ds_read_b64_tr_b16 a[106:107], v22 offset:33280
  s_add_u32 m0, s76, 4096
  v_mfma_f32_16x16x32_bf16 v[152:155], a[40:43], a[32:35], v[152:155]
  ds_read_b64_tr_b16 a[108:109], v22 offset:36864
  buffer_load_dwordx4 v13, s[32:35], s73 offen lds
  v_mfma_f32_16x16x32_bf16 v[156:159], a[0:3], a[44:47], v[156:159]
  ds_read_b64_tr_b16 a[110:111], v22 offset:37376
  v_lshrrev_b32 v5, 4, v1
  v_mfma_f32_16x16x32_bf16 v[160:163], a[4:7], a[44:47], v[160:163]
  v_lshlrev_b32 v5, 2, v5
  v_mfma_f32_16x16x32_bf16 v[164:167], a[8:11], a[44:47], v[164:167]
  v_sub_u32 v4, v4, v5
  v_mfma_f32_16x16x32_bf16 v[168:171], a[12:15], a[44:47], v[168:171]
  v_and_b32 v5, 1, v1
  v_mfma_f32_16x16x32_bf16 v[172:175], a[16:19], a[44:47], v[172:175]
  v_sub_u32 v4, v4, v5
  v_mfma_f32_16x16x32_bf16 v[176:179], a[20:23], a[44:47], v[176:179]
  v_lshlrev_b32 v5, 4, v5
  v_mfma_f32_16x16x32_bf16 v[180:183], a[24:27], a[44:47], v[180:183]
  s_add_u32 m0, s76, 8192
  v_mfma_f32_16x16x32_bf16 v[184:187], a[28:31], a[44:47], v[184:187]
  buffer_load_dwordx4 v14, s[36:39], s73 offen lds
  v_mfma_f32_16x16x32_bf16 v[188:191], a[32:35], a[44:47], v[188:191]
  v_mov_b32 v6, 0x0c0c0c0c
  v_mfma_f32_16x16x32_bf16 v[192:195], a[48:51], a[4:7], v[192:195]
  v_mov_b32 v54, 0xc0c0100
  v_mfma_f32_16x16x32_bf16 v[196:199], a[48:51], a[8:11], v[196:199]
  v_alignbit_b32 v56, v54, v54, v5
  v_mfma_f32_16x16x32_bf16 v[200:203], a[48:51], a[12:15], v[200:203]
  v_cmp_le_i32 vcc, 0, v4
  v_mfma_f32_16x16x32_bf16 v[204:207], a[48:51], a[16:19], v[204:207]
  v_nop
  v_mfma_f32_16x16x32_bf16 v[208:211], a[48:51], a[20:23], v[208:211]
  s_add_u32 m0, s76, 12288
  v_mfma_f32_16x16x32_bf16 v[212:215], a[48:51], a[24:27], v[212:215]
  buffer_load_dwordx4 v15, s[40:43], s74 offen lds
  v_mfma_f32_16x16x32_bf16 v[216:219], a[48:51], a[28:31], v[216:219]
  v_cndmask_b32 v54, v56, v6, vcc
  v_mfma_f32_16x16x32_bf16 v[220:223], a[48:51], a[32:35], v[220:223]
  v_cndmask_b32 v56, v6, v56, vcc
  v_mfma_f32_16x16x32_bf16 a[240:243], a[48:51], a[252:255], a[240:243]
  v_mov_b32 v55, 0xc0c0302
  v_mfma_f32_16x16x32_bf16 v[224:227], a[52:55], a[4:7], v[224:227]
  v_alignbit_b32 v57, v55, v55, v5
  v_mfma_f32_16x16x32_bf16 v[228:231], a[52:55], a[8:11], v[228:231]
  s_add_u32 m0, s76, 16384
  v_mfma_f32_16x16x32_bf16 v[232:235], a[52:55], a[12:15], v[232:235]
  buffer_load_dwordx4 v16, s[44:47], s74 offen lds
  v_mfma_f32_16x16x32_bf16 v[236:239], a[52:55], a[16:19], v[236:239]
  s_add_u32 s73, s73, s75
  v_mfma_f32_16x16x32_bf16 v[240:243], a[52:55], a[20:23], v[240:243]
  s_add_u32 s74, s74, 114688
  v_mfma_f32_16x16x32_bf16 v[244:247], a[52:55], a[24:27], v[244:247]
  v_cmp_le_i32 vcc, 2, v4
  v_mfma_f32_16x16x32_bf16 v[248:251], a[52:55], a[28:31], v[248:251]
  v_nop
  v_mfma_f32_16x16x32_bf16 v[252:255], a[52:55], a[32:35], v[252:255]
  v_cndmask_b32 v55, v57, v6, vcc
  v_mfma_f32_16x16x32_bf16 a[244:247], a[52:55], a[252:255], a[244:247]
  v_cndmask_b32 v57, v6, v57, vcc
  s_waitcnt vmcnt(27) lgkmcnt(0)
  s_barrier
  v_mfma_f32_16x16x32_bf16 v[88:91], a[92:95], a[60:63], v[88:91]
  ds_read_b128 a[0:3], v18 offset:0
  s_add_u32 s82, s56, 0
  v_mfma_f32_16x16x32_bf16 v[92:95], a[92:95], a[64:67], v[92:95]
  ds_read_b128 a[4:7], v18 offset:2048
  s_add_u32 m0, s85, 24576
  v_mfma_f32_16x16x32_bf16 v[96:99], a[92:95], a[68:71], v[96:99]
  ds_read_b128 a[8:11], v18 offset:4096
  buffer_load_dwordx4 v17, s[12:15], s82 offen lds
  v_mfma_f32_16x16x32_bf16 v[100:103], a[92:95], a[72:75], v[100:103]
  ds_read_b128 a[12:15], v18 offset:6144
  s_and_b32 s83, s68, 1
  v_mfma_f32_16x16x32_bf16 v[104:107], a[92:95], a[76:79], v[104:107]
  ds_read_b128 a[16:19], v18 offset:8192
  s_lshl_b32 s83, s83, 6
  v_mfma_f32_16x16x32_bf16 v[108:111], a[92:95], a[80:83], v[108:111]
  ds_read_b128 a[20:23], v18 offset:10240
  s_add_u32 s82, s56, 8192
  v_mfma_f32_16x16x32_bf16 v[112:115], a[92:95], a[84:87], v[112:115]
  ds_read_b128 a[24:27], v18 offset:12288
  s_add_u32 m0, s85, 25600
  v_mfma_f32_16x16x32_bf16 v[116:119], a[92:95], a[88:91], v[116:119]
  ds_read_b128 a[28:31], v18 offset:14336
  buffer_load_dwordx4 v17, s[12:15], s82 offen lds
  v_mfma_f32_16x16x32_bf16 a[228:231], a[92:95], a[252:255], a[228:231]
  ds_read_b128 a[32:35], v18 offset:16384
  v_lshrrev_b32 v4, 5, v1
  v_mfma_f32_16x16x32_bf16 v[120:123], a[96:99], a[56:59], v[120:123]
  ds_read_b64_tr_b16 a[36:37], v22 offset:40960
  v_lshlrev_b32 v4, 10, v4
  v_mfma_f32_16x16x32_bf16 v[124:127], a[96:99], a[60:63], v[124:127]
  ds_read_b64_tr_b16 a[38:39], v22 offset:41472
  v_bfe_u32 v6, v1, 2, 2
  v_mfma_f32_16x16x32_bf16 v[128:131], a[96:99], a[64:67], v[128:131]
  ds_read_b64_tr_b16 a[40:41], v22 offset:45056
  s_add_u32 s82, s56, 32768
  v_mfma_f32_16x16x32_bf16 v[132:135], a[96:99], a[68:71], v[132:135]
  ds_read_b64_tr_b16 a[42:43], v22 offset:45568
  s_add_u32 m0, s85, 32768
  v_mfma_f32_16x16x32_bf16 v[136:139], a[96:99], a[72:75], v[136:139]
  ds_read_b64_tr_b16 a[44:45], v22 offset:49152
  buffer_load_dwordx4 v17, s[12:15], s82 offen lds
  v_mfma_f32_16x16x32_bf16 v[140:143], a[96:99], a[76:79], v[140:143]
  ds_read_b64_tr_b16 a[46:47], v22 offset:49664
  v_lshl_add_u32 v4, v6, 7, v4
  v_mfma_f32_16x16x32_bf16 v[144:147], a[96:99], a[80:83], v[144:147]
  ds_read_b64_tr_b16 a[48:49], v22 offset:53248
  v_lshrrev_b32 v6, 1, v6
  v_mfma_f32_16x16x32_bf16 v[148:151], a[96:99], a[84:87], v[148:151]
  ds_read_b64_tr_b16 a[50:51], v22 offset:53760
  v_lshl_add_u32 v4, v6, 6, v4
  v_mfma_f32_16x16x32_bf16 v[152:155], a[96:99], a[88:91], v[152:155]
  ds_read_b64_tr_b16 a[52:53], v22 offset:57344
  s_add_u32 s82, s56, 40960
  v_mfma_f32_16x16x32_bf16 v[156:159], a[56:59], a[100:103], v[156:159]
  ds_read_b64_tr_b16 a[54:55], v22 offset:57856
  s_add_u32 m0, s85, 33792
  v_mfma_f32_16x16x32_bf16 v[160:163], a[60:63], a[100:103], v[160:163]
  buffer_load_dwordx4 v17, s[12:15], s82 offen lds
  v_bfe_u32 v6, v1, 4, 1
  v_mfma_f32_16x16x32_bf16 v[164:167], a[64:67], a[100:103], v[164:167]
  v_lshl_add_u32 v4, v6, 5, v4
  v_mfma_f32_16x16x32_bf16 v[168:171], a[68:71], a[100:103], v[168:171]
  s_add_u32 s82, s56, 65536
  v_mfma_f32_16x16x32_bf16 v[172:175], a[72:75], a[100:103], v[172:175]
  s_add_u32 m0, s85, 139264
  v_mfma_f32_16x16x32_bf16 v[176:179], a[76:79], a[100:103], v[176:179]
  buffer_load_dwordx4 v17, s[12:15], s82 offen lds
  v_mfma_f32_16x16x32_bf16 v[180:183], a[80:83], a[100:103], v[180:183]
  v_and_b32 v6, 1, v1
  v_mfma_f32_16x16x32_bf16 v[184:187], a[84:87], a[100:103], v[184:187]
  v_lshl_add_u32 v4, v6, 4, v4
  v_mfma_f32_16x16x32_bf16 v[188:191], a[88:91], a[100:103], v[188:191]
  v_bfe_u32 v6, v1, 1, 1
  v_mfma_f32_16x16x32_bf16 v[192:195], a[104:107], a[60:63], v[192:195]
  s_add_u32 s82, s56, 73728
  v_mfma_f32_16x16x32_bf16 v[196:199], a[104:107], a[64:67], v[196:199]
  s_add_u32 m0, s85, 140288
  v_mfma_f32_16x16x32_bf16 v[200:203], a[104:107], a[68:71], v[200:203]
  buffer_load_dwordx4 v17, s[12:15], s82 offen lds
  v_mfma_f32_16x16x32_bf16 v[204:207], a[104:107], a[72:75], v[204:207]
  v_lshl_add_u32 v4, v6, 3, v4
  v_mfma_f32_16x16x32_bf16 v[208:211], a[104:107], a[76:79], v[208:211]
  v_xor_b32 v4, s83, v4
  v_mfma_f32_16x16x32_bf16 v[212:215], a[104:107], a[80:83], v[212:215]
  s_lshl_b32 s83, s83, 5
  v_mfma_f32_16x16x32_bf16 v[216:219], a[104:107], a[84:87], v[216:219]
  s_add_u32 s82, s56, 98304
  v_mfma_f32_16x16x32_bf16 v[220:223], a[104:107], a[88:91], v[220:223]
  s_add_u32 m0, s85, 147456
  v_mfma_f32_16x16x32_bf16 a[240:243], a[104:107], a[252:255], a[240:243]
  buffer_load_dwordx4 v17, s[12:15], s82 offen lds
  v_mfma_f32_16x16x32_bf16 v[224:227], a[108:111], a[60:63], v[224:227]
  v_add_u32 v2, s83, v4
  v_mfma_f32_16x16x32_bf16 v[228:231], a[108:111], a[64:67], v[228:231]
  v_xor_b32 v3, 64, v2
  v_mfma_f32_16x16x32_bf16 v[232:235], a[108:111], a[68:71], v[232:235]
  v_add_u32 v4, 65536, v2
  v_mfma_f32_16x16x32_bf16 v[236:239], a[108:111], a[72:75], v[236:239]
  s_add_u32 s82, s56, 106496
  v_mfma_f32_16x16x32_bf16 v[240:243], a[108:111], a[76:79], v[240:243]
  s_add_u32 m0, s85, 148480
  v_mfma_f32_16x16x32_bf16 v[244:247], a[108:111], a[80:83], v[244:247]
  buffer_load_dwordx4 v17, s[12:15], s82 offen lds
  v_mfma_f32_16x16x32_bf16 v[248:251], a[108:111], a[84:87], v[248:251]
  v_add_u32 v5, 65536, v3
  v_mfma_f32_16x16x32_bf16 v[252:255], a[108:111], a[88:91], v[252:255]
  v_add_u32 v6, 131072, v2
  v_mfma_f32_16x16x32_bf16 a[244:247], a[108:111], a[252:255], a[244:247]
  v_add_u32 v49, 131072, v3
  s_waitcnt vmcnt(14) lgkmcnt(0)
  s_barrier
  v_mfma_f32_16x16x32_bf16 v[88:91], a[36:39], a[4:7], v[88:91]
  ds_read_b128 a[56:59], v19 offset:0
  v_cmp_ne_u64 vcc, s[86:87], v[78:79]
  v_cmp_ne_u64 s[94:95], s[86:87], v[82:83]
  v_cmp_ne_u64 s[92:93], s[86:87], v[86:87]
  s_or_b64 vcc, vcc, s[94:95]
  s_or_b64 vcc, vcc, s[92:93]
  s_cbranch_vccnz L_slow_gat00
L_back_gat00:
  v_mfma_f32_16x16x32_bf16 v[92:95], a[36:39], a[8:11], v[92:95]
  ds_read_b128 a[60:63], v19 offset:2048
  s_mul_i32 s83, s68, 1152
  v_mfma_f32_16x16x32_bf16 v[96:99], a[36:39], a[12:15], v[96:99]
  ds_read_b128 a[64:67], v19 offset:4096
  s_add_u32 s83, s83, 157696
  v_mfma_f32_16x16x32_bf16 v[100:103], a[36:39], a[16:19], v[100:103]
  ds_read_b128 a[68:71], v19 offset:6144
  v_lshl_add_u32 v44, v1, 2, s83
  v_mfma_f32_16x16x32_bf16 v[104:107], a[36:39], a[20:23], v[104:107]
  ds_read_b128 a[72:75], v19 offset:8192
  v_and_b32 v45, 15, v1
  v_mfma_f32_16x16x32_bf16 v[108:111], a[36:39], a[24:27], v[108:111]
  ds_read_b128 a[76:79], v19 offset:10240
  v_lshl_add_u32 v45, v45, 2, s83
  v_mfma_f32_16x16x32_bf16 v[112:115], a[36:39], a[28:31], v[112:115]
  ds_read_b128 a[80:83], v19 offset:12288
  v_add_u32 v46, 512, v45
  v_mfma_f32_16x16x32_bf16 v[116:119], a[36:39], a[32:35], v[116:119]
  ds_read_b128 a[84:87], v19 offset:14336
  v_add_u32 v47, 256, v45
  v_mfma_f32_16x16x32_bf16 a[228:231], a[36:39], a[252:255], a[228:231]
  ds_read_b128 a[88:91], v19 offset:16384
  v_lshrrev_b32 v43, 4, v1
  v_mfma_f32_16x16x32_bf16 v[120:123], a[40:43], a[0:3], v[120:123]
  ds_read_b64_tr_b16 a[92:93], v23 offset:0
  v_lshl_add_u32 v43, v43, 4, s83
  v_mfma_f32_16x16x32_bf16 v[124:127], a[40:43], a[4:7], v[124:127]
  ds_read_b64_tr_b16 a[94:95], v23 offset:512
  v_mfma_f32_16x16x32_bf16 v[128:131], a[40:43], a[8:11], v[128:131]
  ds_read_b64_tr_b16 a[96:97], v23 offset:4096
  v_mfma_f32_16x16x32_bf16 v[132:135], a[40:43], a[12:15], v[132:135]
  ds_read_b64_tr_b16 a[98:99], v23 offset:4608
  v_mfma_f32_16x16x32_bf16 v[136:139], a[40:43], a[16:19], v[136:139]
  ds_read_b64_tr_b16 a[100:101], v23 offset:8192
  v_mfma_f32_16x16x32_bf16 v[140:143], a[40:43], a[20:23], v[140:143]
  ds_read_b64_tr_b16 a[102:103], v23 offset:8704
  v_mfma_f32_16x16x32_bf16 v[144:147], a[40:43], a[24:27], v[144:147]
  ds_read_b64_tr_b16 a[104:105], v23 offset:12288
  v_mfma_f32_16x16x32_bf16 v[148:151], a[40:43], a[28:31], v[148:151]
  ds_read_b64_tr_b16 a[106:107], v23 offset:12800
  v_mfma_f32_16x16x32_bf16 v[152:155], a[40:43], a[32:35], v[152:155]
  ds_read_b64_tr_b16 a[108:109], v23 offset:16384
  v_mfma_f32_16x16x32_bf16 v[156:159], a[0:3], a[44:47], v[156:159]
  ds_read_b64_tr_b16 a[110:111], v23 offset:16896
  v_mfma_f32_16x16x32_bf16 v[160:163], a[4:7], a[44:47], v[160:163]
  ds_write2_b32 v44, v76, v77 offset0:0 offset1:144
  v_mfma_f32_16x16x32_bf16 v[164:167], a[8:11], a[44:47], v[164:167]
  ds_write2_b32 v44, v80, v81 offset0:64 offset1:208
  v_mfma_f32_16x16x32_bf16 v[168:171], a[12:15], a[44:47], v[168:171]
  ds_write2_b32 v46, v84, v85 offset0:0 offset1:144
  v_mfma_f32_16x16x32_bf16 v[172:175], a[16:19], a[44:47], v[172:175]
  ds_read2_b32 v[60:61], v45 offset0:0 offset1:144
  v_mfma_f32_16x16x32_bf16 v[176:179], a[20:23], a[44:47], v[176:179]
  ds_read2_b32 v[62:63], v45 offset0:16 offset1:160
  v_mfma_f32_16x16x32_bf16 v[180:183], a[24:27], a[44:47], v[180:183]
  ds_read2_b32 v[64:65], v45 offset0:32 offset1:176
  v_mfma_f32_16x16x32_bf16 v[184:187], a[28:31], a[44:47], v[184:187]
  ds_read2_b32 v[66:67], v45 offset0:48 offset1:192
  s_add_u32 s82, s56, 131072
  v_mfma_f32_16x16x32_bf16 v[188:191], a[32:35], a[44:47], v[188:191]
  ds_read2_b32 v[68:69], v47 offset0:0 offset1:144
  s_add_u32 m0, s85, 40960
  v_mfma_f32_16x16x32_bf16 v[192:195], a[48:51], a[4:7], v[192:195]
  ds_read2_b32 v[70:71], v47 offset0:16 offset1:160
  v_mfma_f32_16x16x32_bf16 v[196:199], a[48:51], a[8:11], v[196:199]
  ds_read2_b32 v[72:73], v47 offset0:32 offset1:176
  buffer_load_dwordx4 v17, s[12:15], s82 offen lds
  v_mfma_f32_16x16x32_bf16 v[200:203], a[48:51], a[12:15], v[200:203]
  ds_read2_b32 v[74:75], v47 offset0:48 offset1:192
  v_mfma_f32_16x16x32_bf16 v[204:207], a[48:51], a[16:19], v[204:207]
  ds_read2_b32 v[76:77], v47 offset0:64 offset1:208
  s_add_u32 s82, s56, 139264
  v_mfma_f32_16x16x32_bf16 v[208:211], a[48:51], a[20:23], v[208:211]
  s_add_u32 m0, s85, 41984
  v_mfma_f32_16x16x32_bf16 v[212:215], a[48:51], a[24:27], v[212:215]
  v_mfma_f32_16x16x32_bf16 v[216:219], a[48:51], a[28:31], v[216:219]
  buffer_load_dwordx4 v17, s[12:15], s82 offen lds
  v_mfma_f32_16x16x32_bf16 v[220:223], a[48:51], a[32:35], v[220:223]
  v_mfma_f32_16x16x32_bf16 a[240:243], a[48:51], a[252:255], a[240:243]
  s_add_u32 s82, s56, 163840
  v_mfma_f32_16x16x32_bf16 v[224:227], a[52:55], a[4:7], v[224:227]
  s_add_u32 m0, s85, 49152
  v_mfma_f32_16x16x32_bf16 v[228:231], a[52:55], a[8:11], v[228:231]
  v_mfma_f32_16x16x32_bf16 v[232:235], a[52:55], a[12:15], v[232:235]
  buffer_load_dwordx4 v17, s[12:15], s82 offen lds
  v_mfma_f32_16x16x32_bf16 v[236:239], a[52:55], a[16:19], v[236:239]
  v_mfma_f32_16x16x32_bf16 v[240:243], a[52:55], a[20:23], v[240:243]
  s_add_u32 s82, s56, 172032
  v_mfma_f32_16x16x32_bf16 v[244:247], a[52:55], a[24:27], v[244:247]
  s_add_u32 m0, s85, 50176
  v_mfma_f32_16x16x32_bf16 v[248:251], a[52:55], a[28:31], v[248:251]
  v_mfma_f32_16x16x32_bf16 v[252:255], a[52:55], a[32:35], v[252:255]
  buffer_load_dwordx4 v17, s[12:15], s82 offen lds
  v_mfma_f32_16x16x32_bf16 a[244:247], a[52:55], a[252:255], a[244:247]
  s_waitcnt vmcnt(4) lgkmcnt(0)
  s_barrier
  v_mfma_f32_16x16x32_bf16 v[88:91], a[92:95], a[60:63], v[88:91]
  ds_read_b128 a[0:3], v18 offset:18432
  s_add_u32 s82, s56, 196608
  v_mfma_f32_16x16x32_bf16 v[92:95], a[92:95], a[64:67], v[92:95]
  ds_read_b128 a[4:7], v18 offset:20480
  s_add_u32 m0, s85, 57344
  v_mfma_f32_16x16x32_bf16 v[96:99], a[92:95], a[68:71], v[96:99]
  ds_read_b128 a[8:11], v18 offset:22528
  v_mfma_f32_16x16x32_bf16 v[100:103], a[92:95], a[72:75], v[100:103]
  ds_read_b128 a[12:15], v18 offset:24576
  buffer_load_dwordx4 v17, s[12:15], s82 offen lds
  v_mfma_f32_16x16x32_bf16 v[104:107], a[92:95], a[76:79], v[104:107]
  ds_read_b128 a[16:19], v18 offset:26624
  v_mfma_f32_16x16x32_bf16 v[108:111], a[92:95], a[80:83], v[108:111]
  ds_read_b128 a[20:23], v18 offset:28672
  s_add_u32 s82, s56, 204800
  v_mfma_f32_16x16x32_bf16 v[112:115], a[92:95], a[84:87], v[112:115]
  ds_read_b128 a[24:27], v18 offset:30720
  v_mfma_f32_16x16x32_bf16 v[116:119], a[92:95], a[88:91], v[116:119]
  ds_read_b128 a[28:31], v18 offset:32768
  s_add_u32 m0, s85, 58368
  v_mfma_f32_16x16x32_bf16 a[228:231], a[92:95], a[252:255], a[228:231]
  ds_read_b128 a[32:35], v18 offset:34816
  v_mfma_f32_16x16x32_bf16 v[120:123], a[96:99], a[56:59], v[120:123]
  ds_read_b64_tr_b16 a[36:37], v23 offset:20480
  buffer_load_dwordx4 v17, s[12:15], s82 offen lds
  v_mfma_f32_16x16x32_bf16 v[124:127], a[96:99], a[60:63], v[124:127]
  ds_read_b64_tr_b16 a[38:39], v23 offset:20992
  v_mfma_f32_16x16x32_bf16 v[128:131], a[96:99], a[64:67], v[128:131]
  ds_read_b64_tr_b16 a[40:41], v23 offset:24576
  s_add_u32 s82, s56, 229376
  v_mfma_f32_16x16x32_bf16 v[132:135], a[96:99], a[68:71], v[132:135]
  ds_read_b64_tr_b16 a[42:43], v23 offset:25088
  v_mfma_f32_16x16x32_bf16 v[136:139], a[96:99], a[72:75], v[136:139]
  ds_read_b64_tr_b16 a[44:45], v23 offset:28672
  s_add_u32 m0, s85, 65536
  v_mfma_f32_16x16x32_bf16 v[140:143], a[96:99], a[76:79], v[140:143]
  ds_read_b64_tr_b16 a[46:47], v23 offset:29184
  v_mfma_f32_16x16x32_bf16 v[144:147], a[96:99], a[80:83], v[144:147]
  ds_read_b64_tr_b16 a[48:49], v23 offset:32768
  buffer_load_dwordx4 v17, s[12:15], s82 offen lds
  v_mfma_f32_16x16x32_bf16 v[148:151], a[96:99], a[84:87], v[148:151]
  ds_read_b64_tr_b16 a[50:51], v23 offset:33280
  s_add_u32 s82, s56, 237568
  v_mfma_f32_16x16x32_bf16 v[152:155], a[96:99], a[88:91], v[152:155]
  ds_read_b64_tr_b16 a[52:53], v23 offset:36864
  v_mfma_f32_16x16x32_bf16 v[156:159], a[56:59], a[100:103], v[156:159]
  ds_read_b64_tr_b16 a[54:55], v23 offset:37376
  s_add_u32 m0, s85, 66560
  v_mfma_f32_16x16x32_bf16 v[160:163], a[60:63], a[100:103], v[160:163]
  ds_read_b64_tr_b16 a[112:113], v2 offset:24576
  v_mfma_f32_16x16x32_bf16 v[164:167], a[64:67], a[100:103], v[164:167]
  ds_read_b64_tr_b16 a[114:115], v2 offset:25088
  buffer_load_dwordx4 v17, s[12:15], s82 offen lds
  v_mfma_f32_16x16x32_bf16 v[168:171], a[68:71], a[100:103], v[168:171]
  ds_read_b64_tr_b16 a[116:117], v3 offset:24576
  v_mfma_f32_16x16x32_bf16 v[172:175], a[72:75], a[100:103], v[172:175]
  ds_read_b64_tr_b16 a[118:119], v3 offset:25088
  s_add_u32 s82, s56, 262144
  v_mfma_f32_16x16x32_bf16 v[176:179], a[76:79], a[100:103], v[176:179]
  ds_read_b64_tr_b16 a[120:121], v2 offset:28672
  v_mfma_f32_16x16x32_bf16 v[180:183], a[80:83], a[100:103], v[180:183]
  ds_read_b64_tr_b16 a[122:123], v2 offset:29184
  s_add_u32 m0, s85, 73728
  v_mfma_f32_16x16x32_bf16 v[184:187], a[84:87], a[100:103], v[184:187]
  ds_read_b64_tr_b16 a[124:125], v3 offset:28672
  v_mfma_f32_16x16x32_bf16 v[188:191], a[88:91], a[100:103], v[188:191]
  ds_read_b64_tr_b16 a[126:127], v3 offset:29184
  buffer_load_dwordx4 v17, s[12:15], s82 offen lds
  v_mfma_f32_16x16x32_bf16 v[192:195], a[104:107], a[60:63], v[192:195]
  ds_read_b64_tr_b16 a[128:129], v2 offset:32768
  v_mfma_f32_16x16x32_bf16 v[196:199], a[104:107], a[64:67], v[196:199]
  ds_read_b64_tr_b16 a[130:131], v2 offset:33280
  s_add_u32 s82, s56, 270336
  v_mfma_f32_16x16x32_bf16 v[200:203], a[104:107], a[68:71], v[200:203]
  ds_read_b64_tr_b16 a[132:133], v3 offset:32768
  v_mfma_f32_16x16x32_bf16 v[204:207], a[104:107], a[72:75], v[204:207]
  ds_read_b64_tr_b16 a[134:135], v3 offset:33280
  s_add_u32 m0, s85, 74752
  v_mfma_f32_16x16x32_bf16 v[208:211], a[104:107], a[76:79], v[208:211]
  ds_read_b64_tr_b16 a[136:137], v2 offset:36864
  buffer_load_dwordx4 v17, s[12:15], s82 offen lds
  v_mfma_f32_16x16x32_bf16 v[212:215], a[104:107], a[80:83], v[212:215]
  ds_read_b64_tr_b16 a[138:139], v2 offset:37376
  v_mfma_f32_16x16x32_bf16 v[216:219], a[104:107], a[84:87], v[216:219]
  ds_read_b64_tr_b16 a[140:141], v3 offset:36864
  s_add_u32 s82, s56, 294912
  v_mfma_f32_16x16x32_bf16 v[220:223], a[104:107], a[88:91], v[220:223]
  ds_read_b64_tr_b16 a[142:143], v3 offset:37376
  v_mfma_f32_16x16x32_bf16 a[240:243], a[104:107], a[252:255], a[240:243]
  ds_read_b64_tr_b16 a[144:145], v6 offset:8192
  s_add_u32 m0, s85, 106496
  v_mfma_f32_16x16x32_bf16 v[224:227], a[108:111], a[60:63], v[224:227]
  ds_read_b64_tr_b16 a[146:147], v6 offset:8704
  v_mfma_f32_16x16x32_bf16 v[228:231], a[108:111], a[64:67], v[228:231]
  ds_read_b64_tr_b16 a[148:149], v49 offset:8192
  buffer_load_dwordx4 v17, s[12:15], s82 offen lds
  v_mfma_f32_16x16x32_bf16 v[232:235], a[108:111], a[68:71], v[232:235]
  ds_read_b64_tr_b16 a[150:151], v49 offset:8704
  v_mfma_f32_16x16x32_bf16 v[236:239], a[108:111], a[72:75], v[236:239]
  ds_read_b64_tr_b16 a[152:153], v6 offset:12288
  s_add_u32 s82, s56, 303104
  v_mfma_f32_16x16x32_bf16 v[240:243], a[108:111], a[76:79], v[240:243]
  ds_read_b64_tr_b16 a[154:155], v6 offset:12800
  v_mfma_f32_16x16x32_bf16 v[244:247], a[108:111], a[80:83], v[244:247]
  ds_read_b64_tr_b16 a[156:157], v49 offset:12288
  s_add_u32 m0, s85, 107520
  v_mfma_f32_16x16x32_bf16 v[248:251], a[108:111], a[84:87], v[248:251]
  ds_read_b64_tr_b16 a[158:159], v49 offset:12800
  v_mfma_f32_16x16x32_bf16 v[252:255], a[108:111], a[88:91], v[252:255]
  buffer_load_dwordx4 v17, s[12:15], s82 offen lds
  v_mfma_f32_16x16x32_bf16 a[244:247], a[108:111], a[252:255], a[244:247]
  s_waitcnt vmcnt(8) lgkmcnt(0)
  s_barrier
  v_mfma_f32_16x16x32_bf16 v[88:91], a[36:39], a[4:7], v[88:91]
  ds_read_b128 a[56:59], v19 offset:18432
  s_add_u32 s82, s56, 327680
  v_mfma_f32_16x16x32_bf16 v[92:95], a[36:39], a[8:11], v[92:95]
  ds_read_b128 a[60:63], v19 offset:20480
  s_add_u32 m0, s85, 81920
  v_mfma_f32_16x16x32_bf16 v[96:99], a[36:39], a[12:15], v[96:99]
  ds_read_b128 a[64:67], v19 offset:22528
  buffer_load_dwordx4 v17, s[12:15], s82 offen lds
  v_mfma_f32_16x16x32_bf16 v[100:103], a[36:39], a[16:19], v[100:103]
  ds_read_b128 a[68:71], v19 offset:24576
  s_add_u32 s82, s56, 335872
  v_mfma_f32_16x16x32_bf16 v[104:107], a[36:39], a[20:23], v[104:107]
  ds_read_b128 a[72:75], v19 offset:26624
  v_mfma_f32_16x16x32_bf16 v[108:111], a[36:39], a[24:27], v[108:111]
  ds_read_b128 a[76:79], v19 offset:28672
  s_add_u32 m0, s85, 82944
  v_mfma_f32_16x16x32_bf16 v[112:115], a[36:39], a[28:31], v[112:115]
  ds_read_b128 a[80:83], v19 offset:30720
  buffer_load_dwordx4 v17, s[12:15], s82 offen lds
  v_mfma_f32_16x16x32_bf16 v[116:119], a[36:39], a[32:35], v[116:119]
  ds_read_b128 a[84:87], v19 offset:32768
  s_add_u32 s82, s56, 360448
  v_mfma_f32_16x16x32_bf16 a[228:231], a[36:39], a[252:255], a[228:231]
  ds_read_b128 a[88:91], v19 offset:34816
  s_add_u32 m0, s85, 90112
  v_mfma_f32_16x16x32_bf16 v[120:123], a[40:43], a[0:3], v[120:123]
  ds_read_b64_tr_b16 a[92:93], v22 offset:0
  v_mfma_f32_16x16x32_bf16 v[124:127], a[40:43], a[4:7], v[124:127]
  ds_read_b64_tr_b16 a[94:95], v22 offset:512
  buffer_load_dwordx4 v17, s[12:15], s82 offen lds
  v_mfma_f32_16x16x32_bf16 v[128:131], a[40:43], a[8:11], v[128:131]
  ds_read_b64_tr_b16 a[96:97], v22 offset:4096
  s_add_u32 s82, s56, 368640
  v_mfma_f32_16x16x32_bf16 v[132:135], a[40:43], a[12:15], v[132:135]
  ds_read_b64_tr_b16 a[98:99], v22 offset:4608
  s_add_u32 m0, s85, 91136
  v_mfma_f32_16x16x32_bf16 v[136:139], a[40:43], a[16:19], v[136:139]
  ds_read_b64_tr_b16 a[100:101], v22 offset:8192
  buffer_load_dwordx4 v17, s[12:15], s82 offen lds
  v_mfma_f32_16x16x32_bf16 v[140:143], a[40:43], a[20:23], v[140:143]
  ds_read_b64_tr_b16 a[102:103], v22 offset:8704
  v_mfma_f32_16x16x32_bf16 v[144:147], a[40:43], a[24:27], v[144:147]
  ds_read_b64_tr_b16 a[104:105], v22 offset:12288
  s_add_u32 s82, s56, 393216
  v_mfma_f32_16x16x32_bf16 v[148:151], a[40:43], a[28:31], v[148:151]
  ds_read_b64_tr_b16 a[106:107], v22 offset:12800
  s_add_u32 m0, s85, 98304
  v_mfma_f32_16x16x32_bf16 v[152:155], a[40:43], a[32:35], v[152:155]
  ds_read_b64_tr_b16 a[108:109], v22 offset:16384
  buffer_load_dwordx4 v17, s[12:15], s82 offen lds
  v_mfma_f32_16x16x32_bf16 v[156:159], a[0:3], a[44:47], v[156:159]
  ds_read_b64_tr_b16 a[110:111], v22 offset:16896
  s_add_u32 s82, s56, 401408
  v_mfma_f32_16x16x32_bf16 v[160:163], a[4:7], a[44:47], v[160:163]
  ds_read_b64_tr_b16 a[160:161], v6 offset:16384
  v_mfma_f32_16x16x32_bf16 v[164:167], a[8:11], a[44:47], v[164:167]
  ds_read_b64_tr_b16 a[162:163], v6 offset:16896
  s_add_u32 m0, s85, 99328
  v_mfma_f32_16x16x32_bf16 v[168:171], a[12:15], a[44:47], v[168:171]
  ds_read_b64_tr_b16 a[164:165], v49 offset:16384
  buffer_load_dwordx4 v17, s[12:15], s82 offen lds
  v_mfma_f32_16x16x32_bf16 v[172:175], a[16:19], a[44:47], v[172:175]
  ds_read_b64_tr_b16 a[166:167], v49 offset:16896
  s_add_u32 s61, s57, 98304
  v_mfma_f32_16x16x32_bf16 v[176:179], a[20:23], a[44:47], v[176:179]
  ds_read_b64_tr_b16 a[168:169], v6 offset:20480
  s_add_u32 m0, s85, 24576
  v_mfma_f32_16x16x32_bf16 v[180:183], a[24:27], a[44:47], v[180:183]
  ds_read_b64_tr_b16 a[170:171], v6 offset:20992
  v_mfma_f32_16x16x32_bf16 v[184:187], a[28:31], a[44:47], v[184:187]
  ds_read_b64_tr_b16 a[172:173], v49 offset:20480
  buffer_load_dwordx4 v17, s[12:15], s61 offen lds
  v_mfma_f32_16x16x32_bf16 v[188:191], a[32:35], a[44:47], v[188:191]
  ds_read_b64_tr_b16 a[174:175], v49 offset:20992
  s_add_u32 s61, s57, 106496
  v_mfma_f32_16x16x32_bf16 v[192:195], a[48:51], a[4:7], v[192:195]
  ds_read_b64_tr_b16 a[176:177], v2 offset:40960
  s_add_u32 m0, s85, 25600
  v_mfma_f32_16x16x32_bf16 v[196:199], a[48:51], a[8:11], v[196:199]
  ds_read_b64_tr_b16 a[178:179], v2 offset:41472
  buffer_load_dwordx4 v17, s[12:15], s61 offen lds
  v_mfma_f32_16x16x32_bf16 v[200:203], a[48:51], a[12:15], v[200:203]
  ds_read_b64_tr_b16 a[180:181], v3 offset:40960
  v_mfma_f32_16x16x32_bf16 v[204:207], a[48:51], a[16:19], v[204:207]
  ds_read_b64_tr_b16 a[182:183], v3 offset:41472
  s_add_u32 s61, s53, 0
  v_mfma_f32_16x16x32_bf16 v[208:211], a[48:51], a[20:23], v[208:211]
  ds_read_b64_tr_b16 a[184:185], v2 offset:45056
  s_add_u32 m0, s85, 32768
  v_mfma_f32_16x16x32_bf16 v[212:215], a[48:51], a[24:27], v[212:215]
  ds_read_b64_tr_b16 a[186:187], v2 offset:45568
  buffer_load_dwordx4 v17, s[12:15], s61 offen lds
  v_mfma_f32_16x16x32_bf16 v[216:219], a[48:51], a[28:31], v[216:219]
  ds_read_b64_tr_b16 a[188:189], v3 offset:45056
  s_add_u32 s61, s53, 8192
  v_mfma_f32_16x16x32_bf16 v[220:223], a[48:51], a[32:35], v[220:223]
  ds_read_b64_tr_b16 a[190:191], v3 offset:45568
  v_mfma_f32_16x16x32_bf16 a[240:243], a[48:51], a[252:255], a[240:243]
  ds_read_b64_tr_b16 a[192:193], v2 offset:49152
  s_add_u32 m0, s85, 33792
  v_mfma_f32_16x16x32_bf16 v[224:227], a[52:55], a[4:7], v[224:227]
  ds_read_b64_tr_b16 a[194:195], v2 offset:49664
  buffer_load_dwordx4 v17, s[12:15], s61 offen lds
  v_mfma_f32_16x16x32_bf16 v[228:231], a[52:55], a[8:11], v[228:231]
  ds_read_b64_tr_b16 a[196:197], v3 offset:49152
  s_add_u32 s61, s53, 131072
  v_mfma_f32_16x16x32_bf16 v[232:235], a[52:55], a[12:15], v[232:235]
  ds_read_b64_tr_b16 a[198:199], v3 offset:49664
  s_add_u32 m0, s85, 139264
  v_mfma_f32_16x16x32_bf16 v[236:239], a[52:55], a[16:19], v[236:239]
  ds_read_b64_tr_b16 a[200:201], v2 offset:53248
  v_mfma_f32_16x16x32_bf16 v[240:243], a[52:55], a[20:23], v[240:243]
  ds_read_b64_tr_b16 a[202:203], v2 offset:53760
  buffer_load_dwordx4 v17, s[12:15], s61 offen lds
  v_mfma_f32_16x16x32_bf16 v[244:247], a[52:55], a[24:27], v[244:247]
  ds_read_b64_tr_b16 a[204:205], v3 offset:53248
  s_add_u32 s61, s53, 139264
  v_mfma_f32_16x16x32_bf16 v[248:251], a[52:55], a[28:31], v[248:251]
  ds_read_b64_tr_b16 a[206:207], v3 offset:53760
  s_add_u32 m0, s85, 140288
  v_mfma_f32_16x16x32_bf16 v[252:255], a[52:55], a[32:35], v[252:255]
  buffer_load_dwordx4 v17, s[12:15], s61 offen lds
  v_mfma_f32_16x16x32_bf16 a[244:247], a[52:55], a[252:255], a[244:247]
  s_waitcnt vmcnt(12) lgkmcnt(0)
  s_barrier
  v_mfma_f32_16x16x32_bf16 v[88:91], a[92:95], a[60:63], v[88:91]
  ds_read_b64_tr_b16 a[208:209], v2 offset:57344
  s_add_u32 s82, s56, 425984
  v_mfma_f32_16x16x32_bf16 v[92:95], a[92:95], a[64:67], v[92:95]
  ds_read_b64_tr_b16 a[210:211], v2 offset:57856
  s_add_u32 m0, s85, 0
  v_mfma_f32_16x16x32_bf16 v[96:99], a[92:95], a[68:71], v[96:99]
  ds_read_b64_tr_b16 a[212:213], v3 offset:57344
  buffer_load_dwordx4 v17, s[12:15], s82 offen lds
  v_mfma_f32_16x16x32_bf16 v[100:103], a[92:95], a[72:75], v[100:103]
  ds_read_b64_tr_b16 a[214:215], v3 offset:57856
  s_add_u32 s82, s56, 434176
  v_mfma_f32_16x16x32_bf16 v[104:107], a[92:95], a[76:79], v[104:107]
  ds_read_b64_tr_b16 a[216:217], v2 offset:61440
  s_add_u32 m0, s85, 1024
  v_mfma_f32_16x16x32_bf16 v[108:111], a[92:95], a[80:83], v[108:111]
  ds_read_b64_tr_b16 a[218:219], v2 offset:61952
  buffer_load_dwordx4 v17, s[12:15], s82 offen lds
  v_mfma_f32_16x16x32_bf16 v[112:115], a[92:95], a[84:87], v[112:115]
  ds_read_b64_tr_b16 a[220:221], v3 offset:61440
  s_add_u32 s82, s56, 458752
  v_mfma_f32_16x16x32_bf16 v[116:119], a[92:95], a[88:91], v[116:119]
  ds_read_b64_tr_b16 a[222:223], v3 offset:61952
  s_add_u32 m0, s85, 8192
  v_mfma_f32_16x16x32_bf16 a[228:231], a[92:95], a[252:255], a[228:231]
  ds_read_b64_tr_b16 a[0:1], v4 offset:0
  buffer_load_dwordx4 v17, s[12:15], s82 offen lds
  v_mfma_f32_16x16x32_bf16 v[120:123], a[96:99], a[56:59], v[120:123]
  ds_read_b64_tr_b16 a[2:3], v4 offset:512
  s_add_u32 s82, s56, 466944
  v_mfma_f32_16x16x32_bf16 v[124:127], a[96:99], a[60:63], v[124:127]
  ds_read_b64_tr_b16 a[4:5], v5 offset:0
  s_add_u32 m0, s85, 9216
  v_mfma_f32_16x16x32_bf16 v[128:131], a[96:99], a[64:67], v[128:131]
  ds_read_b64_tr_b16 a[6:7], v5 offset:512
  buffer_load_dwordx4 v17, s[12:15], s82 offen lds
  v_mfma_f32_16x16x32_bf16 v[132:135], a[96:99], a[68:71], v[132:135]
  ds_read_b64_tr_b16 a[8:9], v4 offset:4096
  s_add_u32 s82, s56, 491520
  v_mfma_f32_16x16x32_bf16 v[136:139], a[96:99], a[72:75], v[136:139]
  ds_read_b64_tr_b16 a[10:11], v4 offset:4608
  s_add_u32 m0, s85, 16384
  v_mfma_f32_16x16x32_bf16 v[140:143], a[96:99], a[76:79], v[140:143]
  ds_read_b64_tr_b16 a[12:13], v5 offset:4096
  buffer_load_dwordx4 v17, s[12:15], s82 offen lds
  v_mfma_f32_16x16x32_bf16 v[144:147], a[96:99], a[80:83], v[144:147]
  ds_read_b64_tr_b16 a[14:15], v5 offset:4608
  s_add_u32 s82, s56, 499712
  v_mfma_f32_16x16x32_bf16 v[148:151], a[96:99], a[84:87], v[148:151]
  ds_read_b64_tr_b16 a[16:17], v4 offset:8192
  s_add_u32 m0, s85, 17408
  v_mfma_f32_16x16x32_bf16 v[152:155], a[96:99], a[88:91], v[152:155]
  ds_read_b64_tr_b16 a[18:19], v4 offset:8704
  buffer_load_dwordx4 v17, s[12:15], s82 offen lds
  v_mfma_f32_16x16x32_bf16 v[156:159], a[56:59], a[100:103], v[156:159]
  ds_read_b64_tr_b16 a[20:21], v5 offset:8192
  s_add_u32 s82, s57, 0
  v_mfma_f32_16x16x32_bf16 v[160:163], a[60:63], a[100:103], v[160:163]
  ds_read_b64_tr_b16 a[22:23], v5 offset:8704
  s_add_u32 m0, s85, 114688
  v_mfma_f32_16x16x32_bf16 v[164:167], a[64:67], a[100:103], v[164:167]
  ds_read_b64_tr_b16 a[24:25], v4 offset:12288
  buffer_load_dwordx4 v17, s[12:15], s82 offen lds
  v_mfma_f32_16x16x32_bf16 v[168:171], a[68:71], a[100:103], v[168:171]
  ds_read_b64_tr_b16 a[26:27], v4 offset:12800
  s_add_u32 s82, s57, 8192
  v_mfma_f32_16x16x32_bf16 v[172:175], a[72:75], a[100:103], v[172:175]
  ds_read_b64_tr_b16 a[28:29], v5 offset:12288
  s_add_u32 m0, s85, 115712
  v_mfma_f32_16x16x32_bf16 v[176:179], a[76:79], a[100:103], v[176:179]
  ds_read_b64_tr_b16 a[30:31], v5 offset:12800
  buffer_load_dwordx4 v17, s[12:15], s82 offen lds
  v_mfma_f32_16x16x32_bf16 v[180:183], a[80:83], a[100:103], v[180:183]
  ds_read_b64_tr_b16 a[32:33], v4 offset:40960
  s_add_u32 s82, s57, 32768
  v_mfma_f32_16x16x32_bf16 v[184:187], a[84:87], a[100:103], v[184:187]
  ds_read_b64_tr_b16 a[34:35], v4 offset:41472
  s_add_u32 m0, s85, 122880
  v_mfma_f32_16x16x32_bf16 v[188:191], a[88:91], a[100:103], v[188:191]
  ds_read_b64_tr_b16 a[36:37], v5 offset:40960
  buffer_load_dwordx4 v17, s[12:15], s82 offen lds
  v_mfma_f32_16x16x32_bf16 v[192:195], a[104:107], a[60:63], v[192:195]
  ds_read_b64_tr_b16 a[38:39], v5 offset:41472
  s_add_u32 s82, s57, 40960
  v_mfma_f32_16x16x32_bf16 v[196:199], a[104:107], a[64:67], v[196:199]
  ds_read_b64_tr_b16 a[40:41], v4 offset:45056
  s_add_u32 m0, s85, 123904
  v_mfma_f32_16x16x32_bf16 v[200:203], a[104:107], a[68:71], v[200:203]
  ds_read_b64_tr_b16 a[42:43], v4 offset:45568
  buffer_load_dwordx4 v17, s[12:15], s82 offen lds
  v_mfma_f32_16x16x32_bf16 v[204:207], a[104:107], a[72:75], v[204:207]
  ds_read_b64_tr_b16 a[44:45], v5 offset:45056
  s_add_u32 s82, s57, 65536
  v_mfma_f32_16x16x32_bf16 v[208:211], a[104:107], a[76:79], v[208:211]
  ds_read_b64_tr_b16 a[46:47], v5 offset:45568
  s_add_u32 m0, s85, 131072
  v_mfma_f32_16x16x32_bf16 v[212:215], a[104:107], a[80:83], v[212:215]
  buffer_load_dwordx4 v17, s[12:15], s82 offen lds
  s_add_u32 s82, s57, 73728
  v_mfma_f32_16x16x32_bf16 v[216:219], a[104:107], a[84:87], v[216:219]
  s_add_u32 m0, s85, 132096
  s_nop 0
  buffer_load_dwordx4 v17, s[12:15], s82 offen lds
  v_mfma_f32_16x16x32_bf16 v[220:223], a[104:107], a[88:91], v[220:223]
  s_add_u32 s61, s53, 163840
  s_add_u32 m0, s85, 147456
  v_mfma_f32_16x16x32_bf16 a[240:243], a[104:107], a[252:255], a[240:243]
  buffer_load_dwordx4 v17, s[12:15], s61 offen lds
  s_add_u32 s61, s53, 172032
  v_mfma_f32_16x16x32_bf16 v[224:227], a[108:111], a[60:63], v[224:227]
  s_add_u32 m0, s85, 148480
  s_nop 0
  buffer_load_dwordx4 v17, s[12:15], s61 offen lds
  v_mfma_f32_16x16x32_bf16 v[228:231], a[108:111], a[64:67], v[228:231]
  s_add_u32 s61, s53, 32768
  s_add_u32 m0, s85, 40960
  v_mfma_f32_16x16x32_bf16 v[232:235], a[108:111], a[68:71], v[232:235]
  buffer_load_dwordx4 v17, s[12:15], s61 offen lds
  s_add_u32 s61, s53, 40960
  v_mfma_f32_16x16x32_bf16 v[236:239], a[108:111], a[72:75], v[236:239]
  s_add_u32 m0, s85, 41984
  s_nop 0
  buffer_load_dwordx4 v17, s[12:15], s61 offen lds
  v_mfma_f32_16x16x32_bf16 v[240:243], a[108:111], a[76:79], v[240:243]
  s_add_u32 s61, s53, 65536
  s_add_u32 m0, s85, 49152
  v_mfma_f32_16x16x32_bf16 v[244:247], a[108:111], a[80:83], v[244:247]
  buffer_load_dwordx4 v17, s[12:15], s61 offen lds
  v_mfma_f32_16x16x32_bf16 v[248:251], a[108:111], a[84:87], v[248:251]
  s_add_u32 s61, s53, 73728
  v_mfma_f32_16x16x32_bf16 v[252:255], a[108:111], a[88:91], v[252:255]
  s_add_u32 m0, s85, 50176
  v_mfma_f32_16x16x32_bf16 a[244:247], a[108:111], a[252:255], a[244:247]
  buffer_load_dwordx4 v17, s[12:15], s61 offen lds
  s_waitcnt lgkmcnt(0)
L_epi0:
  v_accvgpr_read_b32 v8, a240
  v_accvgpr_read_b32 v9, a241
  v_accvgpr_read_b32 v10, a242
  v_accvgpr_read_b32 v11, a243
  s_nop 1
  v_accvgpr_read_b32 v12, a244
  v_accvgpr_read_b32 v13, a245
  v_accvgpr_read_b32 v14, a246
  v_accvgpr_read_b32 v15, a247
  v_accvgpr_read_b32 v44, a228
  v_accvgpr_read_b32 v45, a229
  v_accvgpr_read_b32 v46, a230
  v_accvgpr_read_b32 v47, a231
  ds_read_b128 v[78:81], v43 offset:512
  ds_read_b128 v[82:85], v43 offset:1088
  v_pk_fma_f32 v[192:193], v[8:9], v[62:63], v[192:193] op_sel:[0,1,0] op_sel_hi:[1,1,1] neg_lo:[0,1,0] neg_hi:[0,1,0]
  v_pk_fma_f32 v[196:197], v[8:9], v[64:65], v[196:197] op_sel:[0,1,0] op_sel_hi:[1,1,1] neg_lo:[0,1,0] neg_hi:[0,1,0]
  v_pk_fma_f32 v[194:195], v[10:11], v[62:63], v[194:195] op_sel:[0,1,0] op_sel_hi:[1,1,1] neg_lo:[0,1,0] neg_hi:[0,1,0]
  v_pk_fma_f32 v[198:199], v[10:11], v[64:65], v[198:199] op_sel:[0,1,0] op_sel_hi:[1,1,1] neg_lo:[0,1,0] neg_hi:[0,1,0]
  v_pk_fma_f32 v[224:225], v[12:13], v[62:63], v[224:225] op_sel:[0,1,0] op_sel_hi:[1,1,1] neg_lo:[0,1,0] neg_hi:[0,1,0]
  v_pk_fma_f32 v[228:229], v[12:13], v[64:65], v[228:229] op_sel:[0,1,0] op_sel_hi:[1,1,1] neg_lo:[0,1,0] neg_hi:[0,1,0]
  v_pk_fma_f32 v[226:227], v[14:15], v[62:63], v[226:227] op_sel:[0,1,0] op_sel_hi:[1,1,1] neg_lo:[0,1,0] neg_hi:[0,1,0]
  v_pk_fma_f32 v[230:231], v[14:15], v[64:65], v[230:231] op_sel:[0,1,0] op_sel_hi:[1,1,1] neg_lo:[0,1,0] neg_hi:[0,1,0]
  v_pk_mul_f32 v[192:193], v[192:193], v[224:225]
  v_pk_mul_f32 v[196:197], v[196:197], v[228:229]
  v_pk_mul_f32 v[194:195], v[194:195], v[226:227]
  v_pk_mul_f32 v[198:199], v[198:199], v[230:231]
  v_cvt_pk_bf16_f32 v224, v192, v193
  v_cvt_pk_bf16_f32 v226, v196, v197
  v_cvt_pk_bf16_f32 v225, v194, v195
  v_cvt_pk_bf16_f32 v227, v198, v199
  v_permlane16_swap_b32 v224, v226
  s_nop 0
  v_permlane16_swap_b32 v225, v227
  ds_read_b128 v[192:195], v43 offset:0
  ds_read_b128 v[196:199], v43 offset:576
  v_pk_fma_f32 v[200:201], v[8:9], v[66:67], v[200:201] op_sel:[0,1,0] op_sel_hi:[1,1,1] neg_lo:[0,1,0] neg_hi:[0,1,0]
  v_pk_fma_f32 v[204:205], v[8:9], v[68:69], v[204:205] op_sel:[0,1,0] op_sel_hi:[1,1,1] neg_lo:[0,1,0] neg_hi:[0,1,0]
  v_pk_fma_f32 v[202:203], v[10:11], v[66:67], v[202:203] op_sel:[0,1,0] op_sel_hi:[1,1,1] neg_lo:[0,1,0] neg_hi:[0,1,0]
  v_pk_fma_f32 v[206:207], v[10:11], v[68:69], v[206:207] op_sel:[0,1,0] op_sel_hi:[1,1,1] neg_lo:[0,1,0] neg_hi:[0,1,0]
  v_pk_fma_f32 v[232:233], v[12:13], v[66:67], v[232:233] op_sel:[0,1,0] op_sel_hi:[1,1,1] neg_lo:[0,1,0] neg_hi:[0,1,0]
  v_pk_fma_f32 v[236:237], v[12:13], v[68:69], v[236:237] op_sel:[0,1,0] op_sel_hi:[1,1,1] neg_lo:[0,1,0] neg_hi:[0,1,0]
  v_pk_fma_f32 v[234:235], v[14:15], v[66:67], v[234:235] op_sel:[0,1,0] op_sel_hi:[1,1,1] neg_lo:[0,1,0] neg_hi:[0,1,0]
  v_pk_fma_f32 v[238:239], v[14:15], v[68:69], v[238:239] op_sel:[0,1,0] op_sel_hi:[1,1,1] neg_lo:[0,1,0] neg_hi:[0,1,0]
  v_pk_mul_f32 v[200:201], v[200:201], v[232:233]
  v_pk_mul_f32 v[204:205], v[204:205], v[236:237]
  v_pk_mul_f32 v[202:203], v[202:203], v[234:235]
  v_pk_mul_f32 v[206:207], v[206:207], v[238:239]
  v_cvt_pk_bf16_f32 v232, v200, v201
  v_cvt_pk_bf16_f32 v234, v204, v205
  v_cvt_pk_bf16_f32 v233, v202, v203
  v_cvt_pk_bf16_f32 v235, v206, v207
  v_permlane16_swap_b32 v232, v234
  s_nop 0
  v_permlane16_swap_b32 v233, v235
  ds_read_b128 v[200:203], v43 offset:64
  ds_read_b128 v[204:207], v43 offset:640
  v_pk_fma_f32 v[208:209], v[8:9], v[70:71], v[208:209] op_sel:[0,1,0] op_sel_hi:[1,1,1] neg_lo:[0,1,0] neg_hi:[0,1,0]
  v_pk_fma_f32 v[212:213], v[8:9], v[72:73], v[212:213] op_sel:[0,1,0] op_sel_hi:[1,1,1] neg_lo:[0,1,0] neg_hi:[0,1,0]
  v_pk_fma_f32 v[210:211], v[10:11], v[70:71], v[210:211] op_sel:[0,1,0] op_sel_hi:[1,1,1] neg_lo:[0,1,0] neg_hi:[0,1,0]
  v_pk_fma_f32 v[214:215], v[10:11], v[72:73], v[214:215] op_sel:[0,1,0] op_sel_hi:[1,1,1] neg_lo:[0,1,0] neg_hi:[0,1,0]
  v_pk_fma_f32 v[240:241], v[12:13], v[70:71], v[240:241] op_sel:[0,1,0] op_sel_hi:[1,1,1] neg_lo:[0,1,0] neg_hi:[0,1,0]
  v_pk_fma_f32 v[244:245], v[12:13], v[72:73], v[244:245] op_sel:[0,1,0] op_sel_hi:[1,1,1] neg_lo:[0,1,0] neg_hi:[0,1,0]
  v_pk_fma_f32 v[242:243], v[14:15], v[70:71], v[242:243] op_sel:[0,1,0] op_sel_hi:[1,1,1] neg_lo:[0,1,0] neg_hi:[0,1,0]
  v_pk_fma_f32 v[246:247], v[14:15], v[72:73], v[246:247] op_sel:[0,1,0] op_sel_hi:[1,1,1] neg_lo:[0,1,0] neg_hi:[0,1,0]
  v_pk_mul_f32 v[208:209], v[208:209], v[240:241]
  v_pk_mul_f32 v[212:213], v[212:213], v[244:245]
  v_pk_mul_f32 v[210:211], v[210:211], v[242:243]
  v_pk_mul_f32 v[214:215], v[214:215], v[246:247]
  v_cvt_pk_bf16_f32 v240, v208, v209
  v_cvt_pk_bf16_f32 v242, v212, v213
  v_cvt_pk_bf16_f32 v241, v210, v211
  v_cvt_pk_bf16_f32 v243, v214, v215
  v_permlane16_swap_b32 v240, v242
  s_nop 0
  v_permlane16_swap_b32 v241, v243
  ds_read_b128 v[208:211], v43 offset:128
  ds_read_b128 v[212:215], v43 offset:704
  v_pk_fma_f32 v[216:217], v[8:9], v[74:75], v[216:217] op_sel:[0,1,0] op_sel_hi:[1,1,1] neg_lo:[0,1,0] neg_hi:[0,1,0]
  v_pk_fma_f32 v[220:221], v[8:9], v[76:77], v[220:221] op_sel:[0,1,0] op_sel_hi:[1,1,1] neg_lo:[0,1,0] neg_hi:[0,1,0]
  v_pk_fma_f32 v[218:219], v[10:11], v[74:75], v[218:219] op_sel:[0,1,0] op_sel_hi:[1,1,1] neg_lo:[0,1,0] neg_hi:[0,1,0]
  v_pk_fma_f32 v[222:223], v[10:11], v[76:77], v[222:223] op_sel:[0,1,0] op_sel_hi:[1,1,1] neg_lo:[0,1,0] neg_hi:[0,1,0]
  v_pk_fma_f32 v[248:249], v[12:13], v[74:75], v[248:249] op_sel:[0,1,0] op_sel_hi:[1,1,1] neg_lo:[0,1,0] neg_hi:[0,1,0]
  v_pk_fma_f32 v[252:253], v[12:13], v[76:77], v[252:253] op_sel:[0,1,0] op_sel_hi:[1,1,1] neg_lo:[0,1,0] neg_hi:[0,1,0]
  v_pk_fma_f32 v[250:251], v[14:15], v[74:75], v[250:251] op_sel:[0,1,0] op_sel_hi:[1,1,1] neg_lo:[0,1,0] neg_hi:[0,1,0]
  v_pk_fma_f32 v[254:255], v[14:15], v[76:77], v[254:255] op_sel:[0,1,0] op_sel_hi:[1,1,1] neg_lo:[0,1,0] neg_hi:[0,1,0]
  v_pk_mul_f32 v[216:217], v[216:217], v[248:249]
  v_pk_mul_f32 v[220:221], v[220:221], v[252:253]
  v_pk_mul_f32 v[218:219], v[218:219], v[250:251]
  v_pk_mul_f32 v[222:223], v[222:223], v[254:255]
  v_cvt_pk_bf16_f32 v248, v216, v217
  v_cvt_pk_bf16_f32 v250, v220, v221
  v_cvt_pk_bf16_f32 v249, v218, v219
  v_cvt_pk_bf16_f32 v251, v222, v223
  v_permlane16_swap_b32 v248, v250
  s_nop 0
  v_permlane16_swap_b32 v249, v251
  ds_read_b128 v[216:219], v43 offset:192
  ds_read_b128 v[220:223], v43 offset:768
  s_waitcnt lgkmcnt(0)
  s_barrier
  v_mov_b32_dpp v48, v120 row_newbcast:0 row_mask:0xf bank_mask:0xf
  v_mov_b32_dpp v49, v121 row_newbcast:0 row_mask:0xf bank_mask:0xf
  v_mov_b32_dpp v50, v122 row_newbcast:0 row_mask:0xf bank_mask:0xf
  v_mov_b32_dpp v51, v123 row_newbcast:0 row_mask:0xf bank_mask:0xf
  v_mov_b32 v52, v156
  v_mov_b32 v53, v156
  s_nop 0
  s_nop 0
  v_permlane16_swap_b32 v52, v53
  v_mov_b32 v53, v52
  s_nop 1
  v_permlane32_swap_b32 v52, v53
  v_pk_fma_f32 v[120:121], v[48:49], v[60:61], v[120:121] op_sel:[0,1,0] op_sel_hi:[1,1,1] neg_lo:[0,1,0] neg_hi:[0,1,0]
  v_pk_fma_f32 v[124:125], v[48:49], v[62:63], v[124:125] op_sel:[0,1,0] op_sel_hi:[1,1,1] neg_lo:[0,1,0] neg_hi:[0,1,0]
  v_pk_fma_f32 v[128:129], v[48:49], v[64:65], v[128:129] op_sel:[0,1,0] op_sel_hi:[1,1,1] neg_lo:[0,1,0] neg_hi:[0,1,0]
  buffer_store_dwordx4 v[224:227], v26, s[20:23], s88 offen sc1
  v_pk_fma_f32 v[132:133], v[48:49], v[66:67], v[132:133] op_sel:[0,1,0] op_sel_hi:[1,1,1] neg_lo:[0,1,0] neg_hi:[0,1,0]
  v_pk_fma_f32 v[136:137], v[48:49], v[68:69], v[136:137] op_sel:[0,1,0] op_sel_hi:[1,1,1] neg_lo:[0,1,0] neg_hi:[0,1,0]
  v_pk_fma_f32 v[140:141], v[48:49], v[70:71], v[140:141] op_sel:[0,1,0] op_sel_hi:[1,1,1] neg_lo:[0,1,0] neg_hi:[0,1,0]
  v_pk_fma_f32 v[144:145], v[48:49], v[72:73], v[144:145] op_sel:[0,1,0] op_sel_hi:[1,1,1] neg_lo:[0,1,0] neg_hi:[0,1,0]
  v_pk_fma_f32 v[148:149], v[48:49], v[74:75], v[148:149] op_sel:[0,1,0] op_sel_hi:[1,1,1] neg_lo:[0,1,0] neg_hi:[0,1,0]
  v_pk_fma_f32 v[152:153], v[48:49], v[76:77], v[152:153] op_sel:[0,1,0] op_sel_hi:[1,1,1] neg_lo:[0,1,0] neg_hi:[0,1,0]
  v_pk_fma_f32 v[122:123], v[50:51], v[60:61], v[122:123] op_sel:[0,1,0] op_sel_hi:[1,1,1] neg_lo:[0,1,0] neg_hi:[0,1,0]
  v_pk_fma_f32 v[126:127], v[50:51], v[62:63], v[126:127] op_sel:[0,1,0] op_sel_hi:[1,1,1] neg_lo:[0,1,0] neg_hi:[0,1,0]
  v_pk_fma_f32 v[130:131], v[50:51], v[64:65], v[130:131] op_sel:[0,1,0] op_sel_hi:[1,1,1] neg_lo:[0,1,0] neg_hi:[0,1,0]
  v_pk_fma_f32 v[134:135], v[50:51], v[66:67], v[134:135] op_sel:[0,1,0] op_sel_hi:[1,1,1] neg_lo:[0,1,0] neg_hi:[0,1,0]
  v_pk_fma_f32 v[138:139], v[50:51], v[68:69], v[138:139] op_sel:[0,1,0] op_sel_hi:[1,1,1] neg_lo:[0,1,0] neg_hi:[0,1,0]
  v_pk_fma_f32 v[142:143], v[50:51], v[70:71], v[142:143] op_sel:[0,1,0] op_sel_hi:[1,1,1] neg_lo:[0,1,0] neg_hi:[0,1,0]
  v_pk_fma_f32 v[146:147], v[50:51], v[72:73], v[146:147] op_sel:[0,1,0] op_sel_hi:[1,1,1] neg_lo:[0,1,0] neg_hi:[0,1,0]
  s_add_u32 s61, s53, 98304
  s_add_u32 m0, s85, 57344
  s_nop 0
  buffer_load_dwordx4 v17, s[12:15], s61 offen lds
  v_pk_fma_f32 v[150:151], v[50:51], v[74:75], v[150:151] op_sel:[0,1,0] op_sel_hi:[1,1,1] neg_lo:[0,1,0] neg_hi:[0,1,0]
  v_pk_fma_f32 v[154:155], v[50:51], v[76:77], v[154:155] op_sel:[0,1,0] op_sel_hi:[1,1,1] neg_lo:[0,1,0] neg_hi:[0,1,0]
  v_pk_mul_f32 v[120:121], v[120:121], v[60:61] op_sel_hi:[1,0]
  v_pk_mul_f32 v[124:125], v[124:125], v[62:63] op_sel_hi:[1,0]
  v_pk_mul_f32 v[128:129], v[128:129], v[64:65] op_sel_hi:[1,0]
  v_pk_mul_f32 v[132:133], v[132:133], v[66:67] op_sel_hi:[1,0]
  v_pk_mul_f32 v[136:137], v[136:137], v[68:69] op_sel_hi:[1,0]
  v_pk_mul_f32 v[140:141], v[140:141], v[70:71] op_sel_hi:[1,0]
  v_pk_mul_f32 v[144:145], v[144:145], v[72:73] op_sel_hi:[1,0]
  v_pk_mul_f32 v[148:149], v[148:149], v[74:75] op_sel_hi:[1,0]
  v_pk_mul_f32 v[152:153], v[152:153], v[76:77] op_sel_hi:[1,0]
  v_pk_mul_f32 v[122:123], v[122:123], v[60:61] op_sel_hi:[1,0]
  v_pk_mul_f32 v[126:127], v[126:127], v[62:63] op_sel_hi:[1,0]
  v_pk_mul_f32 v[130:131], v[130:131], v[64:65] op_sel_hi:[1,0]
  s_add_u32 s61, s53, 106496
  s_add_u32 m0, s85, 58368
  s_nop 0
  buffer_load_dwordx4 v17, s[12:15], s61 offen lds
  v_pk_mul_f32 v[134:135], v[134:135], v[66:67] op_sel_hi:[1,0]
  v_pk_mul_f32 v[138:139], v[138:139], v[68:69] op_sel_hi:[1,0]
  v_pk_mul_f32 v[142:143], v[142:143], v[70:71] op_sel_hi:[1,0]
  v_pk_mul_f32 v[146:147], v[146:147], v[72:73] op_sel_hi:[1,0]
  v_pk_mul_f32 v[150:151], v[150:151], v[74:75] op_sel_hi:[1,0]
  v_pk_mul_f32 v[154:155], v[154:155], v[76:77] op_sel_hi:[1,0]
  v_cvt_pk_bf16_f32 v8, v120, v121
  v_cvt_pk_bf16_f32 v10, v124, v125
  v_cvt_pk_bf16_f32 v12, v128, v129
  v_cvt_pk_bf16_f32 v14, v132, v133
  v_cvt_pk_bf16_f32 v18, v136, v137
  v_cvt_pk_bf16_f32 v20, v140, v141
  v_cvt_pk_bf16_f32 v22, v144, v145
  buffer_store_dwordx4 v[232:235], v27, s[20:23], s88 offen sc1
  v_cvt_pk_bf16_f32 v24, v148, v149
  v_cvt_pk_bf16_f32 v86, v152, v153
  v_cvt_pk_bf16_f32 v9, v122, v123
  v_cvt_pk_bf16_f32 v11, v126, v127
  v_cvt_pk_bf16_f32 v13, v130, v131
  v_cvt_pk_bf16_f32 v15, v134, v135
  v_cvt_pk_bf16_f32 v19, v138, v139
  v_cvt_pk_bf16_f32 v21, v142, v143
  v_cvt_pk_bf16_f32 v23, v146, v147
  v_cvt_pk_bf16_f32 v25, v150, v151
  v_cvt_pk_bf16_f32 v87, v154, v155
  s_waitcnt lgkmcnt(0)
  v_pk_fma_f32 v[156:157], v[196:197], v[52:53], v[156:157] op_sel_hi:[1,0,1] neg_lo:[0,1,0] neg_hi:[0,1,0]
  v_pk_fma_f32 v[160:161], v[204:205], v[52:53], v[160:161] op_sel_hi:[1,0,1] neg_lo:[0,1,0] neg_hi:[0,1,0]
  s_add_u32 s61, s53, 196608
  s_add_u32 m0, s85, 65536
  s_nop 0
  buffer_load_dwordx4 v17, s[12:15], s61 offen lds
  v_pk_fma_f32 v[164:165], v[212:213], v[52:53], v[164:165] op_sel_hi:[1,0,1] neg_lo:[0,1,0] neg_hi:[0,1,0]
  v_pk_fma_f32 v[168:169], v[220:221], v[52:53], v[168:169] op_sel_hi:[1,0,1] neg_lo:[0,1,0] neg_hi:[0,1,0]
  v_pk_fma_f32 v[188:189], v[82:83], v[52:53], v[188:189] op_sel_hi:[1,0,1] neg_lo:[0,1,0] neg_hi:[0,1,0]
  v_pk_fma_f32 v[158:159], v[198:199], v[52:53], v[158:159] op_sel_hi:[1,0,1] neg_lo:[0,1,0] neg_hi:[0,1,0]
  v_pk_fma_f32 v[162:163], v[206:207], v[52:53], v[162:163] op_sel_hi:[1,0,1] neg_lo:[0,1,0] neg_hi:[0,1,0]
  v_pk_fma_f32 v[166:167], v[214:215], v[52:53], v[166:167] op_sel_hi:[1,0,1] neg_lo:[0,1,0] neg_hi:[0,1,0]
  v_pk_fma_f32 v[170:171], v[222:223], v[52:53], v[170:171] op_sel_hi:[1,0,1] neg_lo:[0,1,0] neg_hi:[0,1,0]
  v_pk_fma_f32 v[190:191], v[84:85], v[52:53], v[190:191] op_sel_hi:[1,0,1] neg_lo:[0,1,0] neg_hi:[0,1,0]
  v_pk_mul_f32 v[156:157], v[156:157], v[192:193]
  v_pk_mul_f32 v[160:161], v[160:161], v[200:201]
  v_pk_mul_f32 v[164:165], v[164:165], v[208:209]
  v_pk_mul_f32 v[168:169], v[168:169], v[216:217]
  v_pk_mul_f32 v[188:189], v[188:189], v[78:79]
  s_add_u32 s61, s53, 204800
  s_add_u32 m0, s85, 66560
  s_nop 0
  buffer_load_dwordx4 v17, s[12:15], s61 offen lds
  v_pk_mul_f32 v[158:159], v[158:159], v[194:195]
  v_pk_mul_f32 v[162:163], v[162:163], v[202:203]
  v_pk_mul_f32 v[166:167], v[166:167], v[210:211]
  v_pk_mul_f32 v[170:171], v[170:171], v[218:219]
  v_pk_mul_f32 v[190:191], v[190:191], v[80:81]
  v_cvt_pk_bf16_f32 v136, v156, v157
  v_cvt_pk_bf16_f32 v138, v160, v161
  v_cvt_pk_bf16_f32 v140, v164, v165
  v_cvt_pk_bf16_f32 v142, v168, v169
  v_cvt_pk_bf16_f32 v152, v188, v189
  v_cvt_pk_bf16_f32 v137, v158, v159
  v_cvt_pk_bf16_f32 v139, v162, v163
  v_cvt_pk_bf16_f32 v141, v166, v167
  buffer_store_dwordx4 v[240:243], v28, s[20:23], s88 offen sc1
  v_cvt_pk_bf16_f32 v143, v170, v171
  v_cvt_pk_bf16_f32 v153, v190, v191
  ds_read_b128 v[192:195], v43 offset:256
  ds_read_b128 v[196:199], v43 offset:832
  ds_read_b128 v[200:203], v43 offset:320
  ds_read_b128 v[204:207], v43 offset:896
  ds_read_b128 v[208:211], v43 offset:384
  ds_read_b128 v[212:215], v43 offset:960
  ds_read_b128 v[216:219], v43 offset:448
  ds_read_b128 v[220:223], v43 offset:1024
  v_pk_fma_f32 v[88:89], v[44:45], v[62:63], v[88:89] op_sel:[0,1,0] op_sel_hi:[1,1,1] neg_lo:[0,1,0] neg_hi:[0,1,0]
  v_pk_fma_f32 v[92:93], v[44:45], v[64:65], v[92:93] op_sel:[0,1,0] op_sel_hi:[1,1,1] neg_lo:[0,1,0] neg_hi:[0,1,0]
  v_pk_fma_f32 v[96:97], v[44:45], v[66:67], v[96:97] op_sel:[0,1,0] op_sel_hi:[1,1,1] neg_lo:[0,1,0] neg_hi:[0,1,0]
  v_pk_fma_f32 v[100:101], v[44:45], v[68:69], v[100:101] op_sel:[0,1,0] op_sel_hi:[1,1,1] neg_lo:[0,1,0] neg_hi:[0,1,0]
  s_add_u32 s61, s53, 229376
  s_add_u32 m0, s85, 73728
  s_nop 0
  buffer_load_dwordx4 v17, s[12:15], s61 offen lds
  v_pk_fma_f32 v[104:105], v[44:45], v[70:71], v[104:105] op_sel:[0,1,0] op_sel_hi:[1,1,1] neg_lo:[0,1,0] neg_hi:[0,1,0]
  v_pk_fma_f32 v[108:109], v[44:45], v[72:73], v[108:109] op_sel:[0,1,0] op_sel_hi:[1,1,1] neg_lo:[0,1,0] neg_hi:[0,1,0]
  v_pk_fma_f32 v[112:113], v[44:45], v[74:75], v[112:113] op_sel:[0,1,0] op_sel_hi:[1,1,1] neg_lo:[0,1,0] neg_hi:[0,1,0]
  v_pk_fma_f32 v[116:117], v[44:45], v[76:77], v[116:117] op_sel:[0,1,0] op_sel_hi:[1,1,1] neg_lo:[0,1,0] neg_hi:[0,1,0]
  v_pk_fma_f32 v[90:91], v[46:47], v[62:63], v[90:91] op_sel:[0,1,0] op_sel_hi:[1,1,1] neg_lo:[0,1,0] neg_hi:[0,1,0]
  v_pk_fma_f32 v[94:95], v[46:47], v[64:65], v[94:95] op_sel:[0,1,0] op_sel_hi:[1,1,1] neg_lo:[0,1,0] neg_hi:[0,1,0]
  v_pk_fma_f32 v[98:99], v[46:47], v[66:67], v[98:99] op_sel:[0,1,0] op_sel_hi:[1,1,1] neg_lo:[0,1,0] neg_hi:[0,1,0]
  v_pk_fma_f32 v[102:103], v[46:47], v[68:69], v[102:103] op_sel:[0,1,0] op_sel_hi:[1,1,1] neg_lo:[0,1,0] neg_hi:[0,1,0]
  v_pk_fma_f32 v[106:107], v[46:47], v[70:71], v[106:107] op_sel:[0,1,0] op_sel_hi:[1,1,1] neg_lo:[0,1,0] neg_hi:[0,1,0]
  v_pk_fma_f32 v[110:111], v[46:47], v[72:73], v[110:111] op_sel:[0,1,0] op_sel_hi:[1,1,1] neg_lo:[0,1,0] neg_hi:[0,1,0]
  v_pk_fma_f32 v[114:115], v[46:47], v[74:75], v[114:115] op_sel:[0,1,0] op_sel_hi:[1,1,1] neg_lo:[0,1,0] neg_hi:[0,1,0]
  v_pk_fma_f32 v[118:119], v[46:47], v[76:77], v[118:119] op_sel:[0,1,0] op_sel_hi:[1,1,1] neg_lo:[0,1,0] neg_hi:[0,1,0]
  v_cvt_pk_bf16_f32 v120, v88, v89
  s_add_u32 s61, s53, 237568
  s_add_u32 m0, s85, 74752
  s_nop 0
  buffer_load_dwordx4 v17, s[12:15], s61 offen lds
  v_cvt_pk_bf16_f32 v122, v92, v93
  v_cvt_pk_bf16_f32 v124, v96, v97
  v_cvt_pk_bf16_f32 v126, v100, v101
  v_cvt_pk_bf16_f32 v128, v104, v105
  v_cvt_pk_bf16_f32 v130, v108, v109
  v_cvt_pk_bf16_f32 v132, v112, v113
  v_cvt_pk_bf16_f32 v134, v116, v117
  v_cvt_pk_bf16_f32 v121, v90, v91
  v_cvt_pk_bf16_f32 v123, v94, v95
  v_cvt_pk_bf16_f32 v125, v98, v99
  v_cvt_pk_bf16_f32 v127, v102, v103
  v_cvt_pk_bf16_f32 v129, v106, v107
  v_cvt_pk_bf16_f32 v131, v110, v111
  v_cvt_pk_bf16_f32 v133, v114, v115
  buffer_store_dwordx4 v[248:251], v29, s[20:23], s88 offen sc1
  v_cvt_pk_bf16_f32 v135, v118, v119
  s_waitcnt lgkmcnt(0)
  v_pk_fma_f32 v[172:173], v[196:197], v[52:53], v[172:173] op_sel_hi:[1,0,1] neg_lo:[0,1,0] neg_hi:[0,1,0]
  v_pk_fma_f32 v[176:177], v[204:205], v[52:53], v[176:177] op_sel_hi:[1,0,1] neg_lo:[0,1,0] neg_hi:[0,1,0]
  v_pk_fma_f32 v[180:181], v[212:213], v[52:53], v[180:181] op_sel_hi:[1,0,1] neg_lo:[0,1,0] neg_hi:[0,1,0]
  v_pk_fma_f32 v[184:185], v[220:221], v[52:53], v[184:185] op_sel_hi:[1,0,1] neg_lo:[0,1,0] neg_hi:[0,1,0]
  v_pk_fma_f32 v[174:175], v[198:199], v[52:53], v[174:175] op_sel_hi:[1,0,1] neg_lo:[0,1,0] neg_hi:[0,1,0]
  v_pk_fma_f32 v[178:179], v[206:207], v[52:53], v[178:179] op_sel_hi:[1,0,1] neg_lo:[0,1,0] neg_hi:[0,1,0]
  v_pk_fma_f32 v[182:183], v[214:215], v[52:53], v[182:183] op_sel_hi:[1,0,1] neg_lo:[0,1,0] neg_hi:[0,1,0]
  v_pk_fma_f32 v[186:187], v[222:223], v[52:53], v[186:187] op_sel_hi:[1,0,1] neg_lo:[0,1,0] neg_hi:[0,1,0]
  v_pk_mul_f32 v[172:173], v[172:173], v[192:193]
  v_pk_mul_f32 v[176:177], v[176:177], v[200:201]
  v_pk_mul_f32 v[180:181], v[180:181], v[208:209]
  s_add_u32 s61, s52, 0
  s_add_u32 m0, s85, 106496
  s_nop 0
  buffer_load_dwordx4 v17, s[8:11], s61 offen lds
  v_pk_mul_f32 v[184:185], v[184:185], v[216:217]
  v_pk_mul_f32 v[174:175], v[174:175], v[194:195]
  v_pk_mul_f32 v[178:179], v[178:179], v[202:203]
  v_pk_mul_f32 v[182:183], v[182:183], v[210:211]
  v_pk_mul_f32 v[186:187], v[186:187], v[218:219]
  v_cvt_pk_bf16_f32 v144, v172, v173
  v_cvt_pk_bf16_f32 v146, v176, v177
  v_cvt_pk_bf16_f32 v148, v180, v181
  v_cvt_pk_bf16_f32 v150, v184, v185
  v_cvt_pk_bf16_f32 v145, v174, v175
  v_cvt_pk_bf16_f32 v147, v178, v179
  v_cvt_pk_bf16_f32 v149, v182, v183
  v_cvt_pk_bf16_f32 v151, v186, v187
  s_add_u32 s61, s52, 8192
  s_add_u32 m0, s85, 107520
  s_nop 0
  buffer_load_dwordx4 v17, s[8:11], s61 offen lds
  v_mfma_f32_16x16x16_bf16 v[88:91], v[8:9], v[120:121], v[38:41]
  v_mfma_f32_16x16x16_bf16 v[92:95], v[10:11], v[120:121], v[34:37]
  v_mfma_f32_16x16x16_bf16 v[96:99], v[10:11], v[122:123], v[30:33]
  v_mfma_f32_16x16x16_bf16 v[100:103], v[12:13], v[122:123], v[34:37]
  v_mfma_f32_16x16x16_bf16 v[104:107], v[12:13], v[124:125], v[30:33]
  v_mfma_f32_16x16x16_bf16 v[108:111], v[14:15], v[124:125], v[34:37]
  v_mfma_f32_16x16x16_bf16 v[112:115], v[14:15], v[126:127], v[30:33]
  s_nop 2
  v_max3_f32 v88, v88, v89, v92
  v_max3_f32 v90, v90, v91, v94
  v_max_f32 v88, v88, v93
  v_mfma_f32_16x16x16_bf16 v[116:119], v[18:19], v[126:127], v[34:37]
  v_max_f32 v89, v90, v95
  v_mul_f32 v92, 0x3eb8aa3b, v62
  v_max_f32 v90, v88, v89
  v_mfma_f32_16x16x16_bf16 v[156:159], v[18:19], v[128:129], v[30:33]
  s_add_u32 s61, s52, 32768
  buffer_load_dwordx4 a[56:59], v17, s[8:11], s61 offen
  v_max3_f32 v96, v96, v97, v100
  v_max3_f32 v98, v98, v99, v102
  v_max_f32 v96, v96, v101
  v_mfma_f32_16x16x16_bf16 v[160:163], v[20:21], v[128:129], v[34:37]
  v_max_f32 v97, v98, v103
  v_mul_f32 v100, 0x3eb8aa3b, v64
  v_max_f32 v98, v96, v97
  v_mfma_f32_16x16x16_bf16 v[164:167], v[20:21], v[130:131], v[30:33]
  v_max3_f32 v104, v104, v105, v108
  v_max3_f32 v106, v106, v107, v110
  v_max_f32 v104, v104, v109
  v_mfma_f32_16x16x16_bf16 v[168:171], v[22:23], v[130:131], v[34:37]
  v_max_f32 v105, v106, v111
  v_mul_f32 v108, 0x3eb8aa3b, v66
  v_max_f32 v106, v104, v105
  s_add_u32 s61, s52, 40960
  buffer_load_dwordx4 a[60:63], v17, s[8:11], s61 offen
  v_mfma_f32_16x16x16_bf16 v[172:175], v[22:23], v[132:133], v[30:33]
  v_max3_f32 v112, v112, v113, v116
  v_max3_f32 v114, v114, v115, v118
  v_max_f32 v112, v112, v117
  v_mfma_f32_16x16x16_bf16 v[176:179], v[24:25], v[132:133], v[34:37]
  v_max_f32 v113, v114, v119
  v_mul_f32 v116, 0x3eb8aa3b, v68
  v_max_f32 v114, v112, v113
  v_mfma_f32_16x16x16_bf16 v[180:183], v[24:25], v[134:135], v[30:33]
  v_max3_f32 v156, v156, v157, v160
  v_max3_f32 v158, v158, v159, v162
  v_max_f32 v156, v156, v161
  v_mfma_f32_16x16x16_bf16 v[184:187], v[86:87], v[134:135], v[34:37]
  v_max_f32 v157, v158, v163
  s_add_u32 s61, s52, 65536
  buffer_load_dwordx4 a[64:67], v17, s[8:11], s61 offen
  v_mul_f32 v160, 0x3eb8aa3b, v70
  v_max_f32 v158, v156, v157
  v_max3_f32 v164, v164, v165, v168
  v_max3_f32 v172, v172, v173, v176
  s_nop 0
  v_max3_f32 v180, v180, v181, v184
  v_max3_f32 v166, v166, v167, v170
  v_max3_f32 v174, v174, v175, v178
  v_max3_f32 v182, v182, v183, v186
  v_max_f32 v164, v164, v169
  v_max_f32 v172, v172, v177
  v_max_f32 v180, v180, v185
  v_max_f32 v165, v166, v171
  v_max_f32 v173, v174, v179
  v_max_f32 v181, v182, v187
  v_mul_f32 v168, 0x3eb8aa3b, v72
  s_add_u32 s61, s52, 73728
  buffer_load_dwordx4 a[68:71], v17, s[8:11], s61 offen
  v_mul_f32 v176, 0x3eb8aa3b, v74
  v_mul_f32 v184, 0x3eb8aa3b, v76
  v_max_f32 v166, v164, v165
  v_max_f32 v174, v172, v173
  v_max_f32 v182, v180, v181
  v_permlane32_swap_b32 v90, v98
  v_permlane32_swap_b32 v158, v166
  v_permlane32_swap_b32 v106, v114
  v_permlane32_swap_b32 v174, v182
  v_max_f32 v90, v90, v98
  v_max_f32 v158, v158, v166
  v_max_f32 v106, v106, v114
  v_max_f32 v174, v174, v182
  s_nop 0
  v_permlane16_swap_b32 v90, v106
  v_permlane16_swap_b32 v158, v174
  s_add_u32 s61, s52, 98304
  buffer_load_dwordx4 a[72:75], v17, s[8:11], s61 offen
  v_max_f32 v90, v90, v106
  v_max_f32 v158, v158, v174
  v_mov_b32 v106, v90
  v_mov_b32 v174, v158
  s_nop 0
  v_permlane16_swap_b32 v90, v106
  v_permlane16_swap_b32 v158, v174
  v_mov_b32 v98, v90
  v_mov_b32 v166, v158
  v_mov_b32 v114, v106
  v_mov_b32 v182, v174
  v_permlane32_swap_b32 v90, v98
  v_permlane32_swap_b32 v158, v166
  v_permlane32_swap_b32 v106, v114
  v_permlane32_swap_b32 v174, v182
  s_add_u32 s61, s52, 106496
  buffer_load_dwordx4 a[76:79], v17, s[8:11], s61 offen
  v_mul_f32_e64 v93, -v90, v92
  v_mov_b32 v8, v26
  v_mul_f32_e64 v101, -v98, v100
  v_mov_b32 v9, v27
  v_fma_f32 v88, v88, v92, v93
  v_mov_b32 v10, v28
  v_fma_f32 v96, v96, v100, v101
  v_mov_b32 v11, v29
  v_fma_f32 v89, v89, v92, v93
  s_lshr_b32 s81, s71, 1
  v_fma_f32 v97, v97, v100, v101
  s_lshl_b32 s81, s81, 1
  v_exp_f32 v88, v88
  s_and_b32 s83, s68, 1
  v_exp_f32 v96, v96
  s_add_u32 s81, s81, s83
  v_exp_f32 v89, v89
  s_lshl_b32 s81, s81, 10
  v_exp_f32 v97, v97
  s_add_u32 s81, s81, 9502720
  v_cvt_pk_bf16_f32 v90, v88, v89
  v_and_b32 v16, 15, v1
  v_cvt_pk_bf16_f32 v98, v96, v97
  v_lshlrev_b32 v16, 3, v16
  v_perm_b32 v92, 0, v90, v54
  v_bfe_u32 v58, v1, 4, 1
  v_perm_b32 v100, 0, v98, v54
  v_lshl_add_u32 v16, v58, 9, v16
  v_perm_b32 v93, 0, v90, v55
  v_perm_b32 v101, 0, v98, v55
  s_lshl_b32 s82, s71, 1
  v_perm_b32 v94, 0, v90, v56
  s_lshr_b32 s83, s68, 1
  v_perm_b32 v102, 0, v98, v56
  s_add_u32 s82, s82, s83
  v_perm_b32 v95, 0, v90, v57
  s_lshl_b32 s59, s82, 5
  v_perm_b32 v103, 0, v98, v57
  s_mul_i32 s82, s82, 147456
  s_and_b32 s83, s68, 1
  v_mul_f32_e64 v109, -v106, v108
  s_lshl_b32 s48, s83, 14
  v_mul_f32_e64 v117, -v114, v116
  s_add_u32 s48, s48, s82
  v_mfma_f32_16x16x32_bf16 v[88:91], a[252:255], v[92:95], 0
  s_add_u32 s61, s52, 131072
  buffer_load_dwordx4 a[80:83], v17, s[8:11], s61 offen
  s_add_u32 s49, s48, 32768
  v_fma_f32 v104, v104, v108, v109
  s_lshl_b32 s50, s83, 15
  v_fma_f32 v112, v112, v116, v117
  s_add_u32 s50, s50, s82
  v_fma_f32 v105, v105, v108, v109
  s_add_u32 s50, s50, 65536
  v_mfma_f32_16x16x32_bf16 v[192:195], v[136:139], v[92:95], 0
  s_lshl_b32 s51, s83, 13
  v_fma_f32 v113, v113, v116, v117
  s_add_u32 s51, s51, s82
  v_exp_f32 v104, v104
  s_add_u32 s51, s51, 131072
  v_exp_f32 v112, v112
  v_lshlrev_b32 v2, 4, v1
  v_mfma_f32_16x16x32_bf16 v[96:99], a[252:255], v[100:103], 0
  v_exp_f32 v105, v105
  v_lshrrev_b32 v4, 2, v1
  v_exp_f32 v113, v113
  s_add_u32 s61, s52, 139264
  buffer_load_dwordx4 a[84:87], v17, s[8:11], s61 offen
  v_add_u32 v6, s59, v4
  v_cvt_pk_bf16_f32 v106, v104, v105
  v_and_b32 v5, 3, v1
  v_mfma_f32_16x16x32_bf16 v[196:199], v[138:141], v[100:103], 0
  v_lshlrev_b32 v3, 4, v5
  v_cvt_pk_bf16_f32 v114, v112, v113
  v_lshl_add_u32 v6, v6, 10, v3
  v_perm_b32 v108, 0, v106, v54
  s_lshl_b32 s82, s72, 7
  v_perm_b32 v116, 0, v114, v54
  s_lshl_b32 s83, s83, 6
  v_perm_b32 v109, 0, v106, v55
  s_add_u32 s82, s82, s83
  v_add_u32 v34, s82, v6
  v_perm_b32 v117, 0, v114, v55
  v_add_u32 v35, 0x4000, v34
  v_perm_b32 v110, 0, v106, v56
  buffer_load_dwordx4 v[36:39], v34, s[4:7], 0 offen
  v_perm_b32 v118, 0, v114, v56
  buffer_load_dwordx4 v[40:43], v35, s[4:7], 0 offen
  s_add_u32 s61, s52, 163840
  buffer_load_dwordx4 a[88:91], v17, s[8:11], s61 offen
  v_perm_b32 v111, 0, v106, v57
  v_perm_b32 v119, 0, v114, v57
  v_and_b32 v6, 31, v1
  v_mul_f32_e64 v161, -v158, v160
  v_add_u32 v3, s59, v6
  v_mul_f32_e64 v169, -v166, v168
  v_lshlrev_b32 v33, 4, v3
  v_mfma_f32_16x16x32_bf16 v[104:107], a[252:255], v[108:111], 0
  v_fma_f32 v156, v156, v160, v161
  v_add_u32 v24, s85, v2
  v_fma_f32 v164, v164, v168, v169
  v_add_u32 v25, 0x10000, v24
  v_fma_f32 v157, v157, v160, v161
  v_add_u32 v26, 0x20000, v24
  v_mfma_f32_16x16x32_bf16 v[200:203], v[140:143], v[108:111], 0
  v_xor_b32 v27, 0x800, v24
  v_fma_f32 v165, v165, v168, v169
  s_add_u32 s61, s52, 172032
  buffer_load_dwordx4 a[92:95], v17, s[8:11], s61 offen
  v_exp_f32 v156, v156
  v_lshrrev_b32 v3, 5, v1
  v_exp_f32 v164, v164
  v_bfe_u32 v29, v1, 1, 2
  v_mfma_f32_16x16x32_bf16 v[112:115], a[252:255], v[116:119], 0
  v_xor_b32 v3, v3, v29
  v_exp_f32 v157, v157
  v_lshlrev_b32 v3, 4, v3
  v_exp_f32 v165, v165
  v_lshl_add_u32 v3, v6, 6, v3
  v_cvt_pk_bf16_f32 v158, v156, v157
  s_add_u32 s82, s85, 57344
  v_add_u32 v29, s82, v3
  v_mfma_f32_16x16x32_bf16 v[204:207], v[142:145], v[116:119], 0
  v_xor_b32 v30, 32, v29
  v_cvt_pk_bf16_f32 v166, v164, v165
  v_bfe_u32 v3, v1, 3, 2
  v_perm_b32 v160, 0, v158, v54
  v_xor_b32 v3, v3, v5
  s_add_u32 s61, s52, 196608
  buffer_load_dwordx4 a[96:99], v17, s[8:11], s61 offen
  v_perm_b32 v168, 0, v166, v54
  v_lshlrev_b32 v3, 4, v3
  v_perm_b32 v161, 0, v158, v55
  v_lshl_add_u32 v3, v4, 6, v3
  v_perm_b32 v169, 0, v166, v55
  v_add_u32 v31, s82, v3
  v_perm_b32 v162, 0, v158, v56
  s_and_b32 s83, s68, 1
  v_perm_b32 v170, 0, v166, v56
  s_lshl_b32 s83, s83, 6
  v_perm_b32 v163, 0, v158, v57
  v_lshrrev_b32 v4, 5, v1
  v_perm_b32 v171, 0, v166, v57
  v_lshlrev_b32 v4, 10, v4
  v_rcp_f32 v88, v88
  v_bfe_u32 v6, v1, 2, 2
  v_rcp_f32 v96, v96
  v_lshl_add_u32 v4, v6, 7, v4
  v_mul_f32 v192, v192, v88
  v_lshrrev_b32 v6, 1, v6
  s_add_u32 s61, s52, 204800
  buffer_load_dwordx4 a[100:103], v17, s[8:11], s61 offen
  v_mul_f32 v196, v196, v96
  v_lshl_add_u32 v4, v6, 6, v4
  v_mul_f32 v193, v193, v88
  v_bfe_u32 v6, v1, 4, 1
  v_mul_f32 v197, v197, v96
  v_lshl_add_u32 v4, v6, 5, v4
  v_mul_f32 v194, v194, v88
  v_and_b32 v6, 1, v1
  v_mul_f32 v198, v198, v96
  v_lshl_add_u32 v4, v6, 4, v4
  v_mul_f32 v195, v195, v88
  v_bfe_u32 v6, v1, 1, 1
  v_lshl_add_u32 v4, v6, 3, v4
  v_mul_f32 v199, v199, v96
  v_xor_b32 v4, s83, v4
  v_cvt_pk_bf16_f32 v120, v192, v193
  s_lshl_b32 s83, s83, 5
  v_cvt_pk_bf16_f32 v122, v196, v197
  v_add_u32 v18, s83, v4
  v_cvt_pk_bf16_f32 v121, v194, v195
  buffer_load_dwordx2 v[58:59], v16, s[20:23], s81 offen offset:0 sc1
  v_xor_b32 v19, 64, v18
  v_cvt_pk_bf16_f32 v123, v198, v199
  v_add_u32 v20, 65536, v18
  v_permlane16_swap_b32 v120, v122
  v_add_u32 v21, 65536, v19
  v_permlane16_swap_b32 v121, v123
  v_add_u32 v22, 131072, v18
  buffer_store_dwordx4 v[120:123], v8, s[20:23], s89 offen sc1
  v_add_u32 v23, 131072, v19
  v_mul_f32_e64 v177, -v174, v176
  s_lshl_b32 s84, s69, 2
  v_mul_f32_e64 v185, -v182, v184
  s_lshr_b32 s83, s70, 2
  v_mfma_f32_16x16x32_bf16 v[156:159], a[252:255], v[160:163], 0
  s_add_u32 s84, s84, s83
  v_fma_f32 v172, v172, v176, v177
  s_lshl_b32 s84, s84, 6
  v_fma_f32 v180, v180, v184, v185
  s_and_b32 s83, s70, 3
  v_fma_f32 v173, v173, v176, v177
  s_add_u32 s61, s52, 229376
  buffer_load_dwordx4 a[104:107], v17, s[8:11], s61 offen
  s_lshl_b32 s83, s83, 2
  v_mfma_f32_16x16x32_bf16 v[208:211], v[144:147], v[160:163], 0
  s_add_u32 s84, s84, s83
  v_fma_f32 v181, v181, v184, v185
  s_add_u32 s84, s84, s68
  v_exp_f32 v172, v172
  s_lshl_b32 s84, s84, 3
  v_exp_f32 v180, v180
  s_add_u32 s84, s84, 9502848
  v_mfma_f32_16x16x32_bf16 v[164:167], a[252:255], v[168:171], 0
  s_lshl_b32 s83, s68, 27
  s_add_u32 s84, s84, s83
  v_exp_f32 v173, v173
  v_exp_f32 v181, v181
  v_cvt_pk_bf16_f32 v174, v172, v173
  v_mfma_f32_16x16x32_bf16 v[212:215], v[146:149], v[168:171], 0
  v_cvt_pk_bf16_f32 v182, v180, v181
  v_perm_b32 v176, 0, v174, v54
  v_perm_b32 v184, 0, v182, v54
  s_add_u32 s61, s52, 237568
  buffer_load_dwordx4 a[108:111], v17, s[8:11], s61 offen
  v_perm_b32 v177, 0, v174, v55
  v_perm_b32 v185, 0, v182, v55
  v_perm_b32 v178, 0, v174, v56
  v_perm_b32 v186, 0, v182, v56
  v_perm_b32 v179, 0, v174, v57
  v_perm_b32 v187, 0, v182, v57
  v_rcp_f32 v104, v104
  v_rcp_f32 v112, v112
  v_mfma_f32_16x16x32_bf16 v[172:175], a[252:255], v[176:179], 0
  v_mul_f32 v200, v200, v104
  v_mul_f32 v204, v204, v112
  v_mul_f32 v201, v201, v104
  v_mfma_f32_16x16x32_bf16 v[216:219], v[148:151], v[176:179], 0
  v_mul_f32 v205, v205, v112
  v_mul_f32 v202, v202, v104
  v_mul_f32 v206, v206, v112
  v_mfma_f32_16x16x32_bf16 v[180:183], a[252:255], v[184:187], 0
  v_mul_f32 v203, v203, v104
  v_mul_f32 v207, v207, v112
  v_cvt_pk_bf16_f32 v124, v200, v201
  v_mfma_f32_16x16x32_bf16 v[220:223], v[150:153], v[184:187], 0
  v_cvt_pk_bf16_f32 v126, v204, v205
  v_cvt_pk_bf16_f32 v125, v202, v203
  v_cvt_pk_bf16_f32 v127, v206, v207
  v_permlane16_swap_b32 v124, v126
  s_nop 0
  v_permlane16_swap_b32 v125, v127
  v_rcp_f32 v156, v156
  v_rcp_f32 v164, v164
  v_mul_f32 v208, v208, v156
  v_mul_f32 v212, v212, v164
  v_mul_f32 v209, v209, v156
  v_mul_f32 v213, v213, v164
  v_mul_f32 v210, v210, v156
  v_mul_f32 v214, v214, v164
  v_mul_f32 v211, v211, v156
  v_mul_f32 v215, v215, v164
  v_cvt_pk_bf16_f32 v128, v208, v209
  v_cvt_pk_bf16_f32 v130, v212, v213
  v_cvt_pk_bf16_f32 v129, v210, v211
  v_cvt_pk_bf16_f32 v131, v214, v215
  v_permlane16_swap_b32 v128, v130
  s_nop 0
  v_permlane16_swap_b32 v129, v131
  v_rcp_f32 v172, v172
  v_rcp_f32 v180, v180
  v_mul_f32 v216, v216, v172
  v_mul_f32 v220, v220, v180
  v_mul_f32 v217, v217, v172
  v_mul_f32 v221, v221, v180
  v_mul_f32 v218, v218, v172
  v_mul_f32 v222, v222, v180
  v_mul_f32 v219, v219, v172
  v_mul_f32 v223, v223, v180
  v_cvt_pk_bf16_f32 v132, v216, v217
  v_cvt_pk_bf16_f32 v134, v220, v221
  v_cvt_pk_bf16_f32 v133, v218, v219
  v_cvt_pk_bf16_f32 v135, v222, v223
  v_permlane16_swap_b32 v132, v134
  s_nop 0
  v_permlane16_swap_b32 v133, v135
  s_waitcnt vmcnt(48)
  buffer_store_dwordx4 v[124:127], v9, s[20:23], s89 offen sc1
  buffer_store_dwordx4 v[128:131], v10, s[20:23], s89 offen sc1
  buffer_store_dwordx4 v[132:135], v11, s[20:23], s89 offen sc1
  s_waitcnt vmcnt(6)
  s_branch L_join
L_t10:
  s_waitcnt vmcnt(15) lgkmcnt(0)
  s_barrier
  ds_read_b128 a[0:3], v18 offset:2048
  ds_read_b128 a[4:7], v18 offset:4096
  ds_read_b128 a[8:11], v18 offset:6144
  ds_read_b128 a[12:15], v18 offset:8192
  ds_read_b128 a[16:19], v20 offset:10240
  ds_read_b128 a[20:23], v20 offset:12288
  ds_read_b128 a[24:27], v20 offset:14336
  ds_read_b128 a[28:31], v20 offset:16384
  ds_read_b64_tr_b16 a[32:33], v22 offset:0
  ds_read_b64_tr_b16 a[34:35], v22 offset:512
  ds_read_b64_tr_b16 a[36:37], v22 offset:4096
  ds_read_b64_tr_b16 a[38:39], v22 offset:4608
  ds_read_b64_tr_b16 a[40:41], v22 offset:8192
  ds_read_b64_tr_b16 a[42:43], v22 offset:8704
  ds_read_b64_tr_b16 a[44:45], v22 offset:12288
  ds_read_b64_tr_b16 a[46:47], v22 offset:12800
  ds_read_b64_tr_b16 a[48:49], v24 offset:16384
  ds_read_b64_tr_b16 a[50:51], v24 offset:16640
  ds_read_b64_tr_b16 a[52:53], v24 offset:18432
  ds_read_b64_tr_b16 a[54:55], v24 offset:18688
  s_waitcnt vmcnt(8) lgkmcnt(0)
  s_barrier
  v_mfma_f32_16x16x32_bf16 v[96:99], a[32:35], a[0:3], 0
  ds_read_b128 a[56:59], v19 offset:2048
  s_add_u32 m0, s76, 40960
  v_mfma_f32_16x16x32_bf16 v[100:103], a[32:35], a[4:7], 0
  ds_read_b128 a[60:63], v19 offset:4096
  buffer_load_dwordx4 v12, s[28:31], s73 offen lds
  v_mfma_f32_16x16x32_bf16 v[104:107], a[32:35], a[8:11], 0
  ds_read_b128 a[64:67], v19 offset:6144
  s_add_u32 m0, s76, 45056
  v_mfma_f32_16x16x32_bf16 v[108:111], a[32:35], a[12:15], 0
  ds_read_b128 a[68:71], v19 offset:8192
  buffer_load_dwordx4 v13, s[32:35], s73 offen lds
  v_mfma_f32_16x16x32_bf16 v[112:115], a[32:35], a[16:19], 0
  ds_read_b128 a[72:75], v21 offset:10240
  s_add_u32 m0, s76, 49152
  v_mfma_f32_16x16x32_bf16 v[116:119], a[32:35], a[20:23], 0
  ds_read_b128 a[76:79], v21 offset:12288
  buffer_load_dwordx4 v14, s[36:39], s73 offen lds
  v_mfma_f32_16x16x32_bf16 v[120:123], a[32:35], a[24:27], 0
  ds_read_b128 a[80:83], v21 offset:14336
  s_add_u32 m0, s76, 53248
  v_mfma_f32_16x16x32_bf16 v[124:127], a[32:35], a[28:31], 0
  ds_read_b128 a[84:87], v21 offset:16384
  buffer_load_dwordx4 v15, s[40:43], s74 offen lds
  v_mfma_f32_16x16x32_bf16 a[228:231], a[32:35], a[252:255], 0
  ds_read_b64_tr_b16 a[88:89], v22 offset:20480
  s_add_u32 m0, s76, 57344
  v_mfma_f32_16x16x32_bf16 v[128:131], a[36:39], a[0:3], 0
  ds_read_b64_tr_b16 a[90:91], v22 offset:20992
  buffer_load_dwordx4 v16, s[44:47], s74 offen lds
  v_mfma_f32_16x16x32_bf16 v[132:135], a[36:39], a[4:7], 0
  ds_read_b64_tr_b16 a[92:93], v22 offset:24576
  s_add_u32 s73, s73, s75
  v_mfma_f32_16x16x32_bf16 v[136:139], a[36:39], a[8:11], 0
  ds_read_b64_tr_b16 a[94:95], v22 offset:25088
  s_add_u32 s74, s74, 114688
  v_mfma_f32_16x16x32_bf16 v[140:143], a[36:39], a[12:15], 0
  ds_read_b64_tr_b16 a[96:97], v22 offset:28672
  s_add_u32 m0, s76, 61440
  v_mfma_f32_16x16x32_bf16 v[144:147], a[36:39], a[16:19], 0
  ds_read_b64_tr_b16 a[98:99], v22 offset:29184
  buffer_load_dwordx4 v12, s[28:31], s73 offen lds
  v_mfma_f32_16x16x32_bf16 v[148:151], a[36:39], a[20:23], 0
  ds_read_b64_tr_b16 a[100:101], v22 offset:32768
  s_add_u32 m0, s76, 65536
  v_mfma_f32_16x16x32_bf16 v[152:155], a[36:39], a[24:27], 0
  ds_read_b64_tr_b16 a[102:103], v22 offset:33280
  buffer_load_dwordx4 v13, s[32:35], s73 offen lds
  v_mfma_f32_16x16x32_bf16 v[156:159], a[36:39], a[28:31], 0
  ds_read_b64_tr_b16 a[104:105], v24 offset:36864
  s_add_u32 m0, s76, 69632
  v_mfma_f32_16x16x32_bf16 a[232:235], a[36:39], a[252:255], 0
  ds_read_b64_tr_b16 a[106:107], v24 offset:37120
  buffer_load_dwordx4 v14, s[36:39], s73 offen lds
  v_mfma_f32_16x16x32_bf16 v[160:163], a[40:43], a[0:3], 0
  ds_read_b64_tr_b16 a[108:109], v24 offset:38912
  s_add_u32 m0, s76, 73728
  v_mfma_f32_16x16x32_bf16 v[164:167], a[40:43], a[4:7], 0
  ds_read_b64_tr_b16 a[110:111], v24 offset:39168
  buffer_load_dwordx4 v15, s[40:43], s74 offen lds
  v_mfma_f32_16x16x32_bf16 v[168:171], a[40:43], a[8:11], 0
  s_add_u32 m0, s76, 77824
  s_nop 0
  buffer_load_dwordx4 v16, s[44:47], s74 offen lds
  v_mfma_f32_16x16x32_bf16 v[172:175], a[40:43], a[12:15], 0
  s_add_u32 s73, s73, s75
  s_add_u32 s74, s74, 114688
  v_mfma_f32_16x16x32_bf16 v[176:179], a[40:43], a[16:19], 0
  s_cmp_eq_u32 s74, 1835008
  s_cselect_b32 s73, 0, s73
  s_cselect_b32 s74, 0, s74
  v_mfma_f32_16x16x32_bf16 v[180:183], a[40:43], a[20:23], 0
  s_add_u32 s92, s93, 0
  s_add_u32 m0, s77, 139264
  v_mfma_f32_16x16x32_bf16 v[184:187], a[40:43], a[24:27], 0
  buffer_load_dwordx4 v8, s[4:7], s92 offen lds
  s_lshl_b32 s84, s69, 7
  v_mfma_f32_16x16x32_bf16 v[188:191], a[40:43], a[28:31], 0
  s_lshl_b32 s83, s70, 3
  s_add_u32 s83, s83, s84
  v_mfma_f32_16x16x32_bf16 a[236:239], a[40:43], a[252:255], 0
  s_lshl_b32 s84, s68, 1
  s_add_u32 s83, s83, s84
  v_mfma_f32_16x16x32_bf16 v[192:195], a[44:47], a[0:3], 0
  s_lshl_b32 s83, s83, 10
  v_lshlrev_b32 v76, 4, v1
  v_mfma_f32_16x16x32_bf16 v[196:199], a[44:47], a[4:7], 0
  buffer_load_dwordx4 v[60:63], v76, s[4:7], s83 offen
  buffer_load_dwordx4 v[64:67], v76, s[4:7], s83 offen offset:1024
  v_mfma_f32_16x16x32_bf16 v[200:203], a[44:47], a[8:11], 0
  v_add_u32 v44, 2, v44
  v_and_b32 v44, 15, v44
  v_mfma_f32_16x16x32_bf16 v[204:207], a[44:47], a[12:15], 0
  v_lshl_add_u32 v48, v44, 5, v45
  v_mfma_f32_16x16x32_bf16 v[208:211], a[44:47], a[16:19], 0
  v_mad_u32_u24 v49, v48, s86, v46
  v_mad_u32_u24 v48, v48, s87, v47
  v_mfma_f32_16x16x32_bf16 v[212:215], a[44:47], a[20:23], 0
  buffer_load_dword a220, v49, s[88:91], s54 offen
  v_mfma_f32_16x16x32_bf16 v[216:219], a[44:47], a[24:27], 0
  buffer_load_dword a221, v48, s[44:47], s55 offen
  v_mfma_f32_16x16x32_bf16 v[220:223], a[44:47], a[28:31], 0
  s_mov_b32 s8, s52
  s_mov_b32 s9, s53
  v_mfma_f32_16x16x32_bf16 a[240:243], a[44:47], a[252:255], 0
  s_mov_b32 s10, 524288
  v_mfma_f32_16x16x32_bf16 v[224:227], a[48:51], a[0:3], 0
  s_mov_b32 s11, 0x20000
  v_mfma_f32_16x16x32_bf16 v[228:231], a[48:51], a[4:7], 0
  s_mov_b32 s12, s60
  s_mov_b32 s13, s61
  v_mfma_f32_16x16x32_bf16 v[232:235], a[48:51], a[8:11], 0
  s_mov_b32 s14, 1835008
  v_mfma_f32_16x16x32_bf16 v[236:239], a[48:51], a[12:15], 0
  s_mov_b32 s15, 0x20000
  v_mfma_f32_16x16x32_bf16 a[244:247], a[48:51], a[252:255], 0
  s_mov_b32 s20, s66
  s_mov_b32 s21, s67
  v_mfma_f32_16x16x32_bf16 v[240:243], a[52:55], a[0:3], 0
  s_mov_b32 s22, 9568256
  v_mfma_f32_16x16x32_bf16 v[244:247], a[52:55], a[4:7], 0
  s_mov_b32 s23, 0x20000
  v_mfma_f32_16x16x32_bf16 v[248:251], a[52:55], a[8:11], 0
  s_mov_b32 s16, s62
  s_mov_b32 s17, s63
  v_mfma_f32_16x16x32_bf16 v[252:255], a[52:55], a[12:15], 0
  s_mov_b32 s18, 2097152
  v_mfma_f32_16x16x32_bf16 a[248:251], a[52:55], a[252:255], 0
  s_mov_b32 s19, 0x20000
  s_waitcnt vmcnt(10) lgkmcnt(0)
  s_barrier
  v_mfma_f32_16x16x32_bf16 v[96:99], a[88:91], a[56:59], v[96:99]
  ds_read_b128 a[0:3], v18 offset:20480
  s_add_u32 m0, s77, 140288
  v_mfma_f32_16x16x32_bf16 v[100:103], a[88:91], a[60:63], v[100:103]
  ds_read_b128 a[4:7], v18 offset:22528
  buffer_load_dwordx4 v9, s[4:7], s92 offen lds
  v_mfma_f32_16x16x32_bf16 v[104:107], a[88:91], a[64:67], v[104:107]
  ds_read_b128 a[8:11], v18 offset:24576
  v_mov_b32 v56, 0
  v_mfma_f32_16x16x32_bf16 v[108:111], a[88:91], a[68:71], v[108:111]
  ds_read_b128 a[12:15], v18 offset:26624
  buffer_load_dwordx2 v[56:57], v56, s[24:27], 0 offen sc1
  v_mfma_f32_16x16x32_bf16 v[112:115], a[88:91], a[72:75], v[112:115]
  ds_read_b128 a[16:19], v20 offset:28672
  s_add_u32 s92, s93, 16384
  v_mfma_f32_16x16x32_bf16 v[116:119], a[88:91], a[76:79], v[116:119]
  ds_read_b128 a[20:23], v20 offset:30720
  s_add_u32 m0, s77, 141312
  v_mfma_f32_16x16x32_bf16 v[120:123], a[88:91], a[80:83], v[120:123]
  ds_read_b128 a[24:27], v20 offset:32768
  buffer_load_dwordx4 v8, s[4:7], s92 offen lds
  v_mfma_f32_16x16x32_bf16 v[124:127], a[88:91], a[84:87], v[124:127]
  ds_read_b128 a[28:31], v20 offset:34816
  v_add_u32 v44, 2, v44
  v_mfma_f32_16x16x32_bf16 a[228:231], a[88:91], a[252:255], a[228:231]
  ds_read_b64_tr_b16 a[32:33], v22 offset:40960
  v_and_b32 v44, 15, v44
  v_mfma_f32_16x16x32_bf16 v[128:131], a[92:95], a[56:59], v[128:131]
  ds_read_b64_tr_b16 a[34:35], v22 offset:41472
  s_add_u32 m0, s77, 142336
  v_mfma_f32_16x16x32_bf16 v[132:135], a[92:95], a[60:63], v[132:135]
  ds_read_b64_tr_b16 a[36:37], v22 offset:45056
  buffer_load_dwordx4 v9, s[4:7], s92 offen lds
  v_mfma_f32_16x16x32_bf16 v[136:139], a[92:95], a[64:67], v[136:139]
  ds_read_b64_tr_b16 a[38:39], v22 offset:45568
  s_add_u32 s93, s93, 128
  v_mfma_f32_16x16x32_bf16 v[140:143], a[92:95], a[68:71], v[140:143]
  ds_read_b64_tr_b16 a[40:41], v22 offset:49152
  s_and_b32 s93, s93, 1023
  v_mfma_f32_16x16x32_bf16 v[144:147], a[92:95], a[72:75], v[144:147]
  ds_read_b64_tr_b16 a[42:43], v22 offset:49664
  v_lshl_add_u32 v48, v44, 5, v45
  v_mfma_f32_16x16x32_bf16 v[148:151], a[92:95], a[76:79], v[148:151]
  ds_read_b64_tr_b16 a[44:45], v22 offset:53248
  v_mad_u32_u24 v49, v48, s86, v46
  v_mfma_f32_16x16x32_bf16 v[152:155], a[92:95], a[80:83], v[152:155]
  ds_read_b64_tr_b16 a[46:47], v22 offset:53760
  v_mad_u32_u24 v48, v48, s87, v47
  v_mfma_f32_16x16x32_bf16 v[156:159], a[92:95], a[84:87], v[156:159]
  ds_read_b64_tr_b16 a[48:49], v24 offset:57344
  s_add_u32 m0, s76, 81920
  v_mfma_f32_16x16x32_bf16 a[232:235], a[92:95], a[252:255], a[232:235]
  ds_read_b64_tr_b16 a[50:51], v24 offset:57600
  buffer_load_dwordx4 v12, s[28:31], s73 offen lds
  v_mfma_f32_16x16x32_bf16 v[160:163], a[96:99], a[56:59], v[160:163]
  ds_read_b64_tr_b16 a[52:53], v24 offset:59392
  buffer_load_dword a222, v49, s[88:91], s54 offen
  v_mfma_f32_16x16x32_bf16 v[164:167], a[96:99], a[60:63], v[164:167]
  ds_read_b64_tr_b16 a[54:55], v24 offset:59648
  buffer_load_dword a223, v48, s[44:47], s55 offen
  v_mfma_f32_16x16x32_bf16 v[168:171], a[96:99], a[64:67], v[168:171]
  s_lshr_b32 s83, s2, 3
  s_add_u32 m0, s76, 86016
  v_mfma_f32_16x16x32_bf16 v[172:175], a[96:99], a[68:71], v[172:175]
  buffer_load_dwordx4 v13, s[32:35], s73 offen lds
  s_and_b32 s84, s2, 7
  v_mfma_f32_16x16x32_bf16 v[176:179], a[96:99], a[72:75], v[176:179]
  s_lshr_b32 s71, s84, 1
  s_lshl_b32 s71, s71, 3
  v_mfma_f32_16x16x32_bf16 v[180:183], a[96:99], a[76:79], v[180:183]
  s_add_u32 m0, s76, 90112
  s_nop 0
  buffer_load_dwordx4 v14, s[36:39], s73 offen lds
  v_mfma_f32_16x16x32_bf16 v[184:187], a[96:99], a[80:83], v[184:187]
  s_lshr_b32 s64, s83, 2
  v_mfma_f32_16x16x32_bf16 v[188:191], a[96:99], a[84:87], v[188:191]
  s_add_u32 s71, s71, s64
  v_mfma_f32_16x16x32_bf16 a[236:239], a[96:99], a[252:255], a[236:239]
  s_and_b32 s72, s83, 3
  v_mfma_f32_16x16x32_bf16 v[192:195], a[100:103], a[56:59], v[192:195]
  s_add_u32 m0, s76, 94208
  v_mfma_f32_16x16x32_bf16 v[196:199], a[100:103], a[60:63], v[196:199]
  buffer_load_dwordx4 v15, s[40:43], s74 offen lds
  v_mfma_f32_16x16x32_bf16 v[200:203], a[100:103], a[64:67], v[200:203]
  s_and_b32 s84, s84, 1
  v_mfma_f32_16x16x32_bf16 v[204:207], a[100:103], a[68:71], v[204:207]
  s_xor_b32 s84, s84, 0
  s_add_u32 m0, s76, 98304
  v_mfma_f32_16x16x32_bf16 v[208:211], a[100:103], a[72:75], v[208:211]
  buffer_load_dwordx4 v16, s[44:47], s74 offen lds
  v_mfma_f32_16x16x32_bf16 v[212:215], a[100:103], a[76:79], v[212:215]
  s_add_u32 s73, s73, s75
  v_mfma_f32_16x16x32_bf16 v[216:219], a[100:103], a[80:83], v[216:219]
  s_add_u32 s74, s74, 114688
  v_mfma_f32_16x16x32_bf16 v[220:223], a[100:103], a[84:87], v[220:223]
  s_lshl_b32 s84, s84, 2
  v_mfma_f32_16x16x32_bf16 a[240:243], a[100:103], a[252:255], a[240:243]
  s_add_u32 s72, s72, s84
  v_mfma_f32_16x16x32_bf16 v[224:227], a[104:107], a[56:59], v[224:227]
  s_lshl_b32 s85, s68, 11
  v_mfma_f32_16x16x32_bf16 v[228:231], a[104:107], a[60:63], v[228:231]
  s_add_u32 m0, s76, 0
  v_mfma_f32_16x16x32_bf16 v[232:235], a[104:107], a[64:67], v[232:235]
  buffer_load_dwordx4 v12, s[28:31], s73 offen lds
  s_mul_i32 s62, s72, 0
  v_mfma_f32_16x16x32_bf16 v[236:239], a[104:107], a[68:71], v[236:239]
  s_mul_i32 s63, s71, 1
  v_mfma_f32_16x16x32_bf16 a[244:247], a[104:107], a[252:255], a[244:247]
  s_add_u32 s62, s62, s63
  v_mfma_f32_16x16x32_bf16 v[240:243], a[108:111], a[56:59], v[240:243]
  s_add_u32 m0, s76, 4096
  v_mfma_f32_16x16x32_bf16 v[244:247], a[108:111], a[60:63], v[244:247]
  buffer_load_dwordx4 v13, s[32:35], s73 offen lds
  v_mfma_f32_16x16x32_bf16 v[248:251], a[108:111], a[64:67], v[248:251]
  s_and_b32 s62, s62, 7
  v_mfma_f32_16x16x32_bf16 v[252:255], a[108:111], a[68:71], v[252:255]
  s_lshl_b32 s63, s62, 12
  v_mfma_f32_16x16x32_bf16 a[248:251], a[108:111], a[252:255], a[248:251]
  s_lshl_b32 s62, s62, 16
  s_waitcnt vmcnt(15) lgkmcnt(0)
  s_barrier
  v_mfma_f32_16x16x32_bf16 v[96:99], a[32:35], a[0:3], v[96:99]
  ds_read_b128 a[56:59], v19 offset:20480
  s_and_b32 s65, s70, 7
  v_mfma_f32_16x16x32_bf16 v[100:103], a[32:35], a[4:7], v[100:103]
  ds_read_b128 a[60:63], v19 offset:22528
  s_lshl_b32 s65, s65, 2
  v_mfma_f32_16x16x32_bf16 v[104:107], a[32:35], a[8:11], v[104:107]
  ds_read_b128 a[64:67], v19 offset:24576
  s_add_u32 m0, s76, 8192
  v_mfma_f32_16x16x32_bf16 v[108:111], a[32:35], a[12:15], v[108:111]
  ds_read_b128 a[68:71], v19 offset:26624
  buffer_load_dwordx4 v14, s[36:39], s73 offen lds
  v_mfma_f32_16x16x32_bf16 v[112:115], a[32:35], a[16:19], v[112:115]
  ds_read_b128 a[72:75], v21 offset:28672
  s_lshr_b32 s64, 0x11061133, s65
  v_mfma_f32_16x16x32_bf16 v[116:119], a[32:35], a[20:23], v[116:119]
  ds_read_b128 a[76:79], v21 offset:30720
  s_and_b32 s64, s64, 15
  v_mfma_f32_16x16x32_bf16 v[120:123], a[32:35], a[24:27], v[120:123]
  ds_read_b128 a[80:83], v21 offset:32768
  s_lshr_b32 s65, 0x76607630, s65
  v_mfma_f32_16x16x32_bf16 v[124:127], a[32:35], a[28:31], v[124:127]
  ds_read_b128 a[84:87], v21 offset:34816
  s_and_b32 s65, s65, 15
  v_mfma_f32_16x16x32_bf16 a[228:231], a[32:35], a[252:255], a[228:231]
  ds_read_b64_tr_b16 a[88:89], v23 offset:0
  s_lshr_b32 s59, s2, 5
  v_mfma_f32_16x16x32_bf16 v[128:131], a[36:39], a[0:3], v[128:131]
  ds_read_b64_tr_b16 a[90:91], v23 offset:512
  s_lshl_b32 s59, s59, 2
  v_mfma_f32_16x16x32_bf16 v[132:135], a[36:39], a[4:7], v[132:135]
  ds_read_b64_tr_b16 a[92:93], v23 offset:4096
  s_add_u32 s59, s59, s68
  v_mfma_f32_16x16x32_bf16 v[136:139], a[36:39], a[8:11], v[136:139]
  ds_read_b64_tr_b16 a[94:95], v23 offset:4608
  s_add_u32 m0, s76, 12288
  v_mfma_f32_16x16x32_bf16 v[140:143], a[36:39], a[12:15], v[140:143]
  ds_read_b64_tr_b16 a[96:97], v23 offset:8192
  buffer_load_dwordx4 v15, s[40:43], s74 offen lds
  v_mfma_f32_16x16x32_bf16 v[144:147], a[36:39], a[16:19], v[144:147]
  ds_read_b64_tr_b16 a[98:99], v23 offset:8704
  s_lshl_b32 s59, s59, 3
  v_mfma_f32_16x16x32_bf16 v[148:151], a[36:39], a[20:23], v[148:151]
  ds_read_b64_tr_b16 a[100:101], v23 offset:12288
  s_add_u32 s59, s59, s65
  v_mfma_f32_16x16x32_bf16 v[152:155], a[36:39], a[24:27], v[152:155]
  ds_read_b64_tr_b16 a[102:103], v23 offset:12800
  s_lshl_b32 s59, s59, 10
  v_mfma_f32_16x16x32_bf16 v[156:159], a[36:39], a[28:31], v[156:159]
  ds_read_b64_tr_b16 a[104:105], v25 offset:16384
  s_and_b32 s65, s2, 1
  v_mfma_f32_16x16x32_bf16 a[232:235], a[36:39], a[252:255], a[232:235]
  ds_read_b64_tr_b16 a[106:107], v25 offset:16640
  s_lshl_b32 s65, s65, 9
  v_mfma_f32_16x16x32_bf16 v[160:163], a[40:43], a[0:3], v[160:163]
  ds_read_b64_tr_b16 a[108:109], v25 offset:18432
  s_add_u32 m0, s76, 16384
  v_mfma_f32_16x16x32_bf16 v[164:167], a[40:43], a[4:7], v[164:167]
  ds_read_b64_tr_b16 a[110:111], v25 offset:18688
  buffer_load_dwordx4 v16, s[44:47], s74 offen lds
  v_mfma_f32_16x16x32_bf16 v[168:171], a[40:43], a[8:11], v[168:171]
  s_add_u32 s73, s73, s75
  s_add_u32 s74, s74, 114688
  v_mfma_f32_16x16x32_bf16 v[172:175], a[40:43], a[12:15], v[172:175]
  s_add_u32 s59, s59, s65
  v_and_b32 v2, 3, v1
  v_mfma_f32_16x16x32_bf16 v[176:179], a[40:43], a[16:19], v[176:179]
  v_lshlrev_b32 v2, 7, v2
  v_lshrrev_b32 v3, 2, v1
  v_mfma_f32_16x16x32_bf16 v[180:183], a[40:43], a[20:23], v[180:183]
  v_cmp_le_u32 vcc, s64, v3
  v_lshl_add_u32 v2, v3, 10, v2
  v_mfma_f32_16x16x32_bf16 v[184:187], a[40:43], a[24:27], v[184:187]
  s_add_u32 s92, s93, 0
  s_add_u32 m0, s77, 102400
  v_mfma_f32_16x16x32_bf16 v[188:191], a[40:43], a[28:31], v[188:191]
  buffer_load_dwordx4 v8, s[4:7], s92 offen lds
  v_add_u32 v2, s59, v2
  v_mfma_f32_16x16x32_bf16 a[236:239], a[40:43], a[252:255], a[236:239]
  v_mov_b32 v3, 0x80000000
  v_cndmask_b32 v2, v2, v3, vcc
  v_mfma_f32_16x16x32_bf16 v[192:195], a[44:47], a[0:3], v[192:195]
  s_lshr_b32 s59, s2, 1
  s_add_u32 s65, s59, 0
  v_mfma_f32_16x16x32_bf16 v[196:199], a[44:47], a[4:7], v[196:199]
  s_and_b32 s65, s65, 3
  s_lshl_b32 s65, s65, 18
  v_mfma_f32_16x16x32_bf16 v[200:203], a[44:47], a[8:11], v[200:203]
  s_add_u32 m0, s77, 103424
  s_nop 0
  buffer_load_dwordx4 v9, s[4:7], s92 offen lds
  v_mfma_f32_16x16x32_bf16 v[204:207], a[44:47], a[12:15], v[204:207]
  s_add_u32 s65, s65, 524288
  buffer_load_dword a216, v2, s[12:15], s65 offen
  v_mfma_f32_16x16x32_bf16 v[208:211], a[44:47], a[16:19], v[208:211]
  v_lshlrev_b32 v68, 16, v60
  v_lshlrev_b32 v76, 16, v64
  v_mfma_f32_16x16x32_bf16 v[212:215], a[44:47], a[20:23], v[212:215]
  v_and_b32 v69, 0xffff0000, v60
  v_and_b32 v77, 0xffff0000, v64
  v_mfma_f32_16x16x32_bf16 v[216:219], a[44:47], a[24:27], v[216:219]
  v_lshlrev_b32 v70, 16, v61
  s_add_u32 s92, s93, 16384
  v_mfma_f32_16x16x32_bf16 v[220:223], a[44:47], a[28:31], v[220:223]
  s_add_u32 m0, s77, 104448
  s_nop 0
  buffer_load_dwordx4 v8, s[4:7], s92 offen lds
  v_mfma_f32_16x16x32_bf16 a[240:243], a[44:47], a[252:255], a[240:243]
  v_lshlrev_b32 v78, 16, v65
  v_and_b32 v71, 0xffff0000, v61
  v_mfma_f32_16x16x32_bf16 v[224:227], a[48:51], a[0:3], v[224:227]
  v_and_b32 v79, 0xffff0000, v65
  v_lshlrev_b32 v72, 16, v62
  v_mfma_f32_16x16x32_bf16 v[228:231], a[48:51], a[4:7], v[228:231]
  v_lshlrev_b32 v80, 16, v66
  s_add_u32 m0, s77, 105472
  v_mfma_f32_16x16x32_bf16 v[232:235], a[48:51], a[8:11], v[232:235]
  buffer_load_dwordx4 v9, s[4:7], s92 offen lds
  s_add_u32 s93, s93, 128
  v_mfma_f32_16x16x32_bf16 v[236:239], a[48:51], a[12:15], v[236:239]
  s_and_b32 s93, s93, 1023
  v_and_b32 v73, 0xffff0000, v62
  v_mfma_f32_16x16x32_bf16 a[244:247], a[48:51], a[252:255], a[244:247]
  v_and_b32 v81, 0xffff0000, v66
  v_lshlrev_b32 v74, 16, v63
  v_mfma_f32_16x16x32_bf16 v[240:243], a[52:55], a[0:3], v[240:243]
  v_lshlrev_b32 v82, 16, v67
  v_and_b32 v75, 0xffff0000, v63
  v_mfma_f32_16x16x32_bf16 v[244:247], a[52:55], a[4:7], v[244:247]
  v_and_b32 v83, 0xffff0000, v67
  v_add_f32 v60, v68, v69
  v_mfma_f32_16x16x32_bf16 v[248:251], a[52:55], a[8:11], v[248:251]
  s_add_u32 m0, s76, 20480
  s_nop 0
  buffer_load_dwordx4 v12, s[28:31], s73 offen lds
  v_mfma_f32_16x16x32_bf16 v[252:255], a[52:55], a[12:15], v[252:255]
  v_add_f32 v64, v76, v77
  v_add_f32 v61, v70, v71
  v_mfma_f32_16x16x32_bf16 a[248:251], a[52:55], a[252:255], a[248:251]
  v_add_f32 v65, v78, v79
  v_add_f32 v62, v72, v73
  v_add_f32 v66, v80, v81
  v_add_f32 v63, v74, v75
  v_add_f32 v67, v82, v83
  s_add_u32 m0, s76, 24576
  s_nop 0
  buffer_load_dwordx4 v13, s[32:35], s73 offen lds
  v_add_f32 v60, v60, v61
  v_add_f32 v64, v64, v65
  v_add_f32 v62, v62, v63
  v_add_f32 v66, v66, v67
  v_add_f32 v60, v60, v62
  v_add_f32 v64, v64, v66
  s_nop 0
  v_add_f32_dpp v60, v60, v60 row_ror:8 row_mask:0xf bank_mask:0xf
  s_add_u32 m0, s76, 28672
  s_nop 0
  buffer_load_dwordx4 v14, s[36:39], s73 offen lds
  v_add_f32_dpp v64, v64, v64 row_ror:8 row_mask:0xf bank_mask:0xf
  v_add_f32_dpp v60, v60, v60 row_ror:4 row_mask:0xf bank_mask:0xf
  s_nop 0
  v_add_f32_dpp v64, v64, v64 row_ror:4 row_mask:0xf bank_mask:0xf
  v_add_f32_dpp v60, v60, v60 row_ror:2 row_mask:0xf bank_mask:0xf
  s_nop 0
  v_add_f32_dpp v64, v64, v64 row_ror:2 row_mask:0xf bank_mask:0xf
  s_waitcnt vmcnt(13) lgkmcnt(0)
  s_barrier
  v_mfma_f32_16x16x32_bf16 v[96:99], a[88:91], a[56:59], v[96:99]
  ds_read_b128 a[0:3], v18 offset:38912
  s_add_u32 m0, s76, 32768
  v_mfma_f32_16x16x32_bf16 v[100:103], a[88:91], a[60:63], v[100:103]
  ds_read_b128 a[4:7], v18 offset:40960
  buffer_load_dwordx4 v15, s[40:43], s74 offen lds
  v_mfma_f32_16x16x32_bf16 v[104:107], a[88:91], a[64:67], v[104:107]
  ds_read_b128 a[8:11], v18 offset:43008
  s_add_u32 s65, s59, 1
  v_mfma_f32_16x16x32_bf16 v[108:111], a[88:91], a[68:71], v[108:111]
  ds_read_b128 a[12:15], v18 offset:45056
  s_add_u32 m0, s76, 36864
  v_mfma_f32_16x16x32_bf16 v[112:115], a[88:91], a[72:75], v[112:115]
  ds_read_b128 a[16:19], v20 offset:47104
  buffer_load_dwordx4 v16, s[44:47], s74 offen lds
  v_mfma_f32_16x16x32_bf16 v[116:119], a[88:91], a[76:79], v[116:119]
  ds_read_b128 a[20:23], v20 offset:49152
  s_add_u32 s73, s73, s75
  v_mfma_f32_16x16x32_bf16 v[120:123], a[88:91], a[80:83], v[120:123]
  ds_read_b128 a[24:27], v20 offset:51200
  s_add_u32 s74, s74, 114688
  v_mfma_f32_16x16x32_bf16 v[124:127], a[88:91], a[84:87], v[124:127]
  ds_read_b128 a[28:31], v20 offset:53248
  s_and_b32 s65, s65, 3
  v_mfma_f32_16x16x32_bf16 a[228:231], a[88:91], a[252:255], a[228:231]
  ds_read_b64_tr_b16 a[32:33], v23 offset:20480
  s_lshl_b32 s65, s65, 18
  v_mfma_f32_16x16x32_bf16 v[128:131], a[92:95], a[56:59], v[128:131]
  ds_read_b64_tr_b16 a[34:35], v23 offset:20992
  s_add_u32 s65, s65, 524288
  v_mfma_f32_16x16x32_bf16 v[132:135], a[92:95], a[60:63], v[132:135]
  ds_read_b64_tr_b16 a[36:37], v23 offset:24576
  buffer_load_dword a217, v2, s[12:15], s65 offen
  v_mfma_f32_16x16x32_bf16 v[136:139], a[92:95], a[64:67], v[136:139]
  ds_read_b64_tr_b16 a[38:39], v23 offset:25088
  s_add_u32 m0, s76, 40960
  v_mfma_f32_16x16x32_bf16 v[140:143], a[92:95], a[68:71], v[140:143]
  ds_read_b64_tr_b16 a[40:41], v23 offset:28672
  buffer_load_dwordx4 v12, s[28:31], s73 offen lds
  v_mfma_f32_16x16x32_bf16 v[144:147], a[92:95], a[72:75], v[144:147]
  ds_read_b64_tr_b16 a[42:43], v23 offset:29184
  v_add_f32_dpp v60, v60, v60 row_ror:1 row_mask:0xf bank_mask:0xf
  v_mfma_f32_16x16x32_bf16 v[148:151], a[92:95], a[76:79], v[148:151]
  ds_read_b64_tr_b16 a[44:45], v23 offset:32768
  v_add_f32_dpp v64, v64, v64 row_ror:1 row_mask:0xf bank_mask:0xf
  v_mfma_f32_16x16x32_bf16 v[152:155], a[92:95], a[80:83], v[152:155]
  ds_read_b64_tr_b16 a[46:47], v23 offset:33280
  v_mov_b32 v61, v60
  v_mfma_f32_16x16x32_bf16 v[156:159], a[92:95], a[84:87], v[156:159]
  ds_read_b64_tr_b16 a[48:49], v25 offset:36864
  s_add_u32 m0, s76, 45056
  v_mfma_f32_16x16x32_bf16 a[232:235], a[92:95], a[252:255], a[232:235]
  ds_read_b64_tr_b16 a[50:51], v25 offset:37120
  buffer_load_dwordx4 v13, s[32:35], s73 offen lds
  v_mfma_f32_16x16x32_bf16 v[160:163], a[96:99], a[56:59], v[160:163]
  ds_read_b64_tr_b16 a[52:53], v25 offset:38912
  v_mov_b32 v65, v64
  v_mfma_f32_16x16x32_bf16 v[164:167], a[96:99], a[60:63], v[164:167]
  ds_read_b64_tr_b16 a[54:55], v25 offset:39168
  v_permlane16_swap_b32 v60, v61
  v_mfma_f32_16x16x32_bf16 v[168:171], a[96:99], a[64:67], v[168:171]
  v_permlane16_swap_b32 v64, v65
  s_add_u32 m0, s76, 49152
  v_mfma_f32_16x16x32_bf16 v[172:175], a[96:99], a[68:71], v[172:175]
  buffer_load_dwordx4 v14, s[36:39], s73 offen lds
  v_add_f32 v60, v60, v61
  v_mfma_f32_16x16x32_bf16 v[176:179], a[96:99], a[72:75], v[176:179]
  v_add_f32 v64, v64, v65
  v_mov_b32 v61, v60
  v_mfma_f32_16x16x32_bf16 v[180:183], a[96:99], a[76:79], v[180:183]
  s_add_u32 m0, s76, 53248
  s_nop 0
  buffer_load_dwordx4 v15, s[40:43], s74 offen lds
  v_mfma_f32_16x16x32_bf16 v[184:187], a[96:99], a[80:83], v[184:187]
  s_add_u32 m0, s76, 57344
  s_nop 0
  buffer_load_dwordx4 v16, s[44:47], s74 offen lds
  v_mfma_f32_16x16x32_bf16 v[188:191], a[96:99], a[84:87], v[188:191]
  s_add_u32 s73, s73, s75
  v_mfma_f32_16x16x32_bf16 a[236:239], a[96:99], a[252:255], a[236:239]
  s_add_u32 s74, s74, 114688
  v_mfma_f32_16x16x32_bf16 v[192:195], a[100:103], a[56:59], v[192:195]
  s_cmp_eq_u32 s74, 1835008
  s_cselect_b32 s73, 0, s73
  s_cselect_b32 s74, 0, s74
  v_mfma_f32_16x16x32_bf16 v[196:199], a[100:103], a[60:63], v[196:199]
  v_mfma_f32_16x16x32_bf16 v[200:203], a[100:103], a[64:67], v[200:203]
  v_mov_b32 v65, v64
  v_mfma_f32_16x16x32_bf16 v[204:207], a[100:103], a[68:71], v[204:207]
  v_permlane32_swap_b32 v60, v61
  v_mfma_f32_16x16x32_bf16 v[208:211], a[100:103], a[72:75], v[208:211]
  v_permlane32_swap_b32 v64, v65
  v_mfma_f32_16x16x32_bf16 v[212:215], a[100:103], a[76:79], v[212:215]
  s_add_u32 s92, s93, 0
  v_mfma_f32_16x16x32_bf16 v[216:219], a[100:103], a[80:83], v[216:219]
  s_add_u32 m0, s77, 120832
  v_mfma_f32_16x16x32_bf16 v[220:223], a[100:103], a[84:87], v[220:223]
  buffer_load_dwordx4 v8, s[4:7], s92 offen lds
  v_add_f32 v60, v60, v61
  v_mfma_f32_16x16x32_bf16 a[240:243], a[100:103], a[252:255], a[240:243]
  v_add_f32 v64, v64, v65
  v_mfma_f32_16x16x32_bf16 v[224:227], a[104:107], a[56:59], v[224:227]
  v_mul_f32 v85, 0x3b000000, v60
  v_mfma_f32_16x16x32_bf16 v[228:231], a[104:107], a[60:63], v[228:231]
  s_add_u32 m0, s77, 121856
  v_mfma_f32_16x16x32_bf16 v[232:235], a[104:107], a[64:67], v[232:235]
  buffer_load_dwordx4 v9, s[4:7], s92 offen lds
  v_mfma_f32_16x16x32_bf16 v[236:239], a[104:107], a[68:71], v[236:239]
  v_mul_f32 v87, 0x3b000000, v64
  v_mfma_f32_16x16x32_bf16 a[244:247], a[104:107], a[252:255], a[244:247]
  v_sub_f32 v68, v68, v85
  s_add_u32 s92, s93, 16384
  v_mfma_f32_16x16x32_bf16 v[240:243], a[108:111], a[56:59], v[240:243]
  s_add_u32 m0, s77, 122880
  v_mfma_f32_16x16x32_bf16 v[244:247], a[108:111], a[60:63], v[244:247]
  buffer_load_dwordx4 v8, s[4:7], s92 offen lds
  v_mfma_f32_16x16x32_bf16 v[248:251], a[108:111], a[64:67], v[248:251]
  v_sub_f32 v76, v76, v87
  v_mfma_f32_16x16x32_bf16 v[252:255], a[108:111], a[68:71], v[252:255]
  v_sub_f32 v69, v69, v85
  v_mfma_f32_16x16x32_bf16 a[248:251], a[108:111], a[252:255], a[248:251]
  v_sub_f32 v77, v77, v87
  s_waitcnt vmcnt(19) lgkmcnt(0)
  s_barrier
  v_mfma_f32_16x16x32_bf16 v[96:99], a[32:35], a[0:3], v[96:99]
  ds_read_b128 a[56:59], v19 offset:38912
  s_add_u32 m0, s77, 123904
  v_mfma_f32_16x16x32_bf16 v[100:103], a[32:35], a[4:7], v[100:103]
  ds_read_b128 a[60:63], v19 offset:40960
  buffer_load_dwordx4 v9, s[4:7], s92 offen lds
  v_mfma_f32_16x16x32_bf16 v[104:107], a[32:35], a[8:11], v[104:107]
  ds_read_b128 a[64:67], v19 offset:43008
  s_add_u32 s93, s93, 128
  v_mfma_f32_16x16x32_bf16 v[108:111], a[32:35], a[12:15], v[108:111]
  ds_read_b128 a[68:71], v19 offset:45056
  s_and_b32 s93, s93, 1023
  v_mfma_f32_16x16x32_bf16 v[112:115], a[32:35], a[16:19], v[112:115]
  ds_read_b128 a[72:75], v21 offset:47104
  s_add_u32 s65, s59, 2
  v_mfma_f32_16x16x32_bf16 v[116:119], a[32:35], a[20:23], v[116:119]
  ds_read_b128 a[76:79], v21 offset:49152
  s_and_b32 s65, s65, 3
  v_mfma_f32_16x16x32_bf16 v[120:123], a[32:35], a[24:27], v[120:123]
  ds_read_b128 a[80:83], v21 offset:51200
  s_add_u32 m0, s76, 61440
  v_mfma_f32_16x16x32_bf16 v[124:127], a[32:35], a[28:31], v[124:127]
  ds_read_b128 a[84:87], v21 offset:53248
  buffer_load_dwordx4 v12, s[28:31], s73 offen lds
  v_mfma_f32_16x16x32_bf16 a[228:231], a[32:35], a[252:255], a[228:231]
  ds_read_b64_tr_b16 a[88:89], v22 offset:0
  s_lshl_b32 s65, s65, 18
  v_mfma_f32_16x16x32_bf16 v[128:131], a[36:39], a[0:3], v[128:131]
  ds_read_b64_tr_b16 a[90:91], v22 offset:512
  s_add_u32 s65, s65, 524288
  v_mfma_f32_16x16x32_bf16 v[132:135], a[36:39], a[4:7], v[132:135]
  ds_read_b64_tr_b16 a[92:93], v22 offset:4096
  buffer_load_dword a218, v2, s[12:15], s65 offen
  v_mfma_f32_16x16x32_bf16 v[136:139], a[36:39], a[8:11], v[136:139]
  ds_read_b64_tr_b16 a[94:95], v22 offset:4608
  v_sub_f32 v70, v70, v85
  v_mfma_f32_16x16x32_bf16 v[140:143], a[36:39], a[12:15], v[140:143]
  ds_read_b64_tr_b16 a[96:97], v22 offset:8192
  s_add_u32 m0, s76, 65536
  v_mfma_f32_16x16x32_bf16 v[144:147], a[36:39], a[16:19], v[144:147]
  ds_read_b64_tr_b16 a[98:99], v22 offset:8704
  buffer_load_dwordx4 v13, s[32:35], s73 offen lds
  v_mfma_f32_16x16x32_bf16 v[148:151], a[36:39], a[20:23], v[148:151]
  ds_read_b64_tr_b16 a[100:101], v22 offset:12288
  v_sub_f32 v78, v78, v87
  v_mfma_f32_16x16x32_bf16 v[152:155], a[36:39], a[24:27], v[152:155]
  ds_read_b64_tr_b16 a[102:103], v22 offset:12800
  v_sub_f32 v71, v71, v85
  v_mfma_f32_16x16x32_bf16 v[156:159], a[36:39], a[28:31], v[156:159]
  ds_read_b64_tr_b16 a[104:105], v24 offset:16384
  v_sub_f32 v79, v79, v87
  v_mfma_f32_16x16x32_bf16 a[232:235], a[36:39], a[252:255], a[232:235]
  ds_read_b64_tr_b16 a[106:107], v24 offset:16640
  v_sub_f32 v72, v72, v85
  v_mfma_f32_16x16x32_bf16 v[160:163], a[40:43], a[0:3], v[160:163]
  ds_read_b64_tr_b16 a[108:109], v24 offset:18432
  s_add_u32 m0, s76, 69632
  v_mfma_f32_16x16x32_bf16 v[164:167], a[40:43], a[4:7], v[164:167]
  ds_read_b64_tr_b16 a[110:111], v24 offset:18688
  buffer_load_dwordx4 v14, s[36:39], s73 offen lds
  v_mfma_f32_16x16x32_bf16 v[168:171], a[40:43], a[8:11], v[168:171]
  v_sub_f32 v80, v80, v87
  v_sub_f32 v73, v73, v85
  v_mfma_f32_16x16x32_bf16 v[172:175], a[40:43], a[12:15], v[172:175]
  v_sub_f32 v81, v81, v87
  v_sub_f32 v74, v74, v85
  v_mfma_f32_16x16x32_bf16 v[176:179], a[40:43], a[16:19], v[176:179]
  s_add_u32 m0, s76, 73728
  s_nop 0
  buffer_load_dwordx4 v15, s[40:43], s74 offen lds
  v_mfma_f32_16x16x32_bf16 v[180:183], a[40:43], a[20:23], v[180:183]
  v_sub_f32 v82, v82, v87
  v_sub_f32 v75, v75, v85
  v_mfma_f32_16x16x32_bf16 v[184:187], a[40:43], a[24:27], v[184:187]
  s_add_u32 m0, s76, 77824
  s_nop 0
  buffer_load_dwordx4 v16, s[44:47], s74 offen lds
  v_mfma_f32_16x16x32_bf16 v[188:191], a[40:43], a[28:31], v[188:191]
  s_add_u32 s73, s73, s75
  s_add_u32 s74, s74, 114688
  v_mfma_f32_16x16x32_bf16 a[236:239], a[40:43], a[252:255], a[236:239]
  v_sub_f32 v83, v83, v87
  v_mul_f32 v60, v68, v68
  v_mfma_f32_16x16x32_bf16 v[192:195], a[44:47], a[0:3], v[192:195]
  v_mul_f32 v64, v76, v76
  v_mul_f32 v61, v69, v69
  v_mfma_f32_16x16x32_bf16 v[196:199], a[44:47], a[4:7], v[196:199]
  s_add_u32 m0, s76, 81920
  s_nop 0
  buffer_load_dwordx4 v12, s[28:31], s73 offen lds
  v_mfma_f32_16x16x32_bf16 v[200:203], a[44:47], a[8:11], v[200:203]
  v_mul_f32 v65, v77, v77
  v_mfma_f32_16x16x32_bf16 v[204:207], a[44:47], a[12:15], v[204:207]
  v_fmac_f32 v60, v70, v70
  v_mfma_f32_16x16x32_bf16 v[208:211], a[44:47], a[16:19], v[208:211]
  v_fmac_f32 v64, v78, v78
  v_fmac_f32 v61, v71, v71
  v_mfma_f32_16x16x32_bf16 v[212:215], a[44:47], a[20:23], v[212:215]
  s_add_u32 m0, s76, 86016
  v_mfma_f32_16x16x32_bf16 v[216:219], a[44:47], a[24:27], v[216:219]
  buffer_load_dwordx4 v13, s[32:35], s73 offen lds
  v_mfma_f32_16x16x32_bf16 v[220:223], a[44:47], a[28:31], v[220:223]
  v_fmac_f32 v65, v79, v79
  v_mfma_f32_16x16x32_bf16 a[240:243], a[44:47], a[252:255], a[240:243]
  v_fmac_f32 v60, v72, v72
  v_fmac_f32 v64, v80, v80
  v_mfma_f32_16x16x32_bf16 v[224:227], a[48:51], a[0:3], v[224:227]
  v_fmac_f32 v61, v73, v73
  v_mfma_f32_16x16x32_bf16 v[228:231], a[48:51], a[4:7], v[228:231]
  s_add_u32 m0, s76, 90112
  v_mfma_f32_16x16x32_bf16 v[232:235], a[48:51], a[8:11], v[232:235]
  buffer_load_dwordx4 v14, s[36:39], s73 offen lds
  v_fmac_f32 v65, v81, v81
  v_mfma_f32_16x16x32_bf16 v[236:239], a[48:51], a[12:15], v[236:239]
  v_fmac_f32 v60, v74, v74
  v_mfma_f32_16x16x32_bf16 a[244:247], a[48:51], a[252:255], a[244:247]
  v_fmac_f32 v64, v82, v82
  v_mfma_f32_16x16x32_bf16 v[240:243], a[52:55], a[0:3], v[240:243]
  v_fmac_f32 v61, v75, v75
  v_mfma_f32_16x16x32_bf16 v[244:247], a[52:55], a[4:7], v[244:247]
  s_add_u32 m0, s76, 94208
  s_nop 0
  buffer_load_dwordx4 v15, s[40:43], s74 offen lds
  v_mfma_f32_16x16x32_bf16 v[248:251], a[52:55], a[8:11], v[248:251]
  v_fmac_f32 v65, v83, v83
  v_mfma_f32_16x16x32_bf16 v[252:255], a[52:55], a[12:15], v[252:255]
  v_add_f32 v60, v60, v61
  v_mfma_f32_16x16x32_bf16 a[248:251], a[52:55], a[252:255], a[248:251]
  v_add_f32 v64, v64, v65
  s_waitcnt vmcnt(20) lgkmcnt(0)
  s_barrier
  v_mfma_f32_16x16x32_bf16 v[96:99], a[88:91], a[56:59], v[96:99]
  ds_read_b128 a[0:3], v18 offset:2048
  s_add_u32 m0, s76, 98304
  v_mfma_f32_16x16x32_bf16 v[100:103], a[88:91], a[60:63], v[100:103]
  ds_read_b128 a[4:7], v18 offset:4096
  buffer_load_dwordx4 v16, s[44:47], s74 offen lds
  v_mfma_f32_16x16x32_bf16 v[104:107], a[88:91], a[64:67], v[104:107]
  ds_read_b128 a[8:11], v18 offset:6144
  s_add_u32 s73, s73, s75
  v_mfma_f32_16x16x32_bf16 v[108:111], a[88:91], a[68:71], v[108:111]
  ds_read_b128 a[12:15], v18 offset:8192
  s_add_u32 s74, s74, 114688
  v_mfma_f32_16x16x32_bf16 v[112:115], a[88:91], a[72:75], v[112:115]
  ds_read_b128 a[16:19], v20 offset:10240
  s_add_u32 s65, s59, 3
  v_mfma_f32_16x16x32_bf16 v[116:119], a[88:91], a[76:79], v[116:119]
  ds_read_b128 a[20:23], v20 offset:12288
  s_add_u32 s92, s93, 0
  v_mfma_f32_16x16x32_bf16 v[120:123], a[88:91], a[80:83], v[120:123]
  ds_read_b128 a[24:27], v20 offset:14336
  s_add_u32 m0, s77, 139264
  v_mfma_f32_16x16x32_bf16 v[124:127], a[88:91], a[84:87], v[124:127]
  ds_read_b128 a[28:31], v20 offset:16384
  buffer_load_dwordx4 v8, s[4:7], s92 offen lds
  v_mfma_f32_16x16x32_bf16 a[228:231], a[88:91], a[252:255], a[228:231]
  ds_read_b64_tr_b16 a[32:33], v22 offset:20480
  s_and_b32 s65, s65, 3
  v_mfma_f32_16x16x32_bf16 v[128:131], a[92:95], a[56:59], v[128:131]
  ds_read_b64_tr_b16 a[34:35], v22 offset:20992
  s_lshl_b32 s65, s65, 18
  v_mfma_f32_16x16x32_bf16 v[132:135], a[92:95], a[60:63], v[132:135]
  ds_read_b64_tr_b16 a[36:37], v22 offset:24576
  s_add_u32 s65, s65, 524288
  v_mfma_f32_16x16x32_bf16 v[136:139], a[92:95], a[64:67], v[136:139]
  ds_read_b64_tr_b16 a[38:39], v22 offset:25088
  buffer_load_dword a219, v2, s[12:15], s65 offen
  v_mfma_f32_16x16x32_bf16 v[140:143], a[92:95], a[68:71], v[140:143]
  ds_read_b64_tr_b16 a[40:41], v22 offset:28672
  s_add_u32 m0, s77, 140288
  v_mfma_f32_16x16x32_bf16 v[144:147], a[92:95], a[72:75], v[144:147]
  ds_read_b64_tr_b16 a[42:43], v22 offset:29184
  buffer_load_dwordx4 v9, s[4:7], s92 offen lds
  v_mfma_f32_16x16x32_bf16 v[148:151], a[92:95], a[76:79], v[148:151]
  ds_read_b64_tr_b16 a[44:45], v22 offset:32768
  v_add_f32_dpp v60, v60, v60 row_ror:8 row_mask:0xf bank_mask:0xf
  v_mfma_f32_16x16x32_bf16 v[152:155], a[92:95], a[80:83], v[152:155]
  ds_read_b64_tr_b16 a[46:47], v22 offset:33280
  v_add_f32_dpp v64, v64, v64 row_ror:8 row_mask:0xf bank_mask:0xf
  v_mfma_f32_16x16x32_bf16 v[156:159], a[92:95], a[84:87], v[156:159]
  ds_read_b64_tr_b16 a[48:49], v24 offset:36864
  v_add_f32_dpp v60, v60, v60 row_ror:4 row_mask:0xf bank_mask:0xf
  v_mfma_f32_16x16x32_bf16 a[232:235], a[92:95], a[252:255], a[232:235]
  ds_read_b64_tr_b16 a[50:51], v24 offset:37120
  s_add_u32 s92, s93, 16384
  v_mfma_f32_16x16x32_bf16 v[160:163], a[96:99], a[56:59], v[160:163]
  ds_read_b64_tr_b16 a[52:53], v24 offset:38912
  s_add_u32 m0, s77, 141312
  v_mfma_f32_16x16x32_bf16 v[164:167], a[96:99], a[60:63], v[164:167]
  ds_read_b64_tr_b16 a[54:55], v24 offset:39168
  buffer_load_dwordx4 v8, s[4:7], s92 offen lds
  v_mfma_f32_16x16x32_bf16 v[168:171], a[96:99], a[64:67], v[168:171]
  v_add_f32_dpp v64, v64, v64 row_ror:4 row_mask:0xf bank_mask:0xf
  v_add_f32_dpp v60, v60, v60 row_ror:2 row_mask:0xf bank_mask:0xf
  v_mfma_f32_16x16x32_bf16 v[172:175], a[96:99], a[68:71], v[172:175]
  s_add_u32 m0, s77, 142336
  s_nop 0
  buffer_load_dwordx4 v9, s[4:7], s92 offen lds
  v_mfma_f32_16x16x32_bf16 v[176:179], a[96:99], a[72:75], v[176:179]
  s_add_u32 s93, s93, 128
  s_and_b32 s93, s93, 1023
  v_mfma_f32_16x16x32_bf16 v[180:183], a[96:99], a[76:79], v[180:183]
  v_add_f32_dpp v64, v64, v64 row_ror:2 row_mask:0xf bank_mask:0xf
  v_add_f32_dpp v60, v60, v60 row_ror:1 row_mask:0xf bank_mask:0xf
  v_mfma_f32_16x16x32_bf16 v[184:187], a[96:99], a[80:83], v[184:187]
  v_add_f32_dpp v64, v64, v64 row_ror:1 row_mask:0xf bank_mask:0xf
  v_mov_b32 v61, v60
  v_mfma_f32_16x16x32_bf16 v[188:191], a[96:99], a[84:87], v[188:191]
  s_add_u32 m0, s76, 0
  s_nop 0
  buffer_load_dwordx4 v12, s[28:31], s73 offen lds
  v_mfma_f32_16x16x32_bf16 a[236:239], a[96:99], a[252:255], a[236:239]
  v_mov_b32 v65, v64
  v_permlane16_swap_b32 v60, v61
  v_mfma_f32_16x16x32_bf16 v[192:195], a[100:103], a[56:59], v[192:195]
  v_permlane16_swap_b32 v64, v65
  v_add_f32 v60, v60, v61
  v_mfma_f32_16x16x32_bf16 v[196:199], a[100:103], a[60:63], v[196:199]
  s_add_u32 m0, s76, 4096
  s_nop 0
  buffer_load_dwordx4 v13, s[32:35], s73 offen lds
  v_mfma_f32_16x16x32_bf16 v[200:203], a[100:103], a[64:67], v[200:203]
  v_add_f32 v64, v64, v65
  v_mfma_f32_16x16x32_bf16 v[204:207], a[100:103], a[68:71], v[204:207]
  v_mov_b32 v61, v60
  v_mfma_f32_16x16x32_bf16 v[208:211], a[100:103], a[72:75], v[208:211]
  v_mov_b32 v65, v64
  v_permlane32_swap_b32 v60, v61
  v_mfma_f32_16x16x32_bf16 v[212:215], a[100:103], a[76:79], v[212:215]
  s_add_u32 m0, s76, 8192
  v_mfma_f32_16x16x32_bf16 v[216:219], a[100:103], a[80:83], v[216:219]
  buffer_load_dwordx4 v14, s[36:39], s73 offen lds
  v_mfma_f32_16x16x32_bf16 v[220:223], a[100:103], a[84:87], v[220:223]
  v_permlane32_swap_b32 v64, v65
  v_mfma_f32_16x16x32_bf16 a[240:243], a[100:103], a[252:255], a[240:243]
  v_add_f32 v60, v60, v61
  v_add_f32 v64, v64, v65
  v_mfma_f32_16x16x32_bf16 v[224:227], a[104:107], a[56:59], v[224:227]
  v_mov_b32 v61, 0x3727c5ac
  v_mfma_f32_16x16x32_bf16 v[228:231], a[104:107], a[60:63], v[228:231]
  s_add_u32 m0, s76, 12288
  v_mfma_f32_16x16x32_bf16 v[232:235], a[104:107], a[64:67], v[232:235]
  buffer_load_dwordx4 v15, s[40:43], s74 offen lds
  v_mov_b32 v65, 0x3727c5ac
  v_mfma_f32_16x16x32_bf16 v[236:239], a[104:107], a[68:71], v[236:239]
  v_fmac_f32 v61, 0x3b000000, v60
  v_mfma_f32_16x16x32_bf16 a[244:247], a[104:107], a[252:255], a[244:247]
  s_add_u32 m0, s76, 16384
  v_mfma_f32_16x16x32_bf16 v[240:243], a[108:111], a[56:59], v[240:243]
  buffer_load_dwordx4 v16, s[44:47], s74 offen lds
  v_mfma_f32_16x16x32_bf16 v[244:247], a[108:111], a[60:63], v[244:247]
  s_add_u32 s73, s73, s75
  s_add_u32 s74, s74, 114688
  v_mfma_f32_16x16x32_bf16 v[248:251], a[108:111], a[64:67], v[248:251]
  v_fmac_f32 v65, 0x3b000000, v64
  v_mfma_f32_16x16x32_bf16 v[252:255], a[108:111], a[68:71], v[252:255]
  v_rsq_f32 v84, v61
  v_mfma_f32_16x16x32_bf16 a[248:251], a[108:111], a[252:255], a[248:251]
  v_rsq_f32 v86, v65
  s_waitcnt vmcnt(25) lgkmcnt(0)
  s_barrier
  v_mfma_f32_16x16x32_bf16 v[96:99], a[32:35], a[0:3], v[96:99]
  ds_read_b128 a[56:59], v19 offset:2048
  s_add_u32 s65, s59, 0
  v_mfma_f32_16x16x32_bf16 v[100:103], a[32:35], a[4:7], v[100:103]
  ds_read_b128 a[60:63], v19 offset:4096
  s_add_u32 m0, s76, 20480
  v_mfma_f32_16x16x32_bf16 v[104:107], a[32:35], a[8:11], v[104:107]
  ds_read_b128 a[64:67], v19 offset:6144
  buffer_load_dwordx4 v12, s[28:31], s73 offen lds
  v_mfma_f32_16x16x32_bf16 v[108:111], a[32:35], a[12:15], v[108:111]
  ds_read_b128 a[68:71], v19 offset:8192
  s_and_b32 s65, s65, 0
  v_mfma_f32_16x16x32_bf16 v[112:115], a[32:35], a[16:19], v[112:115]
  ds_read_b128 a[72:75], v21 offset:10240
  s_lshl_b32 s65, s65, 18
  v_mfma_f32_16x16x32_bf16 v[116:119], a[32:35], a[20:23], v[116:119]
  ds_read_b128 a[76:79], v21 offset:12288
  s_add_u32 s65, s65, 1572864
  v_mfma_f32_16x16x32_bf16 v[120:123], a[32:35], a[24:27], v[120:123]
  ds_read_b128 a[80:83], v21 offset:14336
  buffer_load_dword a220, v2, s[12:15], s65 offen
  v_mfma_f32_16x16x32_bf16 v[124:127], a[32:35], a[28:31], v[124:127]
  ds_read_b128 a[84:87], v21 offset:16384
  v_readfirstlane_b32 s86, v56
  v_mfma_f32_16x16x32_bf16 a[228:231], a[32:35], a[252:255], a[228:231]
  ds_read_b64_tr_b16 a[88:89], v22 offset:40960
  v_readfirstlane_b32 s87, v57
  v_mfma_f32_16x16x32_bf16 v[128:131], a[36:39], a[0:3], v[128:131]
  ds_read_b64_tr_b16 a[90:91], v22 offset:41472
  v_mfma_f32_16x16x32_bf16 v[132:135], a[36:39], a[4:7], v[132:135]
  ds_read_b64_tr_b16 a[92:93], v22 offset:45056
  s_add_u32 m0, s76, 24576
  v_mfma_f32_16x16x32_bf16 v[136:139], a[36:39], a[8:11], v[136:139]
  ds_read_b64_tr_b16 a[94:95], v22 offset:45568
  buffer_load_dwordx4 v13, s[32:35], s73 offen lds
  v_mfma_f32_16x16x32_bf16 v[140:143], a[36:39], a[12:15], v[140:143]
  ds_read_b64_tr_b16 a[96:97], v22 offset:49152
  v_cmp_eq_u32 vcc, 1, v1
  v_mfma_f32_16x16x32_bf16 v[144:147], a[36:39], a[16:19], v[144:147]
  ds_read_b64_tr_b16 a[98:99], v22 offset:49664
  s_lshl_b32 s83, s69, 7
  v_mfma_f32_16x16x32_bf16 v[148:151], a[36:39], a[20:23], v[148:151]
  ds_read_b64_tr_b16 a[100:101], v22 offset:53248
  s_lshl_b32 s84, s70, 3
  v_mfma_f32_16x16x32_bf16 v[152:155], a[36:39], a[24:27], v[152:155]
  ds_read_b64_tr_b16 a[102:103], v22 offset:53760
  s_cmp_eq_u32 s86, 0
  s_cbranch_scc1 L_slow_nonce10
L_back_nonce10:
  v_mfma_f32_16x16x32_bf16 v[156:159], a[36:39], a[28:31], v[156:159]
  ds_read_b64_tr_b16 a[104:105], v24 offset:57344
  v_mfma_f32_16x16x32_bf16 a[232:235], a[36:39], a[252:255], a[232:235]
  ds_read_b64_tr_b16 a[106:107], v24 offset:57600
  v_cndmask_b32 v60, v84, v86, vcc
  v_mfma_f32_16x16x32_bf16 v[160:163], a[40:43], a[0:3], v[160:163]
  ds_read_b64_tr_b16 a[108:109], v24 offset:59392
  v_mfma_f32_16x16x32_bf16 v[164:167], a[40:43], a[4:7], v[164:167]
  ds_read_b64_tr_b16 a[110:111], v24 offset:59648
  v_cndmask_b32 v61, v85, v87, vcc
  v_mfma_f32_16x16x32_bf16 v[168:171], a[40:43], a[8:11], v[168:171]
  s_add_u32 m0, s76, 28672
  v_mfma_f32_16x16x32_bf16 v[172:175], a[40:43], a[12:15], v[172:175]
  buffer_load_dwordx4 v14, s[36:39], s73 offen lds
  v_mfma_f32_16x16x32_bf16 v[176:179], a[40:43], a[16:19], v[176:179]
  v_mov_b32 v62, s86
  v_mfma_f32_16x16x32_bf16 v[180:183], a[40:43], a[20:23], v[180:183]
  v_mov_b32 v63, s87
  v_mfma_f32_16x16x32_bf16 v[184:187], a[40:43], a[24:27], v[184:187]
  s_add_u32 s83, s83, s84
  v_mfma_f32_16x16x32_bf16 v[188:191], a[40:43], a[28:31], v[188:191]
  s_lshl_b32 s84, s68, 1
  v_mfma_f32_16x16x32_bf16 a[236:239], a[40:43], a[252:255], a[236:239]
  s_add_u32 s83, s83, s84
  v_mfma_f32_16x16x32_bf16 v[192:195], a[44:47], a[0:3], v[192:195]
  v_mfma_f32_16x16x32_bf16 v[196:199], a[44:47], a[4:7], v[196:199]
  s_add_u32 m0, s76, 32768
  v_mfma_f32_16x16x32_bf16 v[200:203], a[44:47], a[8:11], v[200:203]
  buffer_load_dwordx4 v15, s[40:43], s74 offen lds
  v_mfma_f32_16x16x32_bf16 v[204:207], a[44:47], a[12:15], v[204:207]
  s_lshl_b32 s83, s83, 4
  v_mfma_f32_16x16x32_bf16 v[208:211], a[44:47], a[16:19], v[208:211]
  s_add_u32 s83, s83, 9437184
  v_mfma_f32_16x16x32_bf16 v[212:215], a[44:47], a[20:23], v[212:215]
  v_lshlrev_b32 v64, 4, v1
  v_mfma_f32_16x16x32_bf16 v[216:219], a[44:47], a[24:27], v[216:219]
  s_add_u32 m0, s76, 36864
  v_mfma_f32_16x16x32_bf16 v[220:223], a[44:47], a[28:31], v[220:223]
  buffer_load_dwordx4 v16, s[44:47], s74 offen lds
  v_mfma_f32_16x16x32_bf16 a[240:243], a[44:47], a[252:255], a[240:243]
  s_add_u32 s73, s73, s75
  v_mfma_f32_16x16x32_bf16 v[224:227], a[48:51], a[0:3], v[224:227]
  v_mfma_f32_16x16x32_bf16 v[228:231], a[48:51], a[4:7], v[228:231]
  s_add_u32 s74, s74, 114688
  v_mfma_f32_16x16x32_bf16 v[232:235], a[48:51], a[8:11], v[232:235]
  s_cmp_eq_u32 s74, 1835008
  s_cselect_b32 s73, 0, s73
  s_cselect_b32 s74, 0, s74
  v_mfma_f32_16x16x32_bf16 v[236:239], a[48:51], a[12:15], v[236:239]
  v_mfma_f32_16x16x32_bf16 a[244:247], a[48:51], a[252:255], a[244:247]
  v_mfma_f32_16x16x32_bf16 v[240:243], a[52:55], a[0:3], v[240:243]
  v_cmp_lt_u32 vcc, 1, v1
  v_mfma_f32_16x16x32_bf16 v[244:247], a[52:55], a[4:7], v[244:247]
  v_mov_b32 v65, 0x80000000
  v_mfma_f32_16x16x32_bf16 v[248:251], a[52:55], a[8:11], v[248:251]
  v_cndmask_b32 v64, v64, v65, vcc
  v_mfma_f32_16x16x32_bf16 v[252:255], a[52:55], a[12:15], v[252:255]
  buffer_store_dwordx4 v[60:63], v64, s[20:23], s83 offen sc1
  v_mfma_f32_16x16x32_bf16 a[248:251], a[52:55], a[252:255], a[248:251]
  s_waitcnt vmcnt(22) lgkmcnt(0)
  s_barrier
  v_mfma_f32_16x16x32_bf16 v[96:99], a[88:91], a[56:59], v[96:99]
  ds_read_b128 a[0:3], v18 offset:20480
  s_add_u32 s92, s93, 0
  v_mfma_f32_16x16x32_bf16 v[100:103], a[88:91], a[60:63], v[100:103]
  ds_read_b128 a[4:7], v18 offset:22528
  s_add_u32 m0, s77, 102400
  v_mfma_f32_16x16x32_bf16 v[104:107], a[88:91], a[64:67], v[104:107]
  ds_read_b128 a[8:11], v18 offset:24576
  buffer_load_dwordx4 v8, s[4:7], s92 offen lds
  v_mfma_f32_16x16x32_bf16 v[108:111], a[88:91], a[68:71], v[108:111]
  ds_read_b128 a[12:15], v18 offset:26624
  s_add_u32 s65, s59, 0
  v_mfma_f32_16x16x32_bf16 v[112:115], a[88:91], a[72:75], v[112:115]
  ds_read_b128 a[16:19], v20 offset:28672
  s_and_b32 s65, s65, 1
  v_mfma_f32_16x16x32_bf16 v[116:119], a[88:91], a[76:79], v[116:119]
  ds_read_b128 a[20:23], v20 offset:30720
  s_lshl_b32 s65, s65, 18
  v_mfma_f32_16x16x32_bf16 v[120:123], a[88:91], a[80:83], v[120:123]
  ds_read_b128 a[24:27], v20 offset:32768
  s_add_u32 s65, s65, 0
  v_mfma_f32_16x16x32_bf16 v[124:127], a[88:91], a[84:87], v[124:127]
  ds_read_b128 a[28:31], v20 offset:34816
  buffer_load_dword a221, v2, s[12:15], s65 offen
  v_mfma_f32_16x16x32_bf16 a[228:231], a[88:91], a[252:255], a[228:231]
  ds_read_b64_tr_b16 a[32:33], v23 offset:0
  s_add_u32 m0, s77, 103424
  v_mfma_f32_16x16x32_bf16 v[128:131], a[92:95], a[56:59], v[128:131]
  ds_read_b64_tr_b16 a[34:35], v23 offset:512
  buffer_load_dwordx4 v9, s[4:7], s92 offen lds
  v_mfma_f32_16x16x32_bf16 v[132:135], a[92:95], a[60:63], v[132:135]
  ds_read_b64_tr_b16 a[36:37], v23 offset:4096
  v_lshrrev_b32 v5, 2, v1
  v_mfma_f32_16x16x32_bf16 v[136:139], a[92:95], a[64:67], v[136:139]
  ds_read_b64_tr_b16 a[38:39], v23 offset:4608
  v_and_b32 v5, 4, v5
  v_mfma_f32_16x16x32_bf16 v[140:143], a[92:95], a[68:71], v[140:143]
  ds_read_b64_tr_b16 a[40:41], v23 offset:8192
  v_xor_b32 v5, v5, v1
  v_mfma_f32_16x16x32_bf16 v[144:147], a[92:95], a[72:75], v[144:147]
  ds_read_b64_tr_b16 a[42:43], v23 offset:8704
  s_add_u32 s92, s93, 16384
  v_mfma_f32_16x16x32_bf16 v[148:151], a[92:95], a[76:79], v[148:151]
  ds_read_b64_tr_b16 a[44:45], v23 offset:12288
  s_add_u32 m0, s77, 104448
  v_mfma_f32_16x16x32_bf16 v[152:155], a[92:95], a[80:83], v[152:155]
  ds_read_b64_tr_b16 a[46:47], v23 offset:12800
  buffer_load_dwordx4 v8, s[4:7], s92 offen lds
  v_mfma_f32_16x16x32_bf16 v[156:159], a[92:95], a[84:87], v[156:159]
  ds_read_b64_tr_b16 a[48:49], v25 offset:16384
  v_and_b32 v5, 7, v5
  v_mfma_f32_16x16x32_bf16 a[232:235], a[92:95], a[252:255], a[232:235]
  ds_read_b64_tr_b16 a[50:51], v25 offset:16640
  v_lshlrev_b32 v5, 4, v5
  v_mfma_f32_16x16x32_bf16 v[160:163], a[96:99], a[56:59], v[160:163]
  ds_read_b64_tr_b16 a[52:53], v25 offset:18432
  v_lshrrev_b32 v6, 3, v1
  v_mfma_f32_16x16x32_bf16 v[164:167], a[96:99], a[60:63], v[164:167]
  ds_read_b64_tr_b16 a[54:55], v25 offset:18688
  s_add_u32 m0, s77, 105472
  v_mfma_f32_16x16x32_bf16 v[168:171], a[96:99], a[64:67], v[168:171]
  buffer_load_dwordx4 v9, s[4:7], s92 offen lds
  s_add_u32 s93, s93, 128
  v_mfma_f32_16x16x32_bf16 v[172:175], a[96:99], a[68:71], v[172:175]
  s_and_b32 s93, s93, 1023
  v_lshl_add_u32 v5, v6, 10, v5
  v_mfma_f32_16x16x32_bf16 v[176:179], a[96:99], a[72:75], v[176:179]
  s_lshl_b32 s84, s72, 7
  v_add_u32 v17, s84, v5
  v_mfma_f32_16x16x32_bf16 v[180:183], a[96:99], a[76:79], v[180:183]
  s_and_b32 s83, s68, 1
  s_lshr_b32 s84, s68, 1
  v_mfma_f32_16x16x32_bf16 v[184:187], a[96:99], a[80:83], v[184:187]
  s_add_u32 m0, s76, 40960
  s_nop 0
  buffer_load_dwordx4 v12, s[28:31], s73 offen lds
  v_mfma_f32_16x16x32_bf16 v[188:191], a[96:99], a[84:87], v[188:191]
  s_lshl_b32 s84, s84, 14
  s_lshl_b32 s52, s83, 18
  v_mfma_f32_16x16x32_bf16 a[236:239], a[96:99], a[252:255], a[236:239]
  s_add_u32 s52, s52, s84
  s_mov_b32 s53, s52
  v_mfma_f32_16x16x32_bf16 v[192:195], a[100:103], a[56:59], v[192:195]
  s_lshl_b32 s64, s83, 19
  s_add_u32 m0, s76, 45056
  v_mfma_f32_16x16x32_bf16 v[196:199], a[100:103], a[60:63], v[196:199]
  buffer_load_dwordx4 v13, s[32:35], s73 offen lds
  s_add_u32 s64, s64, s84
  v_mfma_f32_16x16x32_bf16 v[200:203], a[100:103], a[64:67], v[200:203]
  s_add_u32 s56, s64, 524288
  s_lshl_b32 s64, s83, 17
  v_mfma_f32_16x16x32_bf16 v[204:207], a[100:103], a[68:71], v[204:207]
  s_add_u32 s64, s64, s84
  s_add_u32 s57, s64, 1572864
  v_mfma_f32_16x16x32_bf16 v[208:211], a[100:103], a[72:75], v[208:211]
  s_add_u32 m0, s76, 49152
  v_mfma_f32_16x16x32_bf16 v[212:215], a[100:103], a[76:79], v[212:215]
  buffer_load_dwordx4 v14, s[36:39], s73 offen lds
  v_mfma_f32_16x16x32_bf16 v[216:219], a[100:103], a[80:83], v[216:219]
  s_lshl_b32 s83, s69, 7
  s_sub_u32 s84, s83, 16
  v_mfma_f32_16x16x32_bf16 v[220:223], a[100:103], a[84:87], v[220:223]
  v_add_u32 v5, s84, v1
  v_mfma_f32_16x16x32_bf16 a[240:243], a[100:103], a[252:255], a[240:243]
  v_max_i32 v58, 0, v5
  v_mfma_f32_16x16x32_bf16 v[224:227], a[104:107], a[56:59], v[224:227]
  s_add_u32 m0, s76, 53248
  s_nop 0
  buffer_load_dwordx4 v15, s[40:43], s74 offen lds
  v_mfma_f32_16x16x32_bf16 v[228:231], a[104:107], a[60:63], v[228:231]
  v_lshlrev_b32 v58, 4, v58
  v_mfma_f32_16x16x32_bf16 v[232:235], a[104:107], a[64:67], v[232:235]
  v_add_u32 v5, 64, v5
  v_mfma_f32_16x16x32_bf16 v[236:239], a[104:107], a[68:71], v[236:239]
  v_lshlrev_b32 v59, 4, v5
  s_add_u32 m0, s76, 57344
  v_mfma_f32_16x16x32_bf16 a[244:247], a[104:107], a[252:255], a[244:247]
  buffer_load_dwordx4 v16, s[44:47], s74 offen lds
  v_mfma_f32_16x16x32_bf16 v[240:243], a[108:111], a[56:59], v[240:243]
  s_add_u32 s73, s73, s75
  v_mfma_f32_16x16x32_bf16 v[244:247], a[108:111], a[60:63], v[244:247]
  s_add_u32 s74, s74, 114688
  s_add_u32 s83, s83, 112
  v_mfma_f32_16x16x32_bf16 v[248:251], a[108:111], a[64:67], v[248:251]
  v_and_b32 v5, 15, v1
  v_mfma_f32_16x16x32_bf16 v[252:255], a[108:111], a[68:71], v[252:255]
  v_add_u32 v5, s83, v5
  v_mfma_f32_16x16x32_bf16 a[248:251], a[108:111], a[252:255], a[248:251]
  v_lshlrev_b32 v42, 4, v5
  s_waitcnt vmcnt(27) lgkmcnt(0)
  s_barrier
  v_mfma_f32_16x16x32_bf16 v[96:99], a[32:35], a[0:3], v[96:99]
  ds_read_b128 a[56:59], v19 offset:20480
  s_add_u32 s65, s59, 1
  v_mfma_f32_16x16x32_bf16 v[100:103], a[32:35], a[4:7], v[100:103]
  ds_read_b128 a[60:63], v19 offset:22528
  s_add_u32 m0, s76, 61440
  v_mfma_f32_16x16x32_bf16 v[104:107], a[32:35], a[8:11], v[104:107]
  ds_read_b128 a[64:67], v19 offset:24576
  buffer_load_dwordx4 v12, s[28:31], s73 offen lds
  v_mfma_f32_16x16x32_bf16 v[108:111], a[32:35], a[12:15], v[108:111]
  ds_read_b128 a[68:71], v19 offset:26624
  s_and_b32 s65, s65, 1
  v_mfma_f32_16x16x32_bf16 v[112:115], a[32:35], a[16:19], v[112:115]
  ds_read_b128 a[72:75], v21 offset:28672
  s_lshl_b32 s65, s65, 18
  v_mfma_f32_16x16x32_bf16 v[116:119], a[32:35], a[20:23], v[116:119]
  ds_read_b128 a[76:79], v21 offset:30720
  s_add_u32 s65, s65, 0
  v_mfma_f32_16x16x32_bf16 v[120:123], a[32:35], a[24:27], v[120:123]
  ds_read_b128 a[80:83], v21 offset:32768
  v_mfma_f32_16x16x32_bf16 v[124:127], a[32:35], a[28:31], v[124:127]
  ds_read_b128 a[84:87], v21 offset:34816
  buffer_load_dword a222, v2, s[12:15], s65 offen
  v_mfma_f32_16x16x32_bf16 a[228:231], a[32:35], a[252:255], a[228:231]
  ds_read_b64_tr_b16 a[88:89], v23 offset:20480
  s_lshr_b32 s83, s68, 1
  v_mfma_f32_16x16x32_bf16 v[128:131], a[36:39], a[0:3], v[128:131]
  ds_read_b64_tr_b16 a[90:91], v23 offset:20992
  s_mul_i32 s84, s83, 294912
  v_mfma_f32_16x16x32_bf16 v[132:135], a[36:39], a[4:7], v[132:135]
  ds_read_b64_tr_b16 a[92:93], v23 offset:24576
  s_add_u32 m0, s76, 65536
  v_mfma_f32_16x16x32_bf16 v[136:139], a[36:39], a[8:11], v[136:139]
  ds_read_b64_tr_b16 a[94:95], v23 offset:25088
  buffer_load_dwordx4 v13, s[32:35], s73 offen lds
  v_mfma_f32_16x16x32_bf16 v[140:143], a[36:39], a[12:15], v[140:143]
  ds_read_b64_tr_b16 a[96:97], v23 offset:28672
  v_lshlrev_b32 v5, 4, v1
  v_mfma_f32_16x16x32_bf16 v[144:147], a[36:39], a[16:19], v[144:147]
  ds_read_b64_tr_b16 a[98:99], v23 offset:29184
  v_mfma_f32_16x16x32_bf16 v[148:151], a[36:39], a[20:23], v[148:151]
  ds_read_b64_tr_b16 a[100:101], v23 offset:32768
  v_add_u32 v26, s84, v5
  v_mfma_f32_16x16x32_bf16 v[152:155], a[36:39], a[24:27], v[152:155]
  ds_read_b64_tr_b16 a[102:103], v23 offset:33280
  v_add_u32 v27, 147456, v26
  v_mfma_f32_16x16x32_bf16 v[156:159], a[36:39], a[28:31], v[156:159]
  ds_read_b64_tr_b16 a[104:105], v25 offset:36864
  v_subrev_u32 v28, s84, v5
  v_mfma_f32_16x16x32_bf16 a[232:235], a[36:39], a[252:255], a[232:235]
  ds_read_b64_tr_b16 a[106:107], v25 offset:37120
  v_add_u32 v28, 294912, v28
  v_mfma_f32_16x16x32_bf16 v[160:163], a[40:43], a[0:3], v[160:163]
  ds_read_b64_tr_b16 a[108:109], v25 offset:38912
  v_add_u32 v29, 147456, v28
  v_mfma_f32_16x16x32_bf16 v[164:167], a[40:43], a[4:7], v[164:167]
  ds_read_b64_tr_b16 a[110:111], v25 offset:39168
  v_mfma_f32_16x16x32_bf16 v[168:171], a[40:43], a[8:11], v[168:171]
  s_add_u32 m0, s76, 69632
  v_mfma_f32_16x16x32_bf16 v[172:175], a[40:43], a[12:15], v[172:175]
  buffer_load_dwordx4 v14, s[36:39], s73 offen lds
  v_mfma_f32_16x16x32_bf16 v[176:179], a[40:43], a[16:19], v[176:179]
  s_mul_i32 s83, s69, 576
  v_mfma_f32_16x16x32_bf16 v[180:183], a[40:43], a[20:23], v[180:183]
  s_lshl_b32 s84, s79, 3
  v_mfma_f32_16x16x32_bf16 v[184:187], a[40:43], a[24:27], v[184:187]
  s_add_u32 s84, s84, s68
  v_mfma_f32_16x16x32_bf16 v[188:191], a[40:43], a[28:31], v[188:191]
  s_add_u32 s84, s84, s83
  v_mfma_f32_16x16x32_bf16 a[236:239], a[40:43], a[252:255], a[236:239]
  v_mfma_f32_16x16x32_bf16 v[192:195], a[44:47], a[0:3], v[192:195]
  s_add_u32 s88, s84, 64
  v_mfma_f32_16x16x32_bf16 v[196:199], a[44:47], a[4:7], v[196:199]
  s_add_u32 s89, s84, 68
  v_mfma_f32_16x16x32_bf16 v[200:203], a[44:47], a[8:11], v[200:203]
  s_add_u32 m0, s76, 73728
  v_mfma_f32_16x16x32_bf16 v[204:207], a[44:47], a[12:15], v[204:207]
  buffer_load_dwordx4 v15, s[40:43], s74 offen lds
  v_mfma_f32_16x16x32_bf16 v[208:211], a[44:47], a[16:19], v[208:211]
  s_lshl_b32 s84, s79, 1
  v_mfma_f32_16x16x32_bf16 v[212:215], a[44:47], a[20:23], v[212:215]
  v_mfma_f32_16x16x32_bf16 v[216:219], a[44:47], a[24:27], v[216:219]
  s_and_b32 s64, s68, 1
  v_mfma_f32_16x16x32_bf16 v[220:223], a[44:47], a[28:31], v[220:223]
  s_add_u32 s84, s84, s64
  v_mfma_f32_16x16x32_bf16 a[240:243], a[44:47], a[252:255], a[240:243]
  s_add_u32 s84, s84, s83
  v_mfma_f32_16x16x32_bf16 v[224:227], a[48:51], a[0:3], v[224:227]
  s_add_u32 m0, s76, 77824
  v_mfma_f32_16x16x32_bf16 v[228:231], a[48:51], a[4:7], v[228:231]
  buffer_load_dwordx4 v16, s[44:47], s74 offen lds
  v_mfma_f32_16x16x32_bf16 v[232:235], a[48:51], a[8:11], v[232:235]
  s_add_u32 s73, s73, s75
  v_mfma_f32_16x16x32_bf16 v[236:239], a[48:51], a[12:15], v[236:239]
  v_mfma_f32_16x16x32_bf16 a[244:247], a[48:51], a[252:255], a[244:247]
  s_add_u32 s74, s74, 114688
  v_mfma_f32_16x16x32_bf16 v[240:243], a[52:55], a[0:3], v[240:243]
  s_add_u32 s90, s84, 128
  v_mfma_f32_16x16x32_bf16 v[244:247], a[52:55], a[4:7], v[244:247]
  s_lshl_b32 s88, s88, 10
  v_mfma_f32_16x16x32_bf16 v[248:251], a[52:55], a[8:11], v[248:251]
  s_lshl_b32 s89, s89, 10
  v_mfma_f32_16x16x32_bf16 v[252:255], a[52:55], a[12:15], v[252:255]
  s_lshl_b32 s90, s90, 10
  v_mfma_f32_16x16x32_bf16 a[248:251], a[52:55], a[252:255], a[248:251]
  s_waitcnt vmcnt(23) lgkmcnt(0)
  s_barrier
  v_mfma_f32_16x16x32_bf16 v[96:99], a[88:91], a[56:59], v[96:99]
  ds_read_b128 a[0:3], v18 offset:38912
  s_add_u32 s92, s93, 0
  v_mfma_f32_16x16x32_bf16 v[100:103], a[88:91], a[60:63], v[100:103]
  ds_read_b128 a[4:7], v18 offset:40960
  s_add_u32 m0, s77, 120832
  v_mfma_f32_16x16x32_bf16 v[104:107], a[88:91], a[64:67], v[104:107]
  ds_read_b128 a[8:11], v18 offset:43008
  v_mfma_f32_16x16x32_bf16 v[108:111], a[88:91], a[68:71], v[108:111]
  ds_read_b128 a[12:15], v18 offset:45056
  buffer_load_dwordx4 v8, s[4:7], s92 offen lds
  v_mfma_f32_16x16x32_bf16 v[112:115], a[88:91], a[72:75], v[112:115]
  ds_read_b128 a[16:19], v20 offset:47104
  s_add_u32 m0, s77, 121856
  v_mfma_f32_16x16x32_bf16 v[116:119], a[88:91], a[76:79], v[116:119]
  ds_read_b128 a[20:23], v20 offset:49152
  v_mfma_f32_16x16x32_bf16 v[120:123], a[88:91], a[80:83], v[120:123]
  ds_read_b128 a[24:27], v20 offset:51200
  buffer_load_dwordx4 v9, s[4:7], s92 offen lds
  v_mfma_f32_16x16x32_bf16 v[124:127], a[88:91], a[84:87], v[124:127]
  ds_read_b128 a[28:31], v20 offset:53248
  s_add_u32 s92, s93, 16384
  v_mfma_f32_16x16x32_bf16 a[228:231], a[88:91], a[252:255], a[228:231]
  ds_read_b64_tr_b16 a[32:33], v22 offset:0
  v_mfma_f32_16x16x32_bf16 v[128:131], a[92:95], a[56:59], v[128:131]
  ds_read_b64_tr_b16 a[34:35], v22 offset:512
  s_add_u32 m0, s77, 122880
  v_mfma_f32_16x16x32_bf16 v[132:135], a[92:95], a[60:63], v[132:135]
  ds_read_b64_tr_b16 a[36:37], v22 offset:4096
  v_mfma_f32_16x16x32_bf16 v[136:139], a[92:95], a[64:67], v[136:139]
  ds_read_b64_tr_b16 a[38:39], v22 offset:4608
  buffer_load_dwordx4 v8, s[4:7], s92 offen lds
  v_mfma_f32_16x16x32_bf16 v[140:143], a[92:95], a[68:71], v[140:143]
  ds_read_b64_tr_b16 a[40:41], v22 offset:8192
  s_add_u32 m0, s77, 123904
  v_mfma_f32_16x16x32_bf16 v[144:147], a[92:95], a[72:75], v[144:147]
  ds_read_b64_tr_b16 a[42:43], v22 offset:8704
  v_mfma_f32_16x16x32_bf16 v[148:151], a[92:95], a[76:79], v[148:151]
  ds_read_b64_tr_b16 a[44:45], v22 offset:12288
  buffer_load_dwordx4 v9, s[4:7], s92 offen lds
  v_mfma_f32_16x16x32_bf16 v[152:155], a[92:95], a[80:83], v[152:155]
  ds_read_b64_tr_b16 a[46:47], v22 offset:12800
  s_add_u32 s93, s93, 128
  v_mfma_f32_16x16x32_bf16 v[156:159], a[92:95], a[84:87], v[156:159]
  ds_read_b64_tr_b16 a[48:49], v24 offset:16384
  v_mfma_f32_16x16x32_bf16 a[232:235], a[92:95], a[252:255], a[232:235]
  ds_read_b64_tr_b16 a[50:51], v24 offset:16640
  s_and_b32 s93, s93, 1023
  v_mfma_f32_16x16x32_bf16 v[160:163], a[96:99], a[56:59], v[160:163]
  ds_read_b64_tr_b16 a[52:53], v24 offset:18432
  v_mfma_f32_16x16x32_bf16 v[164:167], a[96:99], a[60:63], v[164:167]
  ds_read_b64_tr_b16 a[54:55], v24 offset:18688
  s_add_u32 m0, s76, 81920
  v_mfma_f32_16x16x32_bf16 v[168:171], a[96:99], a[64:67], v[168:171]
  buffer_load_dwordx4 v12, s[28:31], s73 offen lds
  v_mfma_f32_16x16x32_bf16 v[172:175], a[96:99], a[68:71], v[172:175]
  v_mfma_f32_16x16x32_bf16 v[176:179], a[96:99], a[72:75], v[176:179]
  s_add_u32 s65, s59, 0
  v_mfma_f32_16x16x32_bf16 v[180:183], a[96:99], a[76:79], v[180:183]
  s_add_u32 m0, s76, 86016
  v_mfma_f32_16x16x32_bf16 v[184:187], a[96:99], a[80:83], v[184:187]
  v_mfma_f32_16x16x32_bf16 v[188:191], a[96:99], a[84:87], v[188:191]
  buffer_load_dwordx4 v13, s[32:35], s73 offen lds
  v_mfma_f32_16x16x32_bf16 a[236:239], a[96:99], a[252:255], a[236:239]
  s_and_b32 s65, s65, 1
  v_mfma_f32_16x16x32_bf16 v[192:195], a[100:103], a[56:59], v[192:195]
  v_mfma_f32_16x16x32_bf16 v[196:199], a[100:103], a[60:63], v[196:199]
  s_add_u32 m0, s76, 90112
  v_mfma_f32_16x16x32_bf16 v[200:203], a[100:103], a[64:67], v[200:203]
  v_mfma_f32_16x16x32_bf16 v[204:207], a[100:103], a[68:71], v[204:207]
  buffer_load_dwordx4 v14, s[36:39], s73 offen lds
  v_mfma_f32_16x16x32_bf16 v[208:211], a[100:103], a[72:75], v[208:211]
  s_lshl_b32 s65, s65, 18
  v_mfma_f32_16x16x32_bf16 v[212:215], a[100:103], a[76:79], v[212:215]
  v_mfma_f32_16x16x32_bf16 v[216:219], a[100:103], a[80:83], v[216:219]
  s_add_u32 s65, s65, 0
  v_mfma_f32_16x16x32_bf16 v[220:223], a[100:103], a[84:87], v[220:223]
  s_add_u32 m0, s76, 94208
  v_mfma_f32_16x16x32_bf16 a[240:243], a[100:103], a[252:255], a[240:243]
  v_mfma_f32_16x16x32_bf16 v[224:227], a[104:107], a[56:59], v[224:227]
  buffer_load_dwordx4 v15, s[40:43], s74 offen lds
  v_mfma_f32_16x16x32_bf16 v[228:231], a[104:107], a[60:63], v[228:231]
  v_mfma_f32_16x16x32_bf16 v[232:235], a[104:107], a[64:67], v[232:235]
  s_add_u32 m0, s76, 98304
  v_mfma_f32_16x16x32_bf16 v[236:239], a[104:107], a[68:71], v[236:239]
  buffer_load_dwordx4 v16, s[44:47], s74 offen lds
  v_mfma_f32_16x16x32_bf16 a[244:247], a[104:107], a[252:255], a[244:247]
  v_mfma_f32_16x16x32_bf16 v[240:243], a[108:111], a[56:59], v[240:243]
  s_add_u32 s73, s73, s75
  v_mfma_f32_16x16x32_bf16 v[244:247], a[108:111], a[60:63], v[244:247]
  s_add_u32 s74, s74, 114688
  v_mfma_f32_16x16x32_bf16 v[248:251], a[108:111], a[64:67], v[248:251]
  v_mfma_f32_16x16x32_bf16 v[252:255], a[108:111], a[68:71], v[252:255]
  buffer_load_dword a223, v2, s[8:11], s65 offen
  v_mfma_f32_16x16x32_bf16 a[248:251], a[108:111], a[252:255], a[248:251]
  s_waitcnt vmcnt(27) lgkmcnt(0)
  s_barrier
  v_mfma_f32_16x16x32_bf16 v[96:99], a[32:35], a[0:3], v[96:99]
  ds_read_b128 a[56:59], v19 offset:38912
  s_add_u32 m0, s76, 0
  v_mfma_f32_16x16x32_bf16 v[100:103], a[32:35], a[4:7], v[100:103]
  ds_read_b128 a[60:63], v19 offset:40960
  v_mfma_f32_16x16x32_bf16 v[104:107], a[32:35], a[8:11], v[104:107]
  ds_read_b128 a[64:67], v19 offset:43008
  buffer_load_dwordx4 v12, s[28:31], s73 offen lds
  v_mfma_f32_16x16x32_bf16 v[108:111], a[32:35], a[12:15], v[108:111]
  ds_read_b128 a[68:71], v19 offset:45056
  v_mfma_f32_16x16x32_bf16 v[112:115], a[32:35], a[16:19], v[112:115]
  ds_read_b128 a[72:75], v21 offset:47104
  s_mov_b32 s83, 9437184
  v_mfma_f32_16x16x32_bf16 v[116:119], a[32:35], a[20:23], v[116:119]
  ds_read_b128 a[76:79], v21 offset:49152
  v_mfma_f32_16x16x32_bf16 v[120:123], a[32:35], a[24:27], v[120:123]
  ds_read_b128 a[80:83], v21 offset:51200
  buffer_load_dwordx4 v[76:79], v58, s[20:23], s83 offen sc1
  v_mfma_f32_16x16x32_bf16 v[124:127], a[32:35], a[28:31], v[124:127]
  ds_read_b128 a[84:87], v21 offset:53248
  v_mfma_f32_16x16x32_bf16 a[228:231], a[32:35], a[252:255], a[228:231]
  ds_read_b64_tr_b16 a[88:89], v22 offset:20480
  s_add_u32 m0, s76, 4096
  v_mfma_f32_16x16x32_bf16 v[128:131], a[36:39], a[0:3], v[128:131]
  ds_read_b64_tr_b16 a[90:91], v22 offset:20992
  v_mfma_f32_16x16x32_bf16 v[132:135], a[36:39], a[4:7], v[132:135]
  ds_read_b64_tr_b16 a[92:93], v22 offset:24576
  buffer_load_dwordx4 v13, s[32:35], s73 offen lds
  v_mfma_f32_16x16x32_bf16 v[136:139], a[36:39], a[8:11], v[136:139]
  ds_read_b64_tr_b16 a[94:95], v22 offset:25088
  v_mfma_f32_16x16x32_bf16 v[140:143], a[36:39], a[12:15], v[140:143]
  ds_read_b64_tr_b16 a[96:97], v22 offset:28672
  v_mfma_f32_16x16x32_bf16 v[144:147], a[36:39], a[16:19], v[144:147]
  ds_read_b64_tr_b16 a[98:99], v22 offset:29184
  buffer_load_dwordx4 v[80:83], v59, s[20:23], s83 offen sc1
  v_mfma_f32_16x16x32_bf16 v[148:151], a[36:39], a[20:23], v[148:151]
  ds_read_b64_tr_b16 a[100:101], v22 offset:32768
  v_mfma_f32_16x16x32_bf16 v[152:155], a[36:39], a[24:27], v[152:155]
  ds_read_b64_tr_b16 a[102:103], v22 offset:33280
  buffer_load_dwordx4 v[84:87], v42, s[20:23], s83 offen sc1
  v_mfma_f32_16x16x32_bf16 v[156:159], a[36:39], a[28:31], v[156:159]
  ds_read_b64_tr_b16 a[104:105], v24 offset:36864
  v_mfma_f32_16x16x32_bf16 a[232:235], a[36:39], a[252:255], a[232:235]
  ds_read_b64_tr_b16 a[106:107], v24 offset:37120
  s_add_u32 m0, s76, 8192
  v_mfma_f32_16x16x32_bf16 v[160:163], a[40:43], a[0:3], v[160:163]
  ds_read_b64_tr_b16 a[108:109], v24 offset:38912
  v_mfma_f32_16x16x32_bf16 v[164:167], a[40:43], a[4:7], v[164:167]
  ds_read_b64_tr_b16 a[110:111], v24 offset:39168
  buffer_load_dwordx4 v14, s[36:39], s73 offen lds
  v_mfma_f32_16x16x32_bf16 v[168:171], a[40:43], a[8:11], v[168:171]
  v_mfma_f32_16x16x32_bf16 v[172:175], a[40:43], a[12:15], v[172:175]
  s_add_u32 s65, s59, 1
  v_mfma_f32_16x16x32_bf16 v[176:179], a[40:43], a[16:19], v[176:179]
  v_mfma_f32_16x16x32_bf16 v[180:183], a[40:43], a[20:23], v[180:183]
  v_mfma_f32_16x16x32_bf16 v[184:187], a[40:43], a[24:27], v[184:187]
  s_and_b32 s65, s65, 1
  v_mfma_f32_16x16x32_bf16 v[188:191], a[40:43], a[28:31], v[188:191]
  v_mfma_f32_16x16x32_bf16 a[236:239], a[40:43], a[252:255], a[236:239]
  s_add_u32 m0, s76, 12288
  v_mfma_f32_16x16x32_bf16 v[192:195], a[44:47], a[0:3], v[192:195]
  v_mfma_f32_16x16x32_bf16 v[196:199], a[44:47], a[4:7], v[196:199]
  buffer_load_dwordx4 v15, s[40:43], s74 offen lds
  v_mfma_f32_16x16x32_bf16 v[200:203], a[44:47], a[8:11], v[200:203]
  v_mfma_f32_16x16x32_bf16 v[204:207], a[44:47], a[12:15], v[204:207]
  s_add_u32 m0, s76, 16384
  v_mfma_f32_16x16x32_bf16 v[208:211], a[44:47], a[16:19], v[208:211]
  v_mfma_f32_16x16x32_bf16 v[212:215], a[44:47], a[20:23], v[212:215]
  buffer_load_dwordx4 v16, s[44:47], s74 offen lds
  v_mfma_f32_16x16x32_bf16 v[216:219], a[44:47], a[24:27], v[216:219]
  v_mfma_f32_16x16x32_bf16 v[220:223], a[44:47], a[28:31], v[220:223]
  v_mfma_f32_16x16x32_bf16 a[240:243], a[44:47], a[252:255], a[240:243]
  s_add_u32 s73, s73, s75
  v_mfma_f32_16x16x32_bf16 v[224:227], a[48:51], a[0:3], v[224:227]
  v_mfma_f32_16x16x32_bf16 v[228:231], a[48:51], a[4:7], v[228:231]
  s_add_u32 s74, s74, 114688
  v_mfma_f32_16x16x32_bf16 v[232:235], a[48:51], a[8:11], v[232:235]
  v_mfma_f32_16x16x32_bf16 v[236:239], a[48:51], a[12:15], v[236:239]
  s_lshl_b32 s65, s65, 18
  v_mfma_f32_16x16x32_bf16 a[244:247], a[48:51], a[252:255], a[244:247]
  v_mfma_f32_16x16x32_bf16 v[240:243], a[52:55], a[0:3], v[240:243]
  s_add_u32 s65, s65, 0
  v_mfma_f32_16x16x32_bf16 v[244:247], a[52:55], a[4:7], v[244:247]
  v_mfma_f32_16x16x32_bf16 v[248:251], a[52:55], a[8:11], v[248:251]
  buffer_load_dword a224, v2, s[8:11], s65 offen
  v_mfma_f32_16x16x32_bf16 v[252:255], a[52:55], a[12:15], v[252:255]
  v_mfma_f32_16x16x32_bf16 a[248:251], a[52:55], a[252:255], a[248:251]
  s_waitcnt vmcnt(25) lgkmcnt(0)
  s_barrier
  v_mfma_f32_16x16x32_bf16 v[96:99], a[88:91], a[56:59], v[96:99]
  ds_read_b128 a[0:3], v18 offset:2048
  s_add_u32 s82, s56, 0
  v_mfma_f32_16x16x32_bf16 v[100:103], a[88:91], a[60:63], v[100:103]
  ds_read_b128 a[4:7], v18 offset:4096
  s_add_u32 m0, s85, 24576
  v_mfma_f32_16x16x32_bf16 v[104:107], a[88:91], a[64:67], v[104:107]
  ds_read_b128 a[8:11], v18 offset:6144
  buffer_load_dwordx4 v17, s[12:15], s82 offen lds
  v_mfma_f32_16x16x32_bf16 v[108:111], a[88:91], a[68:71], v[108:111]
  ds_read_b128 a[12:15], v18 offset:8192
  s_and_b32 s83, s68, 1
  v_mfma_f32_16x16x32_bf16 v[112:115], a[88:91], a[72:75], v[112:115]
  ds_read_b128 a[16:19], v20 offset:10240
  s_lshl_b32 s83, s83, 6
  v_mfma_f32_16x16x32_bf16 v[116:119], a[88:91], a[76:79], v[116:119]
  ds_read_b128 a[20:23], v20 offset:12288
  s_add_u32 s82, s56, 8192
  v_mfma_f32_16x16x32_bf16 v[120:123], a[88:91], a[80:83], v[120:123]
  ds_read_b128 a[24:27], v20 offset:14336
  s_add_u32 m0, s85, 25600
  v_mfma_f32_16x16x32_bf16 v[124:127], a[88:91], a[84:87], v[124:127]
  ds_read_b128 a[28:31], v20 offset:16384
  buffer_load_dwordx4 v17, s[12:15], s82 offen lds
  v_mfma_f32_16x16x32_bf16 a[228:231], a[88:91], a[252:255], a[228:231]
  ds_read_b64_tr_b16 a[32:33], v22 offset:40960
  v_lshrrev_b32 v4, 5, v1
  v_mfma_f32_16x16x32_bf16 v[128:131], a[92:95], a[56:59], v[128:131]
  ds_read_b64_tr_b16 a[34:35], v22 offset:41472
  v_lshlrev_b32 v4, 10, v4
  v_mfma_f32_16x16x32_bf16 v[132:135], a[92:95], a[60:63], v[132:135]
  ds_read_b64_tr_b16 a[36:37], v22 offset:45056
  v_bfe_u32 v6, v1, 2, 2
  v_mfma_f32_16x16x32_bf16 v[136:139], a[92:95], a[64:67], v[136:139]
  ds_read_b64_tr_b16 a[38:39], v22 offset:45568
  s_add_u32 s82, s56, 32768
  v_mfma_f32_16x16x32_bf16 v[140:143], a[92:95], a[68:71], v[140:143]
  ds_read_b64_tr_b16 a[40:41], v22 offset:49152
  s_add_u32 m0, s85, 32768
  v_mfma_f32_16x16x32_bf16 v[144:147], a[92:95], a[72:75], v[144:147]
  ds_read_b64_tr_b16 a[42:43], v22 offset:49664
  buffer_load_dwordx4 v17, s[12:15], s82 offen lds
  v_mfma_f32_16x16x32_bf16 v[148:151], a[92:95], a[76:79], v[148:151]
  ds_read_b64_tr_b16 a[44:45], v22 offset:53248
  v_lshl_add_u32 v4, v6, 7, v4
  v_mfma_f32_16x16x32_bf16 v[152:155], a[92:95], a[80:83], v[152:155]
  ds_read_b64_tr_b16 a[46:47], v22 offset:53760
  v_lshrrev_b32 v6, 1, v6
  v_mfma_f32_16x16x32_bf16 v[156:159], a[92:95], a[84:87], v[156:159]
  ds_read_b64_tr_b16 a[48:49], v24 offset:57344
  v_lshl_add_u32 v4, v6, 6, v4
  v_mfma_f32_16x16x32_bf16 a[232:235], a[92:95], a[252:255], a[232:235]
  ds_read_b64_tr_b16 a[50:51], v24 offset:57600
  s_add_u32 s82, s56, 40960
  v_mfma_f32_16x16x32_bf16 v[160:163], a[96:99], a[56:59], v[160:163]
  ds_read_b64_tr_b16 a[52:53], v24 offset:59392
  s_add_u32 m0, s85, 33792
  v_mfma_f32_16x16x32_bf16 v[164:167], a[96:99], a[60:63], v[164:167]
  ds_read_b64_tr_b16 a[54:55], v24 offset:59648
  buffer_load_dwordx4 v17, s[12:15], s82 offen lds
  v_mfma_f32_16x16x32_bf16 v[168:171], a[96:99], a[64:67], v[168:171]
  v_bfe_u32 v6, v1, 4, 1
  v_mfma_f32_16x16x32_bf16 v[172:175], a[96:99], a[68:71], v[172:175]
  v_lshl_add_u32 v4, v6, 5, v4
  v_mfma_f32_16x16x32_bf16 v[176:179], a[96:99], a[72:75], v[176:179]
  s_add_u32 s82, s56, 65536
  v_mfma_f32_16x16x32_bf16 v[180:183], a[96:99], a[76:79], v[180:183]
  s_add_u32 m0, s85, 139264
  v_mfma_f32_16x16x32_bf16 v[184:187], a[96:99], a[80:83], v[184:187]
  buffer_load_dwordx4 v17, s[12:15], s82 offen lds
  v_mfma_f32_16x16x32_bf16 v[188:191], a[96:99], a[84:87], v[188:191]
  v_and_b32 v6, 1, v1
  v_mfma_f32_16x16x32_bf16 a[236:239], a[96:99], a[252:255], a[236:239]
  v_lshl_add_u32 v4, v6, 4, v4
  v_mfma_f32_16x16x32_bf16 v[192:195], a[100:103], a[56:59], v[192:195]
  v_bfe_u32 v6, v1, 1, 1
  v_mfma_f32_16x16x32_bf16 v[196:199], a[100:103], a[60:63], v[196:199]
  s_add_u32 s82, s56, 73728
  v_mfma_f32_16x16x32_bf16 v[200:203], a[100:103], a[64:67], v[200:203]
  s_add_u32 m0, s85, 140288
  v_mfma_f32_16x16x32_bf16 v[204:207], a[100:103], a[68:71], v[204:207]
  buffer_load_dwordx4 v17, s[12:15], s82 offen lds
  v_mfma_f32_16x16x32_bf16 v[208:211], a[100:103], a[72:75], v[208:211]
  v_lshl_add_u32 v4, v6, 3, v4
  v_mfma_f32_16x16x32_bf16 v[212:215], a[100:103], a[76:79], v[212:215]
  v_xor_b32 v4, s83, v4
  v_mfma_f32_16x16x32_bf16 v[216:219], a[100:103], a[80:83], v[216:219]
  s_lshl_b32 s83, s83, 5
  v_mfma_f32_16x16x32_bf16 v[220:223], a[100:103], a[84:87], v[220:223]
  s_add_u32 s82, s56, 98304
  v_mfma_f32_16x16x32_bf16 a[240:243], a[100:103], a[252:255], a[240:243]
  s_add_u32 m0, s85, 147456
  v_mfma_f32_16x16x32_bf16 v[224:227], a[104:107], a[56:59], v[224:227]
  buffer_load_dwordx4 v17, s[12:15], s82 offen lds
  v_mfma_f32_16x16x32_bf16 v[228:231], a[104:107], a[60:63], v[228:231]
  v_add_u32 v2, s83, v4
  v_mfma_f32_16x16x32_bf16 v[232:235], a[104:107], a[64:67], v[232:235]
  v_xor_b32 v3, 64, v2
  v_mfma_f32_16x16x32_bf16 v[236:239], a[104:107], a[68:71], v[236:239]
  v_add_u32 v4, 65536, v2
  v_mfma_f32_16x16x32_bf16 a[244:247], a[104:107], a[252:255], a[244:247]
  s_add_u32 s82, s56, 106496
  v_mfma_f32_16x16x32_bf16 v[240:243], a[108:111], a[56:59], v[240:243]
  s_add_u32 m0, s85, 148480
  v_mfma_f32_16x16x32_bf16 v[244:247], a[108:111], a[60:63], v[244:247]
  buffer_load_dwordx4 v17, s[12:15], s82 offen lds
  v_mfma_f32_16x16x32_bf16 v[248:251], a[108:111], a[64:67], v[248:251]
  v_add_u32 v5, 65536, v3
  v_mfma_f32_16x16x32_bf16 v[252:255], a[108:111], a[68:71], v[252:255]
  v_add_u32 v6, 131072, v2
  v_mfma_f32_16x16x32_bf16 a[248:251], a[108:111], a[252:255], a[248:251]
  v_add_u32 v49, 131072, v3
  s_waitcnt vmcnt(12) lgkmcnt(0)
  s_barrier
  v_mfma_f32_16x16x32_bf16 v[96:99], a[32:35], a[0:3], v[96:99]
  ds_read_b128 a[56:59], v19 offset:2048
  v_cmp_ne_u64 vcc, s[86:87], v[78:79]
  v_cmp_ne_u64 s[94:95], s[86:87], v[82:83]
  v_cmp_ne_u64 s[92:93], s[86:87], v[86:87]
  s_or_b64 vcc, vcc, s[94:95]
  s_or_b64 vcc, vcc, s[92:93]
  s_cbranch_vccnz L_slow_gat10
L_back_gat10:
  v_mfma_f32_16x16x32_bf16 v[100:103], a[32:35], a[4:7], v[100:103]
  ds_read_b128 a[60:63], v19 offset:4096
  s_mul_i32 s83, s68, 1152
  v_mfma_f32_16x16x32_bf16 v[104:107], a[32:35], a[8:11], v[104:107]
  ds_read_b128 a[64:67], v19 offset:6144
  s_add_u32 s83, s83, 157696
  v_mfma_f32_16x16x32_bf16 v[108:111], a[32:35], a[12:15], v[108:111]
  ds_read_b128 a[68:71], v19 offset:8192
  v_lshl_add_u32 v44, v1, 2, s83
  v_mfma_f32_16x16x32_bf16 v[112:115], a[32:35], a[16:19], v[112:115]
  ds_read_b128 a[72:75], v21 offset:10240
  v_and_b32 v45, 15, v1
  v_mfma_f32_16x16x32_bf16 v[116:119], a[32:35], a[20:23], v[116:119]
  ds_read_b128 a[76:79], v21 offset:12288
  v_lshl_add_u32 v45, v45, 2, s83
  v_mfma_f32_16x16x32_bf16 v[120:123], a[32:35], a[24:27], v[120:123]
  ds_read_b128 a[80:83], v21 offset:14336
  v_add_u32 v46, 512, v45
  v_mfma_f32_16x16x32_bf16 v[124:127], a[32:35], a[28:31], v[124:127]
  ds_read_b128 a[84:87], v21 offset:16384
  s_lshr_b32 s84, s68, 1
  v_mfma_f32_16x16x32_bf16 a[228:231], a[32:35], a[252:255], a[228:231]
  ds_read_b64_tr_b16 a[88:89], v23 offset:0
  s_lshl_b32 s84, s84, 8
  v_mfma_f32_16x16x32_bf16 v[128:131], a[36:39], a[0:3], v[128:131]
  ds_read_b64_tr_b16 a[90:91], v23 offset:512
  v_add_u32 v47, s84, v45
  v_mfma_f32_16x16x32_bf16 v[132:135], a[36:39], a[4:7], v[132:135]
  ds_read_b64_tr_b16 a[92:93], v23 offset:4096
  v_subrev_u32 v48, s84, v45
  v_mfma_f32_16x16x32_bf16 v[136:139], a[36:39], a[8:11], v[136:139]
  ds_read_b64_tr_b16 a[94:95], v23 offset:4608
  v_add_u32 v48, 256, v48
  v_mfma_f32_16x16x32_bf16 v[140:143], a[36:39], a[12:15], v[140:143]
  ds_read_b64_tr_b16 a[96:97], v23 offset:8192
  v_mfma_f32_16x16x32_bf16 v[144:147], a[36:39], a[16:19], v[144:147]
  ds_read_b64_tr_b16 a[98:99], v23 offset:8704
  v_mfma_f32_16x16x32_bf16 v[148:151], a[36:39], a[20:23], v[148:151]
  ds_read_b64_tr_b16 a[100:101], v23 offset:12288
  v_mfma_f32_16x16x32_bf16 v[152:155], a[36:39], a[24:27], v[152:155]
  ds_read_b64_tr_b16 a[102:103], v23 offset:12800
  v_mfma_f32_16x16x32_bf16 v[156:159], a[36:39], a[28:31], v[156:159]
  ds_read_b64_tr_b16 a[104:105], v25 offset:16384
  v_mfma_f32_16x16x32_bf16 a[232:235], a[36:39], a[252:255], a[232:235]
  ds_read_b64_tr_b16 a[106:107], v25 offset:16640
  v_mfma_f32_16x16x32_bf16 v[160:163], a[40:43], a[0:3], v[160:163]
  ds_read_b64_tr_b16 a[108:109], v25 offset:18432
  v_mfma_f32_16x16x32_bf16 v[164:167], a[40:43], a[4:7], v[164:167]
  ds_read_b64_tr_b16 a[110:111], v25 offset:18688
  v_mfma_f32_16x16x32_bf16 v[168:171], a[40:43], a[8:11], v[168:171]
  ds_write2_b32 v44, v76, v77 offset0:0 offset1:144
  v_mfma_f32_16x16x32_bf16 v[172:175], a[40:43], a[12:15], v[172:175]
  ds_write2_b32 v44, v80, v81 offset0:64 offset1:208
  s_add_u32 s82, s56, 131072
  v_mfma_f32_16x16x32_bf16 v[176:179], a[40:43], a[16:19], v[176:179]
  ds_write2_b32 v46, v84, v85 offset0:0 offset1:144
  s_add_u32 m0, s85, 40960
  v_mfma_f32_16x16x32_bf16 v[180:183], a[40:43], a[20:23], v[180:183]
  ds_read2_b32 v[60:61], v47 offset0:16 offset1:160
  buffer_load_dwordx4 v17, s[12:15], s82 offen lds
  v_mfma_f32_16x16x32_bf16 v[184:187], a[40:43], a[24:27], v[184:187]
  ds_read2_b32 v[62:63], v47 offset0:32 offset1:176
  s_add_u32 s82, s56, 139264
  v_mfma_f32_16x16x32_bf16 v[188:191], a[40:43], a[28:31], v[188:191]
  ds_read2_b32 v[64:65], v47 offset0:48 offset1:192
  v_mfma_f32_16x16x32_bf16 a[236:239], a[40:43], a[252:255], a[236:239]
  ds_read2_b32 v[66:67], v47 offset0:64 offset1:208
  s_add_u32 m0, s85, 41984
  v_mfma_f32_16x16x32_bf16 v[192:195], a[44:47], a[0:3], v[192:195]
  ds_read2_b32 v[68:69], v48 offset0:16 offset1:160
  buffer_load_dwordx4 v17, s[12:15], s82 offen lds
  v_mfma_f32_16x16x32_bf16 v[196:199], a[44:47], a[4:7], v[196:199]
  ds_read2_b32 v[70:71], v48 offset0:32 offset1:176
  s_add_u32 s82, s56, 163840
  v_mfma_f32_16x16x32_bf16 v[200:203], a[44:47], a[8:11], v[200:203]
  ds_read2_b32 v[72:73], v48 offset0:48 offset1:192
  s_add_u32 m0, s85, 49152
  v_mfma_f32_16x16x32_bf16 v[204:207], a[44:47], a[12:15], v[204:207]
  ds_read2_b32 v[74:75], v48 offset0:64 offset1:208
  v_mfma_f32_16x16x32_bf16 v[208:211], a[44:47], a[16:19], v[208:211]
  buffer_load_dwordx4 v17, s[12:15], s82 offen lds
  v_mfma_f32_16x16x32_bf16 v[212:215], a[44:47], a[20:23], v[212:215]
  s_add_u32 s82, s56, 172032
  v_mfma_f32_16x16x32_bf16 v[216:219], a[44:47], a[24:27], v[216:219]
  s_add_u32 m0, s85, 50176
  v_mfma_f32_16x16x32_bf16 v[220:223], a[44:47], a[28:31], v[220:223]
  buffer_load_dwordx4 v17, s[12:15], s82 offen lds
  v_mfma_f32_16x16x32_bf16 a[240:243], a[44:47], a[252:255], a[240:243]
  v_mfma_f32_16x16x32_bf16 v[224:227], a[48:51], a[0:3], v[224:227]
  s_add_u32 s61, s52, 32768
  v_mfma_f32_16x16x32_bf16 v[228:231], a[48:51], a[4:7], v[228:231]
  buffer_load_dwordx4 v[30:33], v17, s[8:11], s61 offen
  v_mfma_f32_16x16x32_bf16 v[232:235], a[48:51], a[8:11], v[232:235]
  s_add_u32 s61, s52, 40960
  v_mfma_f32_16x16x32_bf16 v[236:239], a[48:51], a[12:15], v[236:239]
  buffer_load_dwordx4 v[34:37], v17, s[8:11], s61 offen
  v_mfma_f32_16x16x32_bf16 a[244:247], a[48:51], a[252:255], a[244:247]
  v_mfma_f32_16x16x32_bf16 v[240:243], a[52:55], a[0:3], v[240:243]
  s_add_u32 s61, s52, 65536
  v_mfma_f32_16x16x32_bf16 v[244:247], a[52:55], a[4:7], v[244:247]
  buffer_load_dwordx4 v[38:41], v17, s[8:11], s61 offen
  v_mfma_f32_16x16x32_bf16 v[248:251], a[52:55], a[8:11], v[248:251]
  s_add_u32 s61, s52, 73728
  v_mfma_f32_16x16x32_bf16 v[252:255], a[52:55], a[12:15], v[252:255]
  buffer_load_dwordx4 v[88:91], v17, s[8:11], s61 offen
  v_mfma_f32_16x16x32_bf16 a[248:251], a[52:55], a[252:255], a[248:251]
  s_waitcnt vmcnt(8) lgkmcnt(0)
  s_barrier
  v_mfma_f32_16x16x32_bf16 v[96:99], a[88:91], a[56:59], v[96:99]
  ds_read_b128 a[0:3], v18 offset:20480
  s_add_u32 s82, s56, 196608
  v_mfma_f32_16x16x32_bf16 v[100:103], a[88:91], a[60:63], v[100:103]
  ds_read_b128 a[4:7], v18 offset:22528
  s_add_u32 m0, s85, 57344
  v_mfma_f32_16x16x32_bf16 v[104:107], a[88:91], a[64:67], v[104:107]
  ds_read_b128 a[8:11], v18 offset:24576
  v_mfma_f32_16x16x32_bf16 v[108:111], a[88:91], a[68:71], v[108:111]
  ds_read_b128 a[12:15], v18 offset:26624
  buffer_load_dwordx4 v17, s[12:15], s82 offen lds
  v_mfma_f32_16x16x32_bf16 v[112:115], a[88:91], a[72:75], v[112:115]
  ds_read_b128 a[16:19], v20 offset:28672
  v_mfma_f32_16x16x32_bf16 v[116:119], a[88:91], a[76:79], v[116:119]
  ds_read_b128 a[20:23], v20 offset:30720
  s_add_u32 s82, s56, 204800
  v_mfma_f32_16x16x32_bf16 v[120:123], a[88:91], a[80:83], v[120:123]
  ds_read_b128 a[24:27], v20 offset:32768
  v_mfma_f32_16x16x32_bf16 v[124:127], a[88:91], a[84:87], v[124:127]
  ds_read_b128 a[28:31], v20 offset:34816
  s_add_u32 m0, s85, 58368
  v_mfma_f32_16x16x32_bf16 a[228:231], a[88:91], a[252:255], a[228:231]
  ds_read_b64_tr_b16 a[32:33], v23 offset:20480
  v_mfma_f32_16x16x32_bf16 v[128:131], a[92:95], a[56:59], v[128:131]
  ds_read_b64_tr_b16 a[34:35], v23 offset:20992
  buffer_load_dwordx4 v17, s[12:15], s82 offen lds
  v_mfma_f32_16x16x32_bf16 v[132:135], a[92:95], a[60:63], v[132:135]
  ds_read_b64_tr_b16 a[36:37], v23 offset:24576
  v_mfma_f32_16x16x32_bf16 v[136:139], a[92:95], a[64:67], v[136:139]
  ds_read_b64_tr_b16 a[38:39], v23 offset:25088
  s_add_u32 s82, s56, 229376
  v_mfma_f32_16x16x32_bf16 v[140:143], a[92:95], a[68:71], v[140:143]
  ds_read_b64_tr_b16 a[40:41], v23 offset:28672
  v_mfma_f32_16x16x32_bf16 v[144:147], a[92:95], a[72:75], v[144:147]
  ds_read_b64_tr_b16 a[42:43], v23 offset:29184
  s_add_u32 m0, s85, 65536
  v_mfma_f32_16x16x32_bf16 v[148:151], a[92:95], a[76:79], v[148:151]
  ds_read_b64_tr_b16 a[44:45], v23 offset:32768
  v_mfma_f32_16x16x32_bf16 v[152:155], a[92:95], a[80:83], v[152:155]
  ds_read_b64_tr_b16 a[46:47], v23 offset:33280
  buffer_load_dwordx4 v17, s[12:15], s82 offen lds
  v_mfma_f32_16x16x32_bf16 v[156:159], a[92:95], a[84:87], v[156:159]
  ds_read_b64_tr_b16 a[48:49], v25 offset:36864
  v_mfma_f32_16x16x32_bf16 a[232:235], a[92:95], a[252:255], a[232:235]
  ds_read_b64_tr_b16 a[50:51], v25 offset:37120
  s_add_u32 s82, s56, 237568
  v_mfma_f32_16x16x32_bf16 v[160:163], a[96:99], a[56:59], v[160:163]
  ds_read_b64_tr_b16 a[52:53], v25 offset:38912
  v_mfma_f32_16x16x32_bf16 v[164:167], a[96:99], a[60:63], v[164:167]
  ds_read_b64_tr_b16 a[54:55], v25 offset:39168
  s_add_u32 m0, s85, 66560
  v_mfma_f32_16x16x32_bf16 v[168:171], a[96:99], a[64:67], v[168:171]
  ds_read_b64_tr_b16 a[112:113], v2 offset:24576
  v_mfma_f32_16x16x32_bf16 v[172:175], a[96:99], a[68:71], v[172:175]
  ds_read_b64_tr_b16 a[114:115], v2 offset:25088
  buffer_load_dwordx4 v17, s[12:15], s82 offen lds
  v_mfma_f32_16x16x32_bf16 v[176:179], a[96:99], a[72:75], v[176:179]
  ds_read_b64_tr_b16 a[116:117], v3 offset:24576
  v_mfma_f32_16x16x32_bf16 v[180:183], a[96:99], a[76:79], v[180:183]
  ds_read_b64_tr_b16 a[118:119], v3 offset:25088
  s_add_u32 s82, s56, 262144
  v_mfma_f32_16x16x32_bf16 v[184:187], a[96:99], a[80:83], v[184:187]
  ds_read_b64_tr_b16 a[120:121], v2 offset:28672
  s_add_u32 m0, s85, 73728
  v_mfma_f32_16x16x32_bf16 v[188:191], a[96:99], a[84:87], v[188:191]
  ds_read_b64_tr_b16 a[122:123], v2 offset:29184
  v_mfma_f32_16x16x32_bf16 a[236:239], a[96:99], a[252:255], a[236:239]
  ds_read_b64_tr_b16 a[124:125], v3 offset:28672
  buffer_load_dwordx4 v17, s[12:15], s82 offen lds
  v_mfma_f32_16x16x32_bf16 v[192:195], a[100:103], a[56:59], v[192:195]
  ds_read_b64_tr_b16 a[126:127], v3 offset:29184
  v_mfma_f32_16x16x32_bf16 v[196:199], a[100:103], a[60:63], v[196:199]
  ds_read_b64_tr_b16 a[128:129], v2 offset:32768
  s_add_u32 s82, s56, 270336
  v_mfma_f32_16x16x32_bf16 v[200:203], a[100:103], a[64:67], v[200:203]
  ds_read_b64_tr_b16 a[130:131], v2 offset:33280
  v_mfma_f32_16x16x32_bf16 v[204:207], a[100:103], a[68:71], v[204:207]
  ds_read_b64_tr_b16 a[132:133], v3 offset:32768
  s_add_u32 m0, s85, 74752
  v_mfma_f32_16x16x32_bf16 v[208:211], a[100:103], a[72:75], v[208:211]
  ds_read_b64_tr_b16 a[134:135], v3 offset:33280
  v_mfma_f32_16x16x32_bf16 v[212:215], a[100:103], a[76:79], v[212:215]
  ds_read_b64_tr_b16 a[136:137], v2 offset:36864
  buffer_load_dwordx4 v17, s[12:15], s82 offen lds
  v_mfma_f32_16x16x32_bf16 v[216:219], a[100:103], a[80:83], v[216:219]
  ds_read_b64_tr_b16 a[138:139], v2 offset:37376
  v_mfma_f32_16x16x32_bf16 v[220:223], a[100:103], a[84:87], v[220:223]
  ds_read_b64_tr_b16 a[140:141], v3 offset:36864
  s_add_u32 s82, s56, 294912
  v_mfma_f32_16x16x32_bf16 a[240:243], a[100:103], a[252:255], a[240:243]
  ds_read_b64_tr_b16 a[142:143], v3 offset:37376
  v_mfma_f32_16x16x32_bf16 v[224:227], a[104:107], a[56:59], v[224:227]
  ds_read_b64_tr_b16 a[144:145], v6 offset:8192
  s_add_u32 m0, s85, 106496
  v_mfma_f32_16x16x32_bf16 v[228:231], a[104:107], a[60:63], v[228:231]
  ds_read_b64_tr_b16 a[146:147], v6 offset:8704
  v_mfma_f32_16x16x32_bf16 v[232:235], a[104:107], a[64:67], v[232:235]
  ds_read_b64_tr_b16 a[148:149], v49 offset:8192
  buffer_load_dwordx4 v17, s[12:15], s82 offen lds
  v_mfma_f32_16x16x32_bf16 v[236:239], a[104:107], a[68:71], v[236:239]
  ds_read_b64_tr_b16 a[150:151], v49 offset:8704
  v_mfma_f32_16x16x32_bf16 a[244:247], a[104:107], a[252:255], a[244:247]
  ds_read_b64_tr_b16 a[152:153], v6 offset:12288
  s_add_u32 s82, s56, 303104
  v_mfma_f32_16x16x32_bf16 v[240:243], a[108:111], a[56:59], v[240:243]
  ds_read_b64_tr_b16 a[154:155], v6 offset:12800
  v_mfma_f32_16x16x32_bf16 v[244:247], a[108:111], a[60:63], v[244:247]
  ds_read_b64_tr_b16 a[156:157], v49 offset:12288
  s_add_u32 m0, s85, 107520
  v_mfma_f32_16x16x32_bf16 v[248:251], a[108:111], a[64:67], v[248:251]
  ds_read_b64_tr_b16 a[158:159], v49 offset:12800
  v_mfma_f32_16x16x32_bf16 v[252:255], a[108:111], a[68:71], v[252:255]
  buffer_load_dwordx4 v17, s[12:15], s82 offen lds
  v_mfma_f32_16x16x32_bf16 a[248:251], a[108:111], a[252:255], a[248:251]
  s_waitcnt vmcnt(12) lgkmcnt(0)
  s_barrier
  v_mfma_f32_16x16x32_bf16 v[96:99], a[32:35], a[0:3], v[96:99]
  ds_read_b128 a[56:59], v19 offset:20480
  s_add_u32 s82, s56, 327680
  v_mfma_f32_16x16x32_bf16 v[100:103], a[32:35], a[4:7], v[100:103]
  ds_read_b128 a[60:63], v19 offset:22528
  s_add_u32 m0, s85, 81920
  v_mfma_f32_16x16x32_bf16 v[104:107], a[32:35], a[8:11], v[104:107]
  ds_read_b128 a[64:67], v19 offset:24576
  buffer_load_dwordx4 v17, s[12:15], s82 offen lds
  v_mfma_f32_16x16x32_bf16 v[108:111], a[32:35], a[12:15], v[108:111]
  ds_read_b128 a[68:71], v19 offset:26624
  s_add_u32 s82, s56, 335872
  v_mfma_f32_16x16x32_bf16 v[112:115], a[32:35], a[16:19], v[112:115]
  ds_read_b128 a[72:75], v21 offset:28672
  v_mfma_f32_16x16x32_bf16 v[116:119], a[32:35], a[20:23], v[116:119]
  ds_read_b128 a[76:79], v21 offset:30720
  s_add_u32 m0, s85, 82944
  v_mfma_f32_16x16x32_bf16 v[120:123], a[32:35], a[24:27], v[120:123]
  ds_read_b128 a[80:83], v21 offset:32768
  buffer_load_dwordx4 v17, s[12:15], s82 offen lds
  v_mfma_f32_16x16x32_bf16 v[124:127], a[32:35], a[28:31], v[124:127]
  ds_read_b128 a[84:87], v21 offset:34816
  s_add_u32 s82, s56, 360448
  v_mfma_f32_16x16x32_bf16 a[228:231], a[32:35], a[252:255], a[228:231]
  ds_read_b64_tr_b16 a[88:89], v22 offset:0
  s_add_u32 m0, s85, 90112
  v_mfma_f32_16x16x32_bf16 v[128:131], a[36:39], a[0:3], v[128:131]
  ds_read_b64_tr_b16 a[90:91], v22 offset:512
  v_mfma_f32_16x16x32_bf16 v[132:135], a[36:39], a[4:7], v[132:135]
  ds_read_b64_tr_b16 a[92:93], v22 offset:4096
  buffer_load_dwordx4 v17, s[12:15], s82 offen lds
  v_mfma_f32_16x16x32_bf16 v[136:139], a[36:39], a[8:11], v[136:139]
  ds_read_b64_tr_b16 a[94:95], v22 offset:4608
  s_add_u32 s82, s56, 368640
  v_mfma_f32_16x16x32_bf16 v[140:143], a[36:39], a[12:15], v[140:143]
  ds_read_b64_tr_b16 a[96:97], v22 offset:8192
  s_add_u32 m0, s85, 91136
  v_mfma_f32_16x16x32_bf16 v[144:147], a[36:39], a[16:19], v[144:147]
  ds_read_b64_tr_b16 a[98:99], v22 offset:8704
  v_mfma_f32_16x16x32_bf16 v[148:151], a[36:39], a[20:23], v[148:151]
  ds_read_b64_tr_b16 a[100:101], v22 offset:12288
  buffer_load_dwordx4 v17, s[12:15], s82 offen lds
  v_mfma_f32_16x16x32_bf16 v[152:155], a[36:39], a[24:27], v[152:155]
  ds_read_b64_tr_b16 a[102:103], v22 offset:12800
  s_add_u32 s82, s56, 393216
  v_mfma_f32_16x16x32_bf16 v[156:159], a[36:39], a[28:31], v[156:159]
  ds_read_b64_tr_b16 a[104:105], v24 offset:16384
  s_add_u32 m0, s85, 98304
  v_mfma_f32_16x16x32_bf16 a[232:235], a[36:39], a[252:255], a[232:235]
  ds_read_b64_tr_b16 a[106:107], v24 offset:16640
  buffer_load_dwordx4 v17, s[12:15], s82 offen lds
  v_mfma_f32_16x16x32_bf16 v[160:163], a[40:43], a[0:3], v[160:163]
  ds_read_b64_tr_b16 a[108:109], v24 offset:18432
  v_mfma_f32_16x16x32_bf16 v[164:167], a[40:43], a[4:7], v[164:167]
  ds_read_b64_tr_b16 a[110:111], v24 offset:18688
  s_add_u32 s82, s56, 401408
  v_mfma_f32_16x16x32_bf16 v[168:171], a[40:43], a[8:11], v[168:171]
  ds_read_b64_tr_b16 a[160:161], v6 offset:16384
  s_add_u32 m0, s85, 99328
  v_mfma_f32_16x16x32_bf16 v[172:175], a[40:43], a[12:15], v[172:175]
  ds_read_b64_tr_b16 a[162:163], v6 offset:16896
  buffer_load_dwordx4 v17, s[12:15], s82 offen lds
  v_mfma_f32_16x16x32_bf16 v[176:179], a[40:43], a[16:19], v[176:179]
  ds_read_b64_tr_b16 a[164:165], v49 offset:16384
  v_mfma_f32_16x16x32_bf16 v[180:183], a[40:43], a[20:23], v[180:183]
  ds_read_b64_tr_b16 a[166:167], v49 offset:16896
  s_add_u32 s61, s57, 98304
  v_mfma_f32_16x16x32_bf16 v[184:187], a[40:43], a[24:27], v[184:187]
  ds_read_b64_tr_b16 a[168:169], v6 offset:20480
  s_add_u32 m0, s85, 24576
  v_mfma_f32_16x16x32_bf16 v[188:191], a[40:43], a[28:31], v[188:191]
  ds_read_b64_tr_b16 a[170:171], v6 offset:20992
  buffer_load_dwordx4 v17, s[12:15], s61 offen lds
  v_mfma_f32_16x16x32_bf16 a[236:239], a[40:43], a[252:255], a[236:239]
  ds_read_b64_tr_b16 a[172:173], v49 offset:20480
  s_add_u32 s61, s57, 106496
  v_mfma_f32_16x16x32_bf16 v[192:195], a[44:47], a[0:3], v[192:195]
  ds_read_b64_tr_b16 a[174:175], v49 offset:20992
  v_mfma_f32_16x16x32_bf16 v[196:199], a[44:47], a[4:7], v[196:199]
  ds_read_b64_tr_b16 a[176:177], v2 offset:40960
  s_add_u32 m0, s85, 25600
  v_mfma_f32_16x16x32_bf16 v[200:203], a[44:47], a[8:11], v[200:203]
  ds_read_b64_tr_b16 a[178:179], v2 offset:41472
  buffer_load_dwordx4 v17, s[12:15], s61 offen lds
  v_mfma_f32_16x16x32_bf16 v[204:207], a[44:47], a[12:15], v[204:207]
  ds_read_b64_tr_b16 a[180:181], v3 offset:40960
  s_add_u32 s61, s53, 0
  v_mfma_f32_16x16x32_bf16 v[208:211], a[44:47], a[16:19], v[208:211]
  ds_read_b64_tr_b16 a[182:183], v3 offset:41472
  s_add_u32 m0, s85, 32768
  v_mfma_f32_16x16x32_bf16 v[212:215], a[44:47], a[20:23], v[212:215]
  ds_read_b64_tr_b16 a[184:185], v2 offset:45056
  v_mfma_f32_16x16x32_bf16 v[216:219], a[44:47], a[24:27], v[216:219]
  ds_read_b64_tr_b16 a[186:187], v2 offset:45568
  buffer_load_dwordx4 v17, s[12:15], s61 offen lds
  v_mfma_f32_16x16x32_bf16 v[220:223], a[44:47], a[28:31], v[220:223]
  ds_read_b64_tr_b16 a[188:189], v3 offset:45056
  s_add_u32 s61, s53, 8192
  v_mfma_f32_16x16x32_bf16 a[240:243], a[44:47], a[252:255], a[240:243]
  ds_read_b64_tr_b16 a[190:191], v3 offset:45568
  s_add_u32 m0, s85, 33792
  v_mfma_f32_16x16x32_bf16 v[224:227], a[48:51], a[0:3], v[224:227]
  ds_read_b64_tr_b16 a[192:193], v2 offset:49152
  v_mfma_f32_16x16x32_bf16 v[228:231], a[48:51], a[4:7], v[228:231]
  ds_read_b64_tr_b16 a[194:195], v2 offset:49664
  buffer_load_dwordx4 v17, s[12:15], s61 offen lds
  v_mfma_f32_16x16x32_bf16 v[232:235], a[48:51], a[8:11], v[232:235]
  ds_read_b64_tr_b16 a[196:197], v3 offset:49152
  s_add_u32 s61, s53, 131072
  v_mfma_f32_16x16x32_bf16 v[236:239], a[48:51], a[12:15], v[236:239]
  ds_read_b64_tr_b16 a[198:199], v3 offset:49664
  s_add_u32 m0, s85, 139264
  v_mfma_f32_16x16x32_bf16 a[244:247], a[48:51], a[252:255], a[244:247]
  ds_read_b64_tr_b16 a[200:201], v2 offset:53248
  buffer_load_dwordx4 v17, s[12:15], s61 offen lds
  v_mfma_f32_16x16x32_bf16 v[240:243], a[52:55], a[0:3], v[240:243]
  ds_read_b64_tr_b16 a[202:203], v2 offset:53760
  v_mfma_f32_16x16x32_bf16 v[244:247], a[52:55], a[4:7], v[244:247]
  ds_read_b64_tr_b16 a[204:205], v3 offset:53248
  s_add_u32 s61, s53, 139264
  v_mfma_f32_16x16x32_bf16 v[248:251], a[52:55], a[8:11], v[248:251]
  ds_read_b64_tr_b16 a[206:207], v3 offset:53760
  s_add_u32 m0, s85, 140288
  v_mfma_f32_16x16x32_bf16 v[252:255], a[52:55], a[12:15], v[252:255]
  buffer_load_dwordx4 v17, s[12:15], s61 offen lds
  v_mfma_f32_16x16x32_bf16 a[248:251], a[52:55], a[252:255], a[248:251]
  s_waitcnt vmcnt(12) lgkmcnt(0)
  s_barrier
  v_mfma_f32_16x16x32_bf16 v[96:99], a[88:91], a[56:59], v[96:99]
  ds_read_b64_tr_b16 a[208:209], v2 offset:57344
  s_add_u32 s61, s53, 163840
  v_mfma_f32_16x16x32_bf16 v[100:103], a[88:91], a[60:63], v[100:103]
  ds_read_b64_tr_b16 a[210:211], v2 offset:57856
  v_mfma_f32_16x16x32_bf16 v[104:107], a[88:91], a[64:67], v[104:107]
  ds_read_b64_tr_b16 a[212:213], v3 offset:57344
  s_add_u32 m0, s85, 147456
  v_mfma_f32_16x16x32_bf16 v[108:111], a[88:91], a[68:71], v[108:111]
  ds_read_b64_tr_b16 a[214:215], v3 offset:57856
  v_mfma_f32_16x16x32_bf16 v[112:115], a[88:91], a[72:75], v[112:115]
  ds_read_b64_tr_b16 a[216:217], v2 offset:61440
  v_mfma_f32_16x16x32_bf16 v[116:119], a[88:91], a[76:79], v[116:119]
  ds_read_b64_tr_b16 a[218:219], v2 offset:61952
  buffer_load_dwordx4 v17, s[12:15], s61 offen lds
  v_mfma_f32_16x16x32_bf16 v[120:123], a[88:91], a[80:83], v[120:123]
  ds_read_b64_tr_b16 a[220:221], v3 offset:61440
  v_mfma_f32_16x16x32_bf16 v[124:127], a[88:91], a[84:87], v[124:127]
  ds_read_b64_tr_b16 a[222:223], v3 offset:61952
  s_add_u32 s61, s53, 172032
  v_mfma_f32_16x16x32_bf16 a[228:231], a[88:91], a[252:255], a[228:231]
  ds_read_b64_tr_b16 a[0:1], v4 offset:0
  v_mfma_f32_16x16x32_bf16 v[128:131], a[92:95], a[56:59], v[128:131]
  ds_read_b64_tr_b16 a[2:3], v4 offset:512
  v_mfma_f32_16x16x32_bf16 v[132:135], a[92:95], a[60:63], v[132:135]
  ds_read_b64_tr_b16 a[4:5], v5 offset:0
  s_add_u32 m0, s85, 148480
  v_mfma_f32_16x16x32_bf16 v[136:139], a[92:95], a[64:67], v[136:139]
  ds_read_b64_tr_b16 a[6:7], v5 offset:512
  v_mfma_f32_16x16x32_bf16 v[140:143], a[92:95], a[68:71], v[140:143]
  ds_read_b64_tr_b16 a[8:9], v4 offset:4096
  buffer_load_dwordx4 v17, s[12:15], s61 offen lds
  v_mfma_f32_16x16x32_bf16 v[144:147], a[92:95], a[72:75], v[144:147]
  ds_read_b64_tr_b16 a[10:11], v4 offset:4608
  v_mfma_f32_16x16x32_bf16 v[148:151], a[92:95], a[76:79], v[148:151]
  ds_read_b64_tr_b16 a[12:13], v5 offset:4096
  v_mfma_f32_16x16x32_bf16 v[152:155], a[92:95], a[80:83], v[152:155]
  ds_read_b64_tr_b16 a[14:15], v5 offset:4608
  s_add_u32 s61, s53, 32768
  v_mfma_f32_16x16x32_bf16 v[156:159], a[92:95], a[84:87], v[156:159]
  ds_read_b64_tr_b16 a[16:17], v4 offset:8192
  v_mfma_f32_16x16x32_bf16 a[232:235], a[92:95], a[252:255], a[232:235]
  ds_read_b64_tr_b16 a[18:19], v4 offset:8704
  s_add_u32 m0, s85, 40960
  v_mfma_f32_16x16x32_bf16 v[160:163], a[96:99], a[56:59], v[160:163]
  ds_read_b64_tr_b16 a[20:21], v5 offset:8192
  v_mfma_f32_16x16x32_bf16 v[164:167], a[96:99], a[60:63], v[164:167]
  ds_read_b64_tr_b16 a[22:23], v5 offset:8704
  v_mfma_f32_16x16x32_bf16 v[168:171], a[96:99], a[64:67], v[168:171]
  ds_read_b64_tr_b16 a[24:25], v4 offset:12288
  buffer_load_dwordx4 v17, s[12:15], s61 offen lds
  v_mfma_f32_16x16x32_bf16 v[172:175], a[96:99], a[68:71], v[172:175]
  ds_read_b64_tr_b16 a[26:27], v4 offset:12800
  v_mfma_f32_16x16x32_bf16 v[176:179], a[96:99], a[72:75], v[176:179]
  ds_read_b64_tr_b16 a[28:29], v5 offset:12288
  v_mfma_f32_16x16x32_bf16 v[180:183], a[96:99], a[76:79], v[180:183]
  ds_read_b64_tr_b16 a[30:31], v5 offset:12800
  s_add_u32 s61, s53, 40960
  v_mfma_f32_16x16x32_bf16 v[184:187], a[96:99], a[80:83], v[184:187]
  ds_read_b64_tr_b16 a[32:33], v4 offset:40960
  v_mfma_f32_16x16x32_bf16 v[188:191], a[96:99], a[84:87], v[188:191]
  ds_read_b64_tr_b16 a[34:35], v4 offset:41472
  s_add_u32 m0, s85, 41984
  v_mfma_f32_16x16x32_bf16 a[236:239], a[96:99], a[252:255], a[236:239]
  ds_read_b64_tr_b16 a[36:37], v5 offset:40960
  v_mfma_f32_16x16x32_bf16 v[192:195], a[100:103], a[56:59], v[192:195]
  ds_read_b64_tr_b16 a[38:39], v5 offset:41472
  v_mfma_f32_16x16x32_bf16 v[196:199], a[100:103], a[60:63], v[196:199]
  ds_read_b64_tr_b16 a[40:41], v4 offset:45056
  buffer_load_dwordx4 v17, s[12:15], s61 offen lds
  v_mfma_f32_16x16x32_bf16 v[200:203], a[100:103], a[64:67], v[200:203]
  ds_read_b64_tr_b16 a[42:43], v4 offset:45568
  v_mfma_f32_16x16x32_bf16 v[204:207], a[100:103], a[68:71], v[204:207]
  ds_read_b64_tr_b16 a[44:45], v5 offset:45056
  s_add_u32 s61, s53, 65536
  v_mfma_f32_16x16x32_bf16 v[208:211], a[100:103], a[72:75], v[208:211]
  ds_read_b64_tr_b16 a[46:47], v5 offset:45568
  v_mfma_f32_16x16x32_bf16 v[212:215], a[100:103], a[76:79], v[212:215]
  v_mfma_f32_16x16x32_bf16 v[216:219], a[100:103], a[80:83], v[216:219]
  s_add_u32 m0, s85, 49152
  v_mfma_f32_16x16x32_bf16 v[220:223], a[100:103], a[84:87], v[220:223]
  v_mfma_f32_16x16x32_bf16 a[240:243], a[100:103], a[252:255], a[240:243]
  buffer_load_dwordx4 v17, s[12:15], s61 offen lds
  v_mfma_f32_16x16x32_bf16 v[224:227], a[104:107], a[56:59], v[224:227]
  v_mfma_f32_16x16x32_bf16 v[228:231], a[104:107], a[60:63], v[228:231]
  v_mfma_f32_16x16x32_bf16 v[232:235], a[104:107], a[64:67], v[232:235]
  s_add_u32 s61, s53, 73728
  v_mfma_f32_16x16x32_bf16 v[236:239], a[104:107], a[68:71], v[236:239]
  v_mfma_f32_16x16x32_bf16 a[244:247], a[104:107], a[252:255], a[244:247]
  s_add_u32 m0, s85, 50176
  v_mfma_f32_16x16x32_bf16 v[240:243], a[108:111], a[56:59], v[240:243]
  v_mfma_f32_16x16x32_bf16 v[244:247], a[108:111], a[60:63], v[244:247]
  v_mfma_f32_16x16x32_bf16 v[248:251], a[108:111], a[64:67], v[248:251]
  buffer_load_dwordx4 v17, s[12:15], s61 offen lds
  v_mfma_f32_16x16x32_bf16 v[252:255], a[108:111], a[68:71], v[252:255]
  v_mfma_f32_16x16x32_bf16 a[248:251], a[108:111], a[252:255], a[248:251]
  s_waitcnt lgkmcnt(0)
L_epi1:
  v_accvgpr_read_b32 v8, a228
  v_accvgpr_read_b32 v9, a229
  v_accvgpr_read_b32 v10, a230
  v_accvgpr_read_b32 v11, a231
  v_accvgpr_read_b32 v12, a232
  v_accvgpr_read_b32 v13, a233
  v_accvgpr_read_b32 v14, a234
  v_accvgpr_read_b32 v15, a235
  v_accvgpr_read_b32 v44, a236
  v_accvgpr_read_b32 v45, a237
  v_accvgpr_read_b32 v46, a238
  v_accvgpr_read_b32 v47, a239
  v_accvgpr_read_b32 v48, a240
  v_accvgpr_read_b32 v49, a241
  v_accvgpr_read_b32 v50, a242
  v_accvgpr_read_b32 v51, a243
  v_accvgpr_read_b32 v52, a244
  v_accvgpr_read_b32 v53, a245
  v_accvgpr_read_b32 v54, a246
  v_accvgpr_read_b32 v55, a247
  v_accvgpr_read_b32 v56, a248
  v_accvgpr_read_b32 v57, a249
  v_accvgpr_read_b32 v58, a250
  v_accvgpr_read_b32 v59, a251
  v_pk_fma_f32 v[96:97], v[8:9], v[60:61], v[96:97] op_sel:[0,1,0] op_sel_hi:[1,1,1] neg_lo:[0,1,0] neg_hi:[0,1,0]
  v_pk_fma_f32 v[100:101], v[8:9], v[62:63], v[100:101] op_sel:[0,1,0] op_sel_hi:[1,1,1] neg_lo:[0,1,0] neg_hi:[0,1,0]
  v_pk_fma_f32 v[98:99], v[10:11], v[60:61], v[98:99] op_sel:[0,1,0] op_sel_hi:[1,1,1] neg_lo:[0,1,0] neg_hi:[0,1,0]
  v_pk_fma_f32 v[102:103], v[10:11], v[62:63], v[102:103] op_sel:[0,1,0] op_sel_hi:[1,1,1] neg_lo:[0,1,0] neg_hi:[0,1,0]
  v_pk_fma_f32 v[128:129], v[12:13], v[60:61], v[128:129] op_sel:[0,1,0] op_sel_hi:[1,1,1] neg_lo:[0,1,0] neg_hi:[0,1,0]
  v_pk_fma_f32 v[132:133], v[12:13], v[62:63], v[132:133] op_sel:[0,1,0] op_sel_hi:[1,1,1] neg_lo:[0,1,0] neg_hi:[0,1,0]
  v_pk_fma_f32 v[130:131], v[14:15], v[60:61], v[130:131] op_sel:[0,1,0] op_sel_hi:[1,1,1] neg_lo:[0,1,0] neg_hi:[0,1,0]
  v_pk_fma_f32 v[134:135], v[14:15], v[62:63], v[134:135] op_sel:[0,1,0] op_sel_hi:[1,1,1] neg_lo:[0,1,0] neg_hi:[0,1,0]
  v_pk_mul_f32 v[96:97], v[96:97], v[128:129]
  v_pk_mul_f32 v[100:101], v[100:101], v[132:133]
  v_pk_mul_f32 v[98:99], v[98:99], v[130:131]
  v_pk_mul_f32 v[102:103], v[102:103], v[134:135]
  v_cvt_pk_bf16_f32 v128, v96, v97
  v_cvt_pk_bf16_f32 v130, v100, v101
  v_cvt_pk_bf16_f32 v129, v98, v99
  v_cvt_pk_bf16_f32 v131, v102, v103
  v_permlane16_swap_b32 v128, v130
  s_nop 0
  v_permlane16_swap_b32 v129, v131
  buffer_store_dwordx4 v[128:131], v26, s[20:23], s88 offen sc1
  v_pk_fma_f32 v[104:105], v[8:9], v[64:65], v[104:105] op_sel:[0,1,0] op_sel_hi:[1,1,1] neg_lo:[0,1,0] neg_hi:[0,1,0]
  v_pk_fma_f32 v[108:109], v[8:9], v[66:67], v[108:109] op_sel:[0,1,0] op_sel_hi:[1,1,1] neg_lo:[0,1,0] neg_hi:[0,1,0]
  v_pk_fma_f32 v[106:107], v[10:11], v[64:65], v[106:107] op_sel:[0,1,0] op_sel_hi:[1,1,1] neg_lo:[0,1,0] neg_hi:[0,1,0]
  v_pk_fma_f32 v[110:111], v[10:11], v[66:67], v[110:111] op_sel:[0,1,0] op_sel_hi:[1,1,1] neg_lo:[0,1,0] neg_hi:[0,1,0]
  v_pk_fma_f32 v[136:137], v[12:13], v[64:65], v[136:137] op_sel:[0,1,0] op_sel_hi:[1,1,1] neg_lo:[0,1,0] neg_hi:[0,1,0]
  v_pk_fma_f32 v[140:141], v[12:13], v[66:67], v[140:141] op_sel:[0,1,0] op_sel_hi:[1,1,1] neg_lo:[0,1,0] neg_hi:[0,1,0]
  v_pk_fma_f32 v[138:139], v[14:15], v[64:65], v[138:139] op_sel:[0,1,0] op_sel_hi:[1,1,1] neg_lo:[0,1,0] neg_hi:[0,1,0]
  v_pk_fma_f32 v[142:143], v[14:15], v[66:67], v[142:143] op_sel:[0,1,0] op_sel_hi:[1,1,1] neg_lo:[0,1,0] neg_hi:[0,1,0]
  v_pk_mul_f32 v[104:105], v[104:105], v[136:137]
  v_pk_mul_f32 v[108:109], v[108:109], v[140:141]
  v_pk_mul_f32 v[106:107], v[106:107], v[138:139]
  v_pk_mul_f32 v[110:111], v[110:111], v[142:143]
  v_cvt_pk_bf16_f32 v136, v104, v105
  v_cvt_pk_bf16_f32 v138, v108, v109
  v_cvt_pk_bf16_f32 v137, v106, v107
  v_cvt_pk_bf16_f32 v139, v110, v111
  v_permlane16_swap_b32 v136, v138
  s_nop 0
  v_permlane16_swap_b32 v137, v139
  buffer_store_dwordx4 v[136:139], v27, s[20:23], s88 offen sc1
  v_pk_fma_f32 v[112:113], v[8:9], v[68:69], v[112:113] op_sel:[0,1,0] op_sel_hi:[1,1,1] neg_lo:[0,1,0] neg_hi:[0,1,0]
  v_pk_fma_f32 v[116:117], v[8:9], v[70:71], v[116:117] op_sel:[0,1,0] op_sel_hi:[1,1,1] neg_lo:[0,1,0] neg_hi:[0,1,0]
  v_pk_fma_f32 v[114:115], v[10:11], v[68:69], v[114:115] op_sel:[0,1,0] op_sel_hi:[1,1,1] neg_lo:[0,1,0] neg_hi:[0,1,0]
  v_pk_fma_f32 v[118:119], v[10:11], v[70:71], v[118:119] op_sel:[0,1,0] op_sel_hi:[1,1,1] neg_lo:[0,1,0] neg_hi:[0,1,0]
  v_pk_fma_f32 v[144:145], v[12:13], v[68:69], v[144:145] op_sel:[0,1,0] op_sel_hi:[1,1,1] neg_lo:[0,1,0] neg_hi:[0,1,0]
  v_pk_fma_f32 v[148:149], v[12:13], v[70:71], v[148:149] op_sel:[0,1,0] op_sel_hi:[1,1,1] neg_lo:[0,1,0] neg_hi:[0,1,0]
  v_pk_fma_f32 v[146:147], v[14:15], v[68:69], v[146:147] op_sel:[0,1,0] op_sel_hi:[1,1,1] neg_lo:[0,1,0] neg_hi:[0,1,0]
  v_pk_fma_f32 v[150:151], v[14:15], v[70:71], v[150:151] op_sel:[0,1,0] op_sel_hi:[1,1,1] neg_lo:[0,1,0] neg_hi:[0,1,0]
  v_pk_mul_f32 v[112:113], v[112:113], v[144:145]
  v_pk_mul_f32 v[116:117], v[116:117], v[148:149]
  v_pk_mul_f32 v[114:115], v[114:115], v[146:147]
  v_pk_mul_f32 v[118:119], v[118:119], v[150:151]
  v_cvt_pk_bf16_f32 v144, v112, v113
  v_cvt_pk_bf16_f32 v146, v116, v117
  v_cvt_pk_bf16_f32 v145, v114, v115
  v_cvt_pk_bf16_f32 v147, v118, v119
  v_permlane16_swap_b32 v144, v146
  s_nop 0
  v_permlane16_swap_b32 v145, v147
  buffer_store_dwordx4 v[144:147], v28, s[20:23], s88 offen sc1
  v_pk_fma_f32 v[120:121], v[8:9], v[72:73], v[120:121] op_sel:[0,1,0] op_sel_hi:[1,1,1] neg_lo:[0,1,0] neg_hi:[0,1,0]
  v_pk_fma_f32 v[124:125], v[8:9], v[74:75], v[124:125] op_sel:[0,1,0] op_sel_hi:[1,1,1] neg_lo:[0,1,0] neg_hi:[0,1,0]
  v_pk_fma_f32 v[122:123], v[10:11], v[72:73], v[122:123] op_sel:[0,1,0] op_sel_hi:[1,1,1] neg_lo:[0,1,0] neg_hi:[0,1,0]
  v_pk_fma_f32 v[126:127], v[10:11], v[74:75], v[126:127] op_sel:[0,1,0] op_sel_hi:[1,1,1] neg_lo:[0,1,0] neg_hi:[0,1,0]
  v_pk_fma_f32 v[152:153], v[12:13], v[72:73], v[152:153] op_sel:[0,1,0] op_sel_hi:[1,1,1] neg_lo:[0,1,0] neg_hi:[0,1,0]
  v_pk_fma_f32 v[156:157], v[12:13], v[74:75], v[156:157] op_sel:[0,1,0] op_sel_hi:[1,1,1] neg_lo:[0,1,0] neg_hi:[0,1,0]
  v_pk_fma_f32 v[154:155], v[14:15], v[72:73], v[154:155] op_sel:[0,1,0] op_sel_hi:[1,1,1] neg_lo:[0,1,0] neg_hi:[0,1,0]
  v_pk_fma_f32 v[158:159], v[14:15], v[74:75], v[158:159] op_sel:[0,1,0] op_sel_hi:[1,1,1] neg_lo:[0,1,0] neg_hi:[0,1,0]
  v_pk_mul_f32 v[120:121], v[120:121], v[152:153]
  v_pk_mul_f32 v[124:125], v[124:125], v[156:157]
  v_pk_mul_f32 v[122:123], v[122:123], v[154:155]
  v_pk_mul_f32 v[126:127], v[126:127], v[158:159]
  v_cvt_pk_bf16_f32 v152, v120, v121
  v_cvt_pk_bf16_f32 v154, v124, v125
  v_cvt_pk_bf16_f32 v153, v122, v123
  v_cvt_pk_bf16_f32 v155, v126, v127
  v_permlane16_swap_b32 v152, v154
  s_nop 0
  v_permlane16_swap_b32 v153, v155
  buffer_store_dwordx4 v[152:155], v29, s[20:23], s88 offen sc1
  v_pk_fma_f32 v[160:161], v[44:45], v[60:61], v[160:161] op_sel:[0,1,0] op_sel_hi:[1,1,1] neg_lo:[0,1,0] neg_hi:[0,1,0]
  v_pk_fma_f32 v[164:165], v[44:45], v[62:63], v[164:165] op_sel:[0,1,0] op_sel_hi:[1,1,1] neg_lo:[0,1,0] neg_hi:[0,1,0]
  v_pk_fma_f32 v[162:163], v[46:47], v[60:61], v[162:163] op_sel:[0,1,0] op_sel_hi:[1,1,1] neg_lo:[0,1,0] neg_hi:[0,1,0]
  v_pk_fma_f32 v[166:167], v[46:47], v[62:63], v[166:167] op_sel:[0,1,0] op_sel_hi:[1,1,1] neg_lo:[0,1,0] neg_hi:[0,1,0]
  v_pk_fma_f32 v[192:193], v[48:49], v[60:61], v[192:193] op_sel:[0,1,0] op_sel_hi:[1,1,1] neg_lo:[0,1,0] neg_hi:[0,1,0]
  v_pk_fma_f32 v[196:197], v[48:49], v[62:63], v[196:197] op_sel:[0,1,0] op_sel_hi:[1,1,1] neg_lo:[0,1,0] neg_hi:[0,1,0]
  v_pk_fma_f32 v[194:195], v[50:51], v[60:61], v[194:195] op_sel:[0,1,0] op_sel_hi:[1,1,1] neg_lo:[0,1,0] neg_hi:[0,1,0]
  v_pk_fma_f32 v[198:199], v[50:51], v[62:63], v[198:199] op_sel:[0,1,0] op_sel_hi:[1,1,1] neg_lo:[0,1,0] neg_hi:[0,1,0]
  v_pk_mul_f32 v[160:161], v[160:161], v[192:193]
  v_pk_mul_f32 v[164:165], v[164:165], v[196:197]
  v_pk_mul_f32 v[162:163], v[162:163], v[194:195]
  v_pk_mul_f32 v[166:167], v[166:167], v[198:199]
  v_cvt_pk_bf16_f32 v192, v160, v161
  v_cvt_pk_bf16_f32 v194, v164, v165
  v_cvt_pk_bf16_f32 v193, v162, v163
  v_cvt_pk_bf16_f32 v195, v166, v167
  v_permlane16_swap_b32 v192, v194
  s_nop 0
  v_permlane16_swap_b32 v193, v195
  buffer_store_dwordx4 v[192:195], v26, s[20:23], s89 offen sc1
  v_pk_fma_f32 v[168:169], v[44:45], v[64:65], v[168:169] op_sel:[0,1,0] op_sel_hi:[1,1,1] neg_lo:[0,1,0] neg_hi:[0,1,0]
  v_pk_fma_f32 v[172:173], v[44:45], v[66:67], v[172:173] op_sel:[0,1,0] op_sel_hi:[1,1,1] neg_lo:[0,1,0] neg_hi:[0,1,0]
  v_pk_fma_f32 v[170:171], v[46:47], v[64:65], v[170:171] op_sel:[0,1,0] op_sel_hi:[1,1,1] neg_lo:[0,1,0] neg_hi:[0,1,0]
  v_pk_fma_f32 v[174:175], v[46:47], v[66:67], v[174:175] op_sel:[0,1,0] op_sel_hi:[1,1,1] neg_lo:[0,1,0] neg_hi:[0,1,0]
  v_pk_fma_f32 v[200:201], v[48:49], v[64:65], v[200:201] op_sel:[0,1,0] op_sel_hi:[1,1,1] neg_lo:[0,1,0] neg_hi:[0,1,0]
  v_pk_fma_f32 v[204:205], v[48:49], v[66:67], v[204:205] op_sel:[0,1,0] op_sel_hi:[1,1,1] neg_lo:[0,1,0] neg_hi:[0,1,0]
  v_pk_fma_f32 v[202:203], v[50:51], v[64:65], v[202:203] op_sel:[0,1,0] op_sel_hi:[1,1,1] neg_lo:[0,1,0] neg_hi:[0,1,0]
  v_pk_fma_f32 v[206:207], v[50:51], v[66:67], v[206:207] op_sel:[0,1,0] op_sel_hi:[1,1,1] neg_lo:[0,1,0] neg_hi:[0,1,0]
  v_pk_mul_f32 v[168:169], v[168:169], v[200:201]
  v_pk_mul_f32 v[172:173], v[172:173], v[204:205]
  v_pk_mul_f32 v[170:171], v[170:171], v[202:203]
  v_pk_mul_f32 v[174:175], v[174:175], v[206:207]
  v_cvt_pk_bf16_f32 v200, v168, v169
  v_cvt_pk_bf16_f32 v202, v172, v173
  v_cvt_pk_bf16_f32 v201, v170, v171
  v_cvt_pk_bf16_f32 v203, v174, v175
  v_permlane16_swap_b32 v200, v202
  s_nop 0
  v_permlane16_swap_b32 v201, v203
  buffer_store_dwordx4 v[200:203], v27, s[20:23], s89 offen sc1
  v_pk_fma_f32 v[176:177], v[44:45], v[68:69], v[176:177] op_sel:[0,1,0] op_sel_hi:[1,1,1] neg_lo:[0,1,0] neg_hi:[0,1,0]
  v_pk_fma_f32 v[180:181], v[44:45], v[70:71], v[180:181] op_sel:[0,1,0] op_sel_hi:[1,1,1] neg_lo:[0,1,0] neg_hi:[0,1,0]
  v_pk_fma_f32 v[178:179], v[46:47], v[68:69], v[178:179] op_sel:[0,1,0] op_sel_hi:[1,1,1] neg_lo:[0,1,0] neg_hi:[0,1,0]
  v_pk_fma_f32 v[182:183], v[46:47], v[70:71], v[182:183] op_sel:[0,1,0] op_sel_hi:[1,1,1] neg_lo:[0,1,0] neg_hi:[0,1,0]
  v_pk_fma_f32 v[208:209], v[48:49], v[68:69], v[208:209] op_sel:[0,1,0] op_sel_hi:[1,1,1] neg_lo:[0,1,0] neg_hi:[0,1,0]
  v_pk_fma_f32 v[212:213], v[48:49], v[70:71], v[212:213] op_sel:[0,1,0] op_sel_hi:[1,1,1] neg_lo:[0,1,0] neg_hi:[0,1,0]
  v_pk_fma_f32 v[210:211], v[50:51], v[68:69], v[210:211] op_sel:[0,1,0] op_sel_hi:[1,1,1] neg_lo:[0,1,0] neg_hi:[0,1,0]
  v_pk_fma_f32 v[214:215], v[50:51], v[70:71], v[214:215] op_sel:[0,1,0] op_sel_hi:[1,1,1] neg_lo:[0,1,0] neg_hi:[0,1,0]
  v_pk_mul_f32 v[176:177], v[176:177], v[208:209]
  v_pk_mul_f32 v[180:181], v[180:181], v[212:213]
  v_pk_mul_f32 v[178:179], v[178:179], v[210:211]
  v_pk_mul_f32 v[182:183], v[182:183], v[214:215]
  v_cvt_pk_bf16_f32 v208, v176, v177
  v_cvt_pk_bf16_f32 v210, v180, v181
  v_cvt_pk_bf16_f32 v209, v178, v179
  v_cvt_pk_bf16_f32 v211, v182, v183
  v_permlane16_swap_b32 v208, v210
  s_nop 0
  v_permlane16_swap_b32 v209, v211
  buffer_store_dwordx4 v[208:211], v28, s[20:23], s89 offen sc1
  v_pk_fma_f32 v[184:185], v[44:45], v[72:73], v[184:185] op_sel:[0,1,0] op_sel_hi:[1,1,1] neg_lo:[0,1,0] neg_hi:[0,1,0]
  v_pk_fma_f32 v[188:189], v[44:45], v[74:75], v[188:189] op_sel:[0,1,0] op_sel_hi:[1,1,1] neg_lo:[0,1,0] neg_hi:[0,1,0]
  v_pk_fma_f32 v[186:187], v[46:47], v[72:73], v[186:187] op_sel:[0,1,0] op_sel_hi:[1,1,1] neg_lo:[0,1,0] neg_hi:[0,1,0]
  v_pk_fma_f32 v[190:191], v[46:47], v[74:75], v[190:191] op_sel:[0,1,0] op_sel_hi:[1,1,1] neg_lo:[0,1,0] neg_hi:[0,1,0]
  v_pk_fma_f32 v[216:217], v[48:49], v[72:73], v[216:217] op_sel:[0,1,0] op_sel_hi:[1,1,1] neg_lo:[0,1,0] neg_hi:[0,1,0]
  v_pk_fma_f32 v[220:221], v[48:49], v[74:75], v[220:221] op_sel:[0,1,0] op_sel_hi:[1,1,1] neg_lo:[0,1,0] neg_hi:[0,1,0]
  v_pk_fma_f32 v[218:219], v[50:51], v[72:73], v[218:219] op_sel:[0,1,0] op_sel_hi:[1,1,1] neg_lo:[0,1,0] neg_hi:[0,1,0]
  v_pk_fma_f32 v[222:223], v[50:51], v[74:75], v[222:223] op_sel:[0,1,0] op_sel_hi:[1,1,1] neg_lo:[0,1,0] neg_hi:[0,1,0]
  v_pk_mul_f32 v[184:185], v[184:185], v[216:217]
  v_pk_mul_f32 v[188:189], v[188:189], v[220:221]
  v_pk_mul_f32 v[186:187], v[186:187], v[218:219]
  v_pk_mul_f32 v[190:191], v[190:191], v[222:223]
  v_cvt_pk_bf16_f32 v216, v184, v185
  v_cvt_pk_bf16_f32 v218, v188, v189
  v_cvt_pk_bf16_f32 v217, v186, v187
  v_cvt_pk_bf16_f32 v219, v190, v191
  v_permlane16_swap_b32 v216, v218
  s_nop 0
  v_permlane16_swap_b32 v217, v219
  buffer_store_dwordx4 v[216:219], v29, s[20:23], s89 offen sc1
  v_pk_fma_f32 v[224:225], v[52:53], v[60:61], v[224:225] op_sel:[0,1,0] op_sel_hi:[1,1,1] neg_lo:[0,1,0] neg_hi:[0,1,0]
  v_pk_fma_f32 v[228:229], v[52:53], v[62:63], v[228:229] op_sel:[0,1,0] op_sel_hi:[1,1,1] neg_lo:[0,1,0] neg_hi:[0,1,0]
  v_pk_fma_f32 v[226:227], v[54:55], v[60:61], v[226:227] op_sel:[0,1,0] op_sel_hi:[1,1,1] neg_lo:[0,1,0] neg_hi:[0,1,0]
  v_pk_fma_f32 v[230:231], v[54:55], v[62:63], v[230:231] op_sel:[0,1,0] op_sel_hi:[1,1,1] neg_lo:[0,1,0] neg_hi:[0,1,0]
  v_pk_fma_f32 v[240:241], v[56:57], v[60:61], v[240:241] op_sel:[0,1,0] op_sel_hi:[1,1,1] neg_lo:[0,1,0] neg_hi:[0,1,0]
  v_pk_fma_f32 v[244:245], v[56:57], v[62:63], v[244:245] op_sel:[0,1,0] op_sel_hi:[1,1,1] neg_lo:[0,1,0] neg_hi:[0,1,0]
  v_pk_fma_f32 v[242:243], v[58:59], v[60:61], v[242:243] op_sel:[0,1,0] op_sel_hi:[1,1,1] neg_lo:[0,1,0] neg_hi:[0,1,0]
  v_pk_fma_f32 v[246:247], v[58:59], v[62:63], v[246:247] op_sel:[0,1,0] op_sel_hi:[1,1,1] neg_lo:[0,1,0] neg_hi:[0,1,0]
  v_pk_mul_f32 v[224:225], v[224:225], v[240:241]
  v_pk_mul_f32 v[228:229], v[228:229], v[244:245]
  v_pk_mul_f32 v[226:227], v[226:227], v[242:243]
  v_pk_mul_f32 v[230:231], v[230:231], v[246:247]
  v_cvt_pk_bf16_f32 v240, v224, v225
  v_cvt_pk_bf16_f32 v242, v228, v229
  v_cvt_pk_bf16_f32 v241, v226, v227
  v_cvt_pk_bf16_f32 v243, v230, v231
  v_permlane16_swap_b32 v240, v242
  s_nop 0
  v_permlane16_swap_b32 v241, v243
  buffer_store_dwordx4 v[240:243], v26, s[20:23], s90 offen sc1
  v_pk_fma_f32 v[232:233], v[52:53], v[64:65], v[232:233] op_sel:[0,1,0] op_sel_hi:[1,1,1] neg_lo:[0,1,0] neg_hi:[0,1,0]
  v_pk_fma_f32 v[236:237], v[52:53], v[66:67], v[236:237] op_sel:[0,1,0] op_sel_hi:[1,1,1] neg_lo:[0,1,0] neg_hi:[0,1,0]
  v_pk_fma_f32 v[234:235], v[54:55], v[64:65], v[234:235] op_sel:[0,1,0] op_sel_hi:[1,1,1] neg_lo:[0,1,0] neg_hi:[0,1,0]
  v_pk_fma_f32 v[238:239], v[54:55], v[66:67], v[238:239] op_sel:[0,1,0] op_sel_hi:[1,1,1] neg_lo:[0,1,0] neg_hi:[0,1,0]
  v_pk_fma_f32 v[248:249], v[56:57], v[64:65], v[248:249] op_sel:[0,1,0] op_sel_hi:[1,1,1] neg_lo:[0,1,0] neg_hi:[0,1,0]
  v_pk_fma_f32 v[252:253], v[56:57], v[66:67], v[252:253] op_sel:[0,1,0] op_sel_hi:[1,1,1] neg_lo:[0,1,0] neg_hi:[0,1,0]
  v_pk_fma_f32 v[250:251], v[58:59], v[64:65], v[250:251] op_sel:[0,1,0] op_sel_hi:[1,1,1] neg_lo:[0,1,0] neg_hi:[0,1,0]
  v_pk_fma_f32 v[254:255], v[58:59], v[66:67], v[254:255] op_sel:[0,1,0] op_sel_hi:[1,1,1] neg_lo:[0,1,0] neg_hi:[0,1,0]
  v_pk_mul_f32 v[232:233], v[232:233], v[248:249]
  v_pk_mul_f32 v[236:237], v[236:237], v[252:253]
  v_pk_mul_f32 v[234:235], v[234:235], v[250:251]
  v_pk_mul_f32 v[238:239], v[238:239], v[254:255]
  v_cvt_pk_bf16_f32 v248, v232, v233
  v_cvt_pk_bf16_f32 v250, v236, v237
  v_cvt_pk_bf16_f32 v249, v234, v235
  v_cvt_pk_bf16_f32 v251, v238, v239
  v_permlane16_swap_b32 v248, v250
  s_nop 0
  v_permlane16_swap_b32 v249, v251
  buffer_store_dwordx4 v[248:251], v27, s[20:23], s90 offen sc1
  s_waitcnt vmcnt(40)
  v_accvgpr_write_b32 a56, v30
  v_accvgpr_write_b32 a57, v31
  v_accvgpr_write_b32 a58, v32
  v_accvgpr_write_b32 a59, v33
  v_accvgpr_write_b32 a60, v34
  v_accvgpr_write_b32 a61, v35
  v_accvgpr_write_b32 a62, v36
  v_accvgpr_write_b32 a63, v37
  v_accvgpr_write_b32 a64, v38
  v_accvgpr_write_b32 a65, v39
  v_accvgpr_write_b32 a66, v40
  v_accvgpr_write_b32 a67, v41
  v_accvgpr_write_b32 a68, v88
  v_accvgpr_write_b32 a69, v89
  v_accvgpr_write_b32 a70, v90
  v_accvgpr_write_b32 a71, v91
  s_lshl_b32 s84, s69, 2
  s_lshr_b32 s83, s70, 2
  s_add_u32 s84, s84, s83
  s_lshl_b32 s84, s84, 6
  s_and_b32 s83, s70, 3
  s_lshl_b32 s83, s83, 2
  s_add_u32 s84, s84, s83
  s_add_u32 s84, s84, s68
  s_lshl_b32 s84, s84, 3
  s_add_u32 s84, s84, 9502720
  s_lshl_b32 s83, s68, 27
  s_add_u32 s84, s84, s83
  s_lshr_b32 s81, s71, 1
  s_lshl_b32 s81, s81, 1
  s_and_b32 s83, s68, 1
  s_add_u32 s81, s81, s83
  s_lshl_b32 s81, s81, 10
  s_add_u32 s81, s81, 9502720
  v_and_b32 v16, 15, v1
  v_lshlrev_b32 v16, 3, v16
  v_bfe_u32 v58, v1, 4, 1
  v_lshl_add_u32 v16, v58, 9, v16
  s_lshl_b32 s82, s71, 1
  s_lshr_b32 s83, s68, 1
  s_add_u32 s82, s82, s83
  s_lshl_b32 s59, s82, 5
  s_mul_i32 s82, s82, 147456
  s_and_b32 s83, s68, 1
  s_lshl_b32 s48, s83, 14
  s_add_u32 s48, s48, s82
  s_add_u32 s49, s48, 32768
  s_lshl_b32 s50, s83, 15
  s_add_u32 s50, s50, s82
  s_add_u32 s50, s50, 65536
  s_lshl_b32 s51, s83, 13
  s_add_u32 s51, s51, s82
  s_add_u32 s51, s51, 131072
  v_lshlrev_b32 v2, 4, v1
  v_lshrrev_b32 v4, 2, v1
  v_add_u32 v6, s59, v4
  v_and_b32 v5, 3, v1
  v_lshlrev_b32 v3, 4, v5
  v_lshl_add_u32 v6, v6, 10, v3
  s_lshl_b32 s82, s72, 7
  s_lshl_b32 s83, s83, 6
  s_add_u32 s82, s82, s83
  v_add_u32 v34, s82, v6
  v_add_u32 v35, 0x4000, v34
  buffer_load_dwordx4 v[36:39], v34, s[4:7], 0 offen
  buffer_load_dwordx4 v[40:43], v35, s[4:7], 0 offen
  v_and_b32 v6, 31, v1
  v_add_u32 v3, s59, v6
  v_lshlrev_b32 v33, 4, v3
  v_add_u32 v24, s85, v2
  v_add_u32 v25, 0x10000, v24
  v_add_u32 v26, 0x20000, v24
  v_xor_b32 v27, 0x800, v24
  v_lshrrev_b32 v3, 5, v1
  v_bfe_u32 v29, v1, 1, 2
  v_xor_b32 v3, v3, v29
  v_lshlrev_b32 v3, 4, v3
  v_lshl_add_u32 v3, v6, 6, v3
  s_add_u32 s82, s85, 57344
  v_add_u32 v29, s82, v3
  v_xor_b32 v30, 32, v29
  v_bfe_u32 v3, v1, 3, 2
  v_xor_b32 v3, v3, v5
  v_lshlrev_b32 v3, 4, v3
  v_lshl_add_u32 v3, v4, 6, v3
  v_add_u32 v31, s82, v3
  s_and_b32 s83, s68, 1
  s_lshl_b32 s83, s83, 6
  v_lshrrev_b32 v4, 5, v1
  v_lshlrev_b32 v4, 10, v4
  v_bfe_u32 v6, v1, 2, 2
  v_lshl_add_u32 v4, v6, 7, v4
  v_lshrrev_b32 v6, 1, v6
  v_lshl_add_u32 v4, v6, 6, v4
  v_bfe_u32 v6, v1, 4, 1
  v_lshl_add_u32 v4, v6, 5, v4
  v_and_b32 v6, 1, v1
  v_lshl_add_u32 v4, v6, 4, v4
  v_bfe_u32 v6, v1, 1, 1
  v_lshl_add_u32 v4, v6, 3, v4
  v_xor_b32 v4, s83, v4
  s_lshl_b32 s83, s83, 5
  v_add_u32 v18, s83, v4
  v_xor_b32 v19, 64, v18
  v_add_u32 v20, 65536, v18
  v_add_u32 v21, 65536, v19
  v_add_u32 v22, 131072, v18
  v_add_u32 v23, 131072, v19
  s_waitcnt vmcnt(2) lgkmcnt(0)
  s_barrier
  v_mov_b32 v8, s86
  v_mov_b32 v9, s87
  v_lshlrev_b32 v10, 31, v1
  v_lshl_or_b32 v10, v1, 25, v10
  buffer_store_dwordx2 v[8:9], v10, s[20:23], s84 offen sc1
  s_mov_b32 s84, 0x8000000
  s_add_u32 s61, s52, 98304
  buffer_load_dwordx4 a[72:75], v17, s[8:11], s61 offen
  s_add_u32 s61, s52, 106496
  buffer_load_dwordx4 a[76:79], v17, s[8:11], s61 offen
  s_add_u32 s61, s52, 131072
  buffer_load_dwordx4 a[80:83], v17, s[8:11], s61 offen
  s_add_u32 s61, s52, 139264
  buffer_load_dwordx4 a[84:87], v17, s[8:11], s61 offen
  s_add_u32 s61, s52, 163840
  buffer_load_dwordx4 a[88:91], v17, s[8:11], s61 offen
  s_add_u32 s61, s52, 172032
  buffer_load_dwordx4 a[92:95], v17, s[8:11], s61 offen
  s_add_u32 s61, s52, 196608
  buffer_load_dwordx4 a[96:99], v17, s[8:11], s61 offen
  s_add_u32 s61, s52, 204800
  buffer_load_dwordx4 a[100:103], v17, s[8:11], s61 offen
  s_add_u32 s61, s52, 229376
  buffer_load_dwordx4 a[104:107], v17, s[8:11], s61 offen
  s_add_u32 s61, s52, 237568
  buffer_load_dwordx4 a[108:111], v17, s[8:11], s61 offen
  s_add_u32 s82, s56, 425984
  s_add_u32 m0, s85, 0
  s_nop 0
  buffer_load_dwordx4 v17, s[12:15], s82 offen lds
  s_add_u32 s82, s56, 434176
  s_add_u32 m0, s85, 1024
  s_nop 0
  buffer_load_dwordx4 v17, s[12:15], s82 offen lds
  s_add_u32 s82, s56, 458752
  s_add_u32 m0, s85, 8192
  s_nop 0
  buffer_load_dwordx4 v17, s[12:15], s82 offen lds
  s_add_u32 s82, s56, 466944
  s_add_u32 m0, s85, 9216
  s_nop 0
  buffer_load_dwordx4 v17, s[12:15], s82 offen lds
  s_add_u32 s82, s56, 491520
  s_add_u32 m0, s85, 16384
  s_nop 0
  buffer_load_dwordx4 v17, s[12:15], s82 offen lds
  s_add_u32 s82, s56, 499712
  s_add_u32 m0, s85, 17408
  s_nop 0
  buffer_load_dwordx4 v17, s[12:15], s82 offen lds
  s_add_u32 s82, s57, 0
  s_add_u32 m0, s85, 114688
  s_nop 0
  buffer_load_dwordx4 v17, s[12:15], s82 offen lds
  s_add_u32 s82, s57, 8192
  s_add_u32 m0, s85, 115712
  s_nop 0
  buffer_load_dwordx4 v17, s[12:15], s82 offen lds
  s_add_u32 s82, s57, 32768
  s_add_u32 m0, s85, 122880
  s_nop 0
  buffer_load_dwordx4 v17, s[12:15], s82 offen lds
  s_add_u32 s82, s57, 40960
  s_add_u32 m0, s85, 123904
  s_nop 0
  buffer_load_dwordx4 v17, s[12:15], s82 offen lds
  s_add_u32 s82, s57, 65536
  s_add_u32 m0, s85, 131072
  s_nop 0
  buffer_load_dwordx4 v17, s[12:15], s82 offen lds
  s_add_u32 s82, s57, 73728
  s_add_u32 m0, s85, 132096
  s_nop 0
  buffer_load_dwordx4 v17, s[12:15], s82 offen lds
  s_add_u32 s61, s53, 98304
  s_add_u32 m0, s85, 57344
  s_nop 0
  buffer_load_dwordx4 v17, s[12:15], s61 offen lds
  s_add_u32 s61, s53, 106496
  s_add_u32 m0, s85, 58368
  s_nop 0
  buffer_load_dwordx4 v17, s[12:15], s61 offen lds
  s_add_u32 s61, s53, 196608
  s_add_u32 m0, s85, 65536
  s_nop 0
  buffer_load_dwordx4 v17, s[12:15], s61 offen lds
  s_add_u32 s61, s53, 204800
  s_add_u32 m0, s85, 66560
  s_nop 0
  buffer_load_dwordx4 v17, s[12:15], s61 offen lds
  s_add_u32 s61, s53, 229376
  s_add_u32 m0, s85, 73728
  s_nop 0
  buffer_load_dwordx4 v17, s[12:15], s61 offen lds
  s_add_u32 s61, s53, 237568
  s_add_u32 m0, s85, 74752
  s_nop 0
  buffer_load_dwordx4 v17, s[12:15], s61 offen lds
  buffer_load_dwordx2 v[58:59], v16, s[20:23], s81 offen offset:0 sc1
  s_add_u32 s61, s52, 0
  s_add_u32 m0, s85, 106496
  s_nop 0
  buffer_load_dwordx4 v17, s[8:11], s61 offen lds
  s_add_u32 s61, s52, 8192
  s_add_u32 m0, s85, 107520
  s_nop 0
  buffer_load_dwordx4 v17, s[8:11], s61 offen lds
  s_waitcnt vmcnt(2)
L_join:
  v_cmp_ne_u64 vcc, s[86:87], v[58:59]
  s_nop 0
  s_and_b32 vcc_lo, vcc_lo, 285217024
  s_cbranch_scc1 L_slow_e
L_go:
  s_add_u32 s82, s50, 0
  buffer_load_dwordx4 v[144:147], v2, s[20:23], s82 offen offset:0 sc1
  buffer_load_dwordx4 v[148:151], v2, s[20:23], s82 offen offset:1024 sc1
  buffer_load_dwordx4 v[152:155], v2, s[20:23], s82 offen offset:2048 sc1
  buffer_load_dwordx4 v[156:159], v2, s[20:23], s82 offen offset:3072 sc1
  s_add_u32 s82, s50, 4096
  buffer_load_dwordx4 v[160:163], v2, s[20:23], s82 offen offset:0 sc1
  buffer_load_dwordx4 v[164:167], v2, s[20:23], s82 offen offset:1024 sc1
  buffer_load_dwordx4 v[168:171], v2, s[20:23], s82 offen offset:2048 sc1
  buffer_load_dwordx4 v[172:175], v2, s[20:23], s82 offen offset:3072 sc1
  s_add_u32 s82, s50, 8192
  buffer_load_dwordx4 v[176:179], v2, s[20:23], s82 offen offset:0 sc1
  buffer_load_dwordx4 v[180:183], v2, s[20:23], s82 offen offset:1024 sc1
  buffer_load_dwordx4 v[184:187], v2, s[20:23], s82 offen offset:2048 sc1
  buffer_load_dwordx4 v[188:191], v2, s[20:23], s82 offen offset:3072 sc1
  s_mov_b32 s83, 9437184
  buffer_load_dword v44, v33, s[20:23], s83 offen sc1
  s_waitcnt vmcnt(13)
  s_barrier
  v_mov_b32 v12, s86
  v_mov_b32 v13, s87
  v_lshlrev_b32 v14, 31, v1
  v_lshl_or_b32 v14, v1, 25, v14
  buffer_store_dwordx2 v[12:13], v14, s[20:23], s84 offen sc1
  s_waitcnt vmcnt(10) lgkmcnt(0)
  v_mfma_f32_32x32x16_bf16 v[64:79], a[112:115], v[144:147], 0
  s_add_u32 s82, s50, 12288
  v_mfma_f32_32x32x16_bf16 v[80:95], a[116:119], v[144:147], 0
  buffer_load_dwordx4 v[192:195], v2, s[20:23], s82 offen offset:0 sc1
  v_mfma_f32_32x32x16_bf16 v[64:79], a[120:123], v[148:151], v[64:79]
  v_mfma_f32_32x32x16_bf16 v[80:95], a[124:127], v[148:151], v[80:95]
  buffer_load_dwordx4 v[196:199], v2, s[20:23], s82 offen offset:1024 sc1
  v_mfma_f32_32x32x16_bf16 v[64:79], a[128:131], v[152:155], v[64:79]
  buffer_load_dwordx4 v[200:203], v2, s[20:23], s82 offen offset:2048 sc1
  v_mfma_f32_32x32x16_bf16 v[80:95], a[132:135], v[152:155], v[80:95]
  v_mfma_f32_32x32x16_bf16 v[64:79], a[136:139], v[156:159], v[64:79]
  buffer_load_dwordx4 v[204:207], v2, s[20:23], s82 offen offset:3072 sc1
  v_mfma_f32_32x32x16_bf16 v[80:95], a[140:143], v[156:159], v[80:95]
  s_waitcnt vmcnt(10) lgkmcnt(0)
  v_mfma_f32_32x32x16_bf16 v[64:79], a[144:147], v[160:163], v[64:79]
  s_add_u32 s82, s50, 16384
  v_mfma_f32_32x32x16_bf16 v[80:95], a[148:151], v[160:163], v[80:95]
  buffer_load_dwordx4 v[208:211], v2, s[20:23], s82 offen offset:0 sc1
  v_mfma_f32_32x32x16_bf16 v[64:79], a[152:155], v[164:167], v[64:79]
  v_mfma_f32_32x32x16_bf16 v[80:95], a[156:159], v[164:167], v[80:95]
  buffer_load_dwordx4 v[212:215], v2, s[20:23], s82 offen offset:1024 sc1
  v_mfma_f32_32x32x16_bf16 v[64:79], a[160:163], v[168:171], v[64:79]
  buffer_load_dwordx4 v[216:219], v2, s[20:23], s82 offen offset:2048 sc1
  v_mfma_f32_32x32x16_bf16 v[80:95], a[164:167], v[168:171], v[80:95]
  v_mfma_f32_32x32x16_bf16 v[64:79], a[168:171], v[172:175], v[64:79]
  buffer_load_dwordx4 v[220:223], v2, s[20:23], s82 offen offset:3072 sc1
  v_mfma_f32_32x32x16_bf16 v[80:95], a[172:175], v[172:175], v[80:95]
  s_waitcnt vmcnt(10) lgkmcnt(0)
  v_mfma_f32_32x32x16_bf16 v[64:79], a[176:179], v[176:179], v[64:79]
  s_add_u32 s82, s50, 20480
  v_mfma_f32_32x32x16_bf16 v[80:95], a[180:183], v[176:179], v[80:95]
  buffer_load_dwordx4 v[224:227], v2, s[20:23], s82 offen offset:0 sc1
  v_mfma_f32_32x32x16_bf16 v[64:79], a[184:187], v[180:183], v[64:79]
  v_mfma_f32_32x32x16_bf16 v[80:95], a[188:191], v[180:183], v[80:95]
  buffer_load_dwordx4 v[228:231], v2, s[20:23], s82 offen offset:1024 sc1
  v_mfma_f32_32x32x16_bf16 v[64:79], a[192:195], v[184:187], v[64:79]
  buffer_load_dwordx4 v[232:235], v2, s[20:23], s82 offen offset:2048 sc1
  v_mfma_f32_32x32x16_bf16 v[80:95], a[196:199], v[184:187], v[80:95]
  v_mfma_f32_32x32x16_bf16 v[64:79], a[200:203], v[188:191], v[64:79]
  buffer_load_dwordx4 v[236:239], v2, s[20:23], s82 offen offset:3072 sc1
  v_mfma_f32_32x32x16_bf16 v[80:95], a[204:207], v[188:191], v[80:95]
  s_waitcnt vmcnt(8) lgkmcnt(0)
  v_mfma_f32_32x32x16_bf16 v[64:79], a[208:211], v[192:195], v[64:79]
  s_add_u32 s82, s50, 24576
  v_mfma_f32_32x32x16_bf16 v[80:95], a[212:215], v[192:195], v[80:95]
  buffer_load_dwordx4 v[240:243], v2, s[20:23], s82 offen offset:0 sc1
  v_mfma_f32_32x32x16_bf16 v[64:79], a[216:219], v[196:199], v[64:79]
  v_mfma_f32_32x32x16_bf16 v[80:95], a[220:223], v[196:199], v[80:95]
  buffer_load_dwordx4 v[244:247], v2, s[20:23], s82 offen offset:1024 sc1
  v_mfma_f32_32x32x16_bf16 v[64:79], a[0:3], v[200:203], v[64:79]
  buffer_load_dwordx4 v[248:251], v2, s[20:23], s82 offen offset:2048 sc1
  v_mfma_f32_32x32x16_bf16 v[80:95], a[4:7], v[200:203], v[80:95]
  v_mfma_f32_32x32x16_bf16 v[64:79], a[8:11], v[204:207], v[64:79]
  buffer_load_dwordx4 v[252:255], v2, s[20:23], s82 offen offset:3072 sc1
  v_mfma_f32_32x32x16_bf16 v[80:95], a[12:15], v[204:207], v[80:95]
  s_waitcnt vmcnt(8) lgkmcnt(0)
  v_mfma_f32_32x32x16_bf16 v[64:79], a[16:19], v[208:211], v[64:79]
  ds_read_b64_tr_b16 a[144:145], v20 offset:16384
  ds_read_b64_tr_b16 a[146:147], v20 offset:16896
  ds_read_b64_tr_b16 a[148:149], v21 offset:16384
  ds_read_b64_tr_b16 a[150:151], v21 offset:16896
  v_mfma_f32_32x32x16_bf16 v[80:95], a[20:23], v[208:211], v[80:95]
  ds_read_b64_tr_b16 a[152:153], v20 offset:20480
  ds_read_b64_tr_b16 a[154:155], v20 offset:20992
  ds_read_b64_tr_b16 a[156:157], v21 offset:20480
  ds_read_b64_tr_b16 a[158:159], v21 offset:20992
  v_mfma_f32_32x32x16_bf16 v[64:79], a[24:27], v[212:215], v[64:79]
  ds_read_b64_tr_b16 a[160:161], v20 offset:24576
  ds_read_b64_tr_b16 a[162:163], v20 offset:25088
  ds_read_b64_tr_b16 a[164:165], v21 offset:24576
  ds_read_b64_tr_b16 a[166:167], v21 offset:25088
  v_mfma_f32_32x32x16_bf16 v[80:95], a[28:31], v[212:215], v[80:95]
  ds_read_b64_tr_b16 a[168:169], v20 offset:28672
  ds_read_b64_tr_b16 a[170:171], v20 offset:29184
  ds_read_b64_tr_b16 a[172:173], v21 offset:28672
  ds_read_b64_tr_b16 a[174:175], v21 offset:29184
  v_mfma_f32_32x32x16_bf16 v[64:79], a[32:35], v[216:219], v[64:79]
  s_add_u32 s82, s50, 28672
  buffer_load_dwordx4 v[144:147], v2, s[20:23], s82 offen offset:0 sc1
  buffer_load_dwordx4 v[148:151], v2, s[20:23], s82 offen offset:1024 sc1
  buffer_load_dwordx4 v[152:155], v2, s[20:23], s82 offen offset:2048 sc1
  v_mfma_f32_32x32x16_bf16 v[80:95], a[36:39], v[216:219], v[80:95]
  v_mfma_f32_32x32x16_bf16 v[64:79], a[40:43], v[220:223], v[64:79]
  buffer_load_dwordx4 v[156:159], v2, s[20:23], s82 offen offset:3072 sc1
  v_mfma_f32_32x32x16_bf16 v[80:95], a[44:47], v[220:223], v[80:95]
  s_waitcnt vmcnt(8) lgkmcnt(0)
  v_mfma_f32_32x32x16_bf16 v[64:79], a[144:147], v[224:227], v[64:79]
  ds_read_b64_tr_b16 a[112:113], v20 offset:32768
  ds_read_b64_tr_b16 a[114:115], v20 offset:33280
  ds_read_b64_tr_b16 a[116:117], v21 offset:32768
  ds_read_b64_tr_b16 a[118:119], v21 offset:33280
  v_mfma_f32_32x32x16_bf16 v[80:95], a[148:151], v[224:227], v[80:95]
  ds_read_b64_tr_b16 a[120:121], v20 offset:36864
  ds_read_b64_tr_b16 a[122:123], v20 offset:37376
  ds_read_b64_tr_b16 a[124:125], v21 offset:36864
  ds_read_b64_tr_b16 a[126:127], v21 offset:37376
  v_mfma_f32_32x32x16_bf16 v[64:79], a[152:155], v[228:231], v[64:79]
  ds_read_b64_tr_b16 a[128:129], v18 offset:0
  ds_read_b64_tr_b16 a[130:131], v18 offset:512
  ds_read_b64_tr_b16 a[132:133], v19 offset:0
  ds_read_b64_tr_b16 a[134:135], v19 offset:512
  v_mfma_f32_32x32x16_bf16 v[80:95], a[156:159], v[228:231], v[80:95]
  ds_read_b64_tr_b16 a[136:137], v18 offset:4096
  ds_read_b64_tr_b16 a[138:139], v18 offset:4608
  ds_read_b64_tr_b16 a[140:141], v19 offset:4096
  ds_read_b64_tr_b16 a[142:143], v19 offset:4608
  v_mfma_f32_32x32x16_bf16 v[64:79], a[160:163], v[232:235], v[64:79]
  buffer_load_dwordx2 v[58:59], v16, s[20:23], s81 offen offset:128 sc1
  s_add_u32 s82, s51, 0
  buffer_load_dwordx4 v[160:163], v2, s[20:23], s82 offen offset:0 sc1
  buffer_load_dwordx4 v[164:167], v2, s[20:23], s82 offen offset:1024 sc1
  v_mfma_f32_32x32x16_bf16 v[80:95], a[164:167], v[232:235], v[80:95]
  buffer_load_dwordx4 v[168:171], v2, s[20:23], s82 offen offset:2048 sc1
  v_mfma_f32_32x32x16_bf16 v[64:79], a[168:171], v[236:239], v[64:79]
  buffer_load_dwordx4 v[172:175], v2, s[20:23], s82 offen offset:3072 sc1
  v_mfma_f32_32x32x16_bf16 v[80:95], a[172:175], v[236:239], v[80:95]
  s_waitcnt vmcnt(9) lgkmcnt(0)
  v_mfma_f32_32x32x16_bf16 v[64:79], a[112:115], v[240:243], v[64:79]
  ds_read_b64_tr_b16 a[144:145], v18 offset:8192
  ds_read_b64_tr_b16 a[146:147], v18 offset:8704
  ds_read_b64_tr_b16 a[148:149], v19 offset:8192
  ds_read_b64_tr_b16 a[150:151], v19 offset:8704
  v_mfma_f32_32x32x16_bf16 v[80:95], a[116:119], v[240:243], v[80:95]
  ds_read_b64_tr_b16 a[152:153], v18 offset:12288
  ds_read_b64_tr_b16 a[154:155], v18 offset:12800
  ds_read_b64_tr_b16 a[156:157], v19 offset:12288
  ds_read_b64_tr_b16 a[158:159], v19 offset:12800
  v_mfma_f32_32x32x16_bf16 v[64:79], a[120:123], v[244:247], v[64:79]
  ds_read_b64_tr_b16 a[160:161], v18 offset:16384
  ds_read_b64_tr_b16 a[162:163], v18 offset:16896
  ds_read_b64_tr_b16 a[164:165], v19 offset:16384
  ds_read_b64_tr_b16 a[166:167], v19 offset:16896
  v_mfma_f32_32x32x16_bf16 v[80:95], a[124:127], v[244:247], v[80:95]
  ds_read_b64_tr_b16 a[168:169], v18 offset:20480
  ds_read_b64_tr_b16 a[170:171], v18 offset:20992
  ds_read_b64_tr_b16 a[172:173], v19 offset:20480
  ds_read_b64_tr_b16 a[174:175], v19 offset:20992
  v_mfma_f32_32x32x16_bf16 v[64:79], a[128:131], v[248:251], v[64:79]
  s_add_u32 s82, s51, 4096
  buffer_load_dwordx4 v[176:179], v2, s[20:23], s82 offen offset:0 sc1
  buffer_load_dwordx4 v[180:183], v2, s[20:23], s82 offen offset:1024 sc1
  buffer_load_dwordx4 v[184:187], v2, s[20:23], s82 offen offset:2048 sc1
  v_mfma_f32_32x32x16_bf16 v[80:95], a[132:135], v[248:251], v[80:95]
  v_mfma_f32_32x32x16_bf16 v[64:79], a[136:139], v[252:255], v[64:79]
  buffer_load_dwordx4 v[188:191], v2, s[20:23], s82 offen offset:3072 sc1
  v_mfma_f32_32x32x16_bf16 v[80:95], a[140:143], v[252:255], v[80:95]
  s_waitcnt vmcnt(9) lgkmcnt(0)
  v_mfma_f32_32x32x16_bf16 v[64:79], a[144:147], v[144:147], v[64:79]
  ds_read_b64_tr_b16 a[112:113], v20 offset:49152
  ds_read_b64_tr_b16 a[114:115], v20 offset:49664
  ds_read_b64_tr_b16 a[116:117], v21 offset:49152
  ds_read_b64_tr_b16 a[118:119], v21 offset:49664
  v_mfma_f32_32x32x16_bf16 v[80:95], a[148:151], v[144:147], v[80:95]
  ds_read_b64_tr_b16 a[120:121], v20 offset:53248
  ds_read_b64_tr_b16 a[122:123], v20 offset:53760
  ds_read_b64_tr_b16 a[124:125], v21 offset:53248
  ds_read_b64_tr_b16 a[126:127], v21 offset:53760
  v_mfma_f32_32x32x16_bf16 v[64:79], a[152:155], v[148:151], v[64:79]
  ds_read_b64_tr_b16 a[128:129], v20 offset:57344
  ds_read_b64_tr_b16 a[130:131], v20 offset:57856
  ds_read_b64_tr_b16 a[132:133], v21 offset:57344
  ds_read_b64_tr_b16 a[134:135], v21 offset:57856
  v_mfma_f32_32x32x16_bf16 v[80:95], a[156:159], v[148:151], v[80:95]
  ds_read_b64_tr_b16 a[136:137], v20 offset:61440
  ds_read_b64_tr_b16 a[138:139], v20 offset:61952
  ds_read_b64_tr_b16 a[140:141], v21 offset:61440
  ds_read_b64_tr_b16 a[142:143], v21 offset:61952
  v_mfma_f32_32x32x16_bf16 v[64:79], a[160:163], v[152:155], v[64:79]
  s_waitcnt vmcnt(8)
  v_cmp_ne_u64 vcc, s[86:87], v[58:59]
  s_nop 0
  s_and_b32 vcc_lo, vcc_lo, 1114129
  s_cbranch_scc1 L_slow_o0
L_back_o0:
  v_mfma_f32_32x32x16_bf16 v[80:95], a[164:167], v[152:155], v[80:95]
  s_add_u32 s82, s49, 0
  buffer_load_dwordx4 v[192:195], v2, s[20:23], s82 offen offset:0 sc1
  buffer_load_dwordx4 v[196:199], v2, s[20:23], s82 offen offset:1024 sc1
  v_mfma_f32_32x32x16_bf16 v[64:79], a[168:171], v[156:159], v[64:79]
  buffer_load_dwordx4 v[200:203], v2, s[20:23], s82 offen offset:2048 sc1
  v_mfma_f32_32x32x16_bf16 v[80:95], a[172:175], v[156:159], v[80:95]
  buffer_load_dwordx4 v[204:207], v2, s[20:23], s82 offen offset:3072 sc1
  s_waitcnt vmcnt(8) lgkmcnt(0)
  v_mfma_f32_32x32x16_bf16 v[64:79], a[112:115], v[160:163], v[64:79]
  ds_read_b64_tr_b16 a[144:145], v22 offset:0
  ds_read_b64_tr_b16 a[146:147], v22 offset:512
  ds_read_b64_tr_b16 a[148:149], v23 offset:0
  ds_read_b64_tr_b16 a[150:151], v23 offset:512
  v_mfma_f32_32x32x16_bf16 v[80:95], a[116:119], v[160:163], v[80:95]
  ds_read_b64_tr_b16 a[152:153], v22 offset:4096
  ds_read_b64_tr_b16 a[154:155], v22 offset:4608
  ds_read_b64_tr_b16 a[156:157], v23 offset:4096
  ds_read_b64_tr_b16 a[158:159], v23 offset:4608
  v_mfma_f32_32x32x16_bf16 v[64:79], a[120:123], v[164:167], v[64:79]
  ds_read_b64_tr_b16 a[160:161], v18 offset:24576
  ds_read_b64_tr_b16 a[162:163], v18 offset:25088
  ds_read_b64_tr_b16 a[164:165], v19 offset:24576
  ds_read_b64_tr_b16 a[166:167], v19 offset:25088
  v_mfma_f32_32x32x16_bf16 v[80:95], a[124:127], v[164:167], v[80:95]
  ds_read_b64_tr_b16 a[168:169], v18 offset:28672
  ds_read_b64_tr_b16 a[170:171], v18 offset:29184
  ds_read_b64_tr_b16 a[172:173], v19 offset:28672
  ds_read_b64_tr_b16 a[174:175], v19 offset:29184
  v_mfma_f32_32x32x16_bf16 v[64:79], a[128:131], v[168:171], v[64:79]
  s_add_u32 s82, s49, 4096
  buffer_load_dwordx4 v[208:211], v2, s[20:23], s82 offen offset:0 sc1
  buffer_load_dwordx4 v[212:215], v2, s[20:23], s82 offen offset:1024 sc1
  buffer_load_dwordx4 v[216:219], v2, s[20:23], s82 offen offset:2048 sc1
  v_mfma_f32_32x32x16_bf16 v[80:95], a[132:135], v[168:171], v[80:95]
  v_mfma_f32_32x32x16_bf16 v[64:79], a[136:139], v[172:175], v[64:79]
  buffer_load_dwordx4 v[220:223], v2, s[20:23], s82 offen offset:3072 sc1
  v_mfma_f32_32x32x16_bf16 v[80:95], a[140:143], v[172:175], v[80:95]
  s_waitcnt vmcnt(8) lgkmcnt(0)
  s_barrier
  v_mfma_f32_32x32x16_bf16 v[64:79], a[144:147], v[176:179], v[64:79]
  ds_read_b64_tr_b16 a[112:113], v18 offset:32768
  ds_read_b64_tr_b16 a[114:115], v18 offset:33280
  ds_read_b64_tr_b16 a[116:117], v19 offset:32768
  ds_read_b64_tr_b16 a[118:119], v19 offset:33280
  v_mfma_f32_32x32x16_bf16 v[80:95], a[148:151], v[176:179], v[80:95]
  ds_read_b64_tr_b16 a[120:121], v18 offset:36864
  ds_read_b64_tr_b16 a[122:123], v18 offset:37376
  ds_read_b64_tr_b16 a[124:125], v19 offset:36864
  ds_read_b64_tr_b16 a[126:127], v19 offset:37376
  v_mfma_f32_32x32x16_bf16 v[64:79], a[152:155], v[180:183], v[64:79]
  ds_read_b64_tr_b16 a[128:129], v18 offset:40960
  ds_read_b64_tr_b16 a[130:131], v18 offset:41472
  ds_read_b64_tr_b16 a[132:133], v19 offset:40960
  ds_read_b64_tr_b16 a[134:135], v19 offset:41472
  v_mfma_f32_32x32x16_bf16 v[80:95], a[156:159], v[180:183], v[80:95]
  ds_read_b64_tr_b16 a[136:137], v18 offset:45056
  ds_read_b64_tr_b16 a[138:139], v18 offset:45568
  ds_read_b64_tr_b16 a[140:141], v19 offset:45056
  ds_read_b64_tr_b16 a[142:143], v19 offset:45568
  v_mfma_f32_32x32x16_bf16 v[64:79], a[160:163], v[184:187], v[64:79]
  s_add_u32 s82, s49, 8192
  ds_write_b128 v25, a[56:59] offset:16384
  buffer_load_dwordx4 v[224:227], v2, s[20:23], s82 offen offset:0 sc1
  ds_write_b128 v25, a[60:63] offset:17408
  v_mfma_f32_32x32x16_bf16 v[80:95], a[164:167], v[184:187], v[80:95]
  buffer_load_dwordx4 v[228:231], v2, s[20:23], s82 offen offset:1024 sc1
  ds_write_b128 v25, a[64:67] offset:24576
  buffer_load_dwordx4 v[232:235], v2, s[20:23], s82 offen offset:2048 sc1
  v_mfma_f32_32x32x16_bf16 v[64:79], a[168:171], v[188:191], v[64:79]
  ds_write_b128 v25, a[68:71] offset:25600
  v_mfma_f32_32x32x16_bf16 v[80:95], a[172:175], v[188:191], v[80:95]
  buffer_load_dwordx4 v[236:239], v2, s[20:23], s82 offen offset:3072 sc1
  s_waitcnt vmcnt(8) lgkmcnt(4)
  v_mfma_f32_32x32x16_bf16 v[64:79], a[112:115], v[192:195], v[64:79]
  ds_read_b64_tr_b16 a[144:145], v18 offset:49152
  ds_read_b64_tr_b16 a[146:147], v18 offset:49664
  ds_read_b64_tr_b16 a[148:149], v19 offset:49152
  ds_read_b64_tr_b16 a[150:151], v19 offset:49664
  v_mfma_f32_32x32x16_bf16 v[80:95], a[116:119], v[192:195], v[80:95]
  ds_read_b64_tr_b16 a[152:153], v18 offset:53248
  ds_read_b64_tr_b16 a[154:155], v18 offset:53760
  ds_read_b64_tr_b16 a[156:157], v19 offset:53248
  ds_read_b64_tr_b16 a[158:159], v19 offset:53760
  v_mfma_f32_32x32x16_bf16 v[64:79], a[120:123], v[196:199], v[64:79]
  ds_read_b64_tr_b16 a[160:161], v18 offset:57344
  ds_read_b64_tr_b16 a[162:163], v18 offset:57856
  ds_read_b64_tr_b16 a[164:165], v19 offset:57344
  ds_read_b64_tr_b16 a[166:167], v19 offset:57856
  v_mfma_f32_32x32x16_bf16 v[80:95], a[124:127], v[196:199], v[80:95]
  ds_read_b64_tr_b16 a[168:169], v18 offset:61440
  ds_read_b64_tr_b16 a[170:171], v18 offset:61952
  ds_read_b64_tr_b16 a[172:173], v19 offset:61440
  ds_read_b64_tr_b16 a[174:175], v19 offset:61952
  v_mfma_f32_32x32x16_bf16 v[64:79], a[128:131], v[200:203], v[64:79]
  s_add_u32 s82, s49, 12288
  ds_write_b128 v25, a[72:75] offset:32768
  buffer_load_dwordx4 v[240:243], v2, s[20:23], s82 offen offset:0 sc1
  ds_write_b128 v25, a[76:79] offset:33792
  v_mfma_f32_32x32x16_bf16 v[80:95], a[132:135], v[200:203], v[80:95]
  buffer_load_dwordx4 v[244:247], v2, s[20:23], s82 offen offset:1024 sc1
  ds_write_b128 v24, a[80:83] offset:0
  buffer_load_dwordx4 v[248:251], v2, s[20:23], s82 offen offset:2048 sc1
  v_mfma_f32_32x32x16_bf16 v[64:79], a[136:139], v[204:207], v[64:79]
  ds_write_b128 v24, a[84:87] offset:1024
  v_mfma_f32_32x32x16_bf16 v[80:95], a[140:143], v[204:207], v[80:95]
  buffer_load_dwordx4 v[252:255], v2, s[20:23], s82 offen offset:3072 sc1
  s_waitcnt vmcnt(8) lgkmcnt(4)
  v_mfma_f32_32x32x16_bf16 v[64:79], a[144:147], v[208:211], v[64:79]
  ds_read_b64_tr_b16 a[112:113], v22 offset:8192
  ds_read_b64_tr_b16 a[114:115], v22 offset:8704
  ds_read_b64_tr_b16 a[116:117], v23 offset:8192
  ds_read_b64_tr_b16 a[118:119], v23 offset:8704
  v_mfma_f32_32x32x16_bf16 v[80:95], a[148:151], v[208:211], v[80:95]
  ds_read_b64_tr_b16 a[120:121], v22 offset:12288
  ds_read_b64_tr_b16 a[122:123], v22 offset:12800
  ds_read_b64_tr_b16 a[124:125], v23 offset:12288
  ds_read_b64_tr_b16 a[126:127], v23 offset:12800
  v_mfma_f32_32x32x16_bf16 v[64:79], a[152:155], v[212:215], v[64:79]
  ds_read_b64_tr_b16 a[128:129], v22 offset:16384
  ds_read_b64_tr_b16 a[130:131], v22 offset:16896
  ds_read_b64_tr_b16 a[132:133], v23 offset:16384
  ds_read_b64_tr_b16 a[134:135], v23 offset:16896
  v_mfma_f32_32x32x16_bf16 v[80:95], a[156:159], v[212:215], v[80:95]
  ds_read_b64_tr_b16 a[136:137], v22 offset:20480
  ds_read_b64_tr_b16 a[138:139], v22 offset:20992
  ds_read_b64_tr_b16 a[140:141], v23 offset:20480
  ds_read_b64_tr_b16 a[142:143], v23 offset:20992
  v_mfma_f32_32x32x16_bf16 v[64:79], a[160:163], v[216:219], v[64:79]
  s_add_u32 s82, s48, 0
  ds_write_b128 v24, a[88:91] offset:8192
  buffer_load_dwordx4 v[144:147], v2, s[20:23], s82 offen offset:0 sc1
  ds_write_b128 v24, a[92:95] offset:9216
  v_mfma_f32_32x32x16_bf16 v[80:95], a[164:167], v[216:219], v[80:95]
  buffer_load_dwordx4 v[148:151], v2, s[20:23], s82 offen offset:1024 sc1
  ds_write_b128 v24, a[96:99] offset:16384
  v_mfma_f32_32x32x16_bf16 v[64:79], a[168:171], v[220:223], v[64:79]
  buffer_load_dwordx4 v[152:155], v2, s[20:23], s82 offen offset:2048 sc1
  v_mfma_f32_32x32x16_bf16 v[80:95], a[172:175], v[220:223], v[80:95]
  buffer_load_dwordx4 v[156:159], v2, s[20:23], s82 offen offset:3072 sc1
  s_waitcnt vmcnt(8) lgkmcnt(3)
  v_mfma_f32_32x32x16_bf16 v[64:79], a[112:115], v[224:227], v[64:79]
  ds_read_b64_tr_b16 a[144:145], v20 offset:0
  ds_read_b64_tr_b16 a[146:147], v20 offset:512
  ds_read_b64_tr_b16 a[148:149], v21 offset:0
  ds_read_b64_tr_b16 a[150:151], v21 offset:512
  v_mfma_f32_32x32x16_bf16 v[80:95], a[116:119], v[224:227], v[80:95]
  ds_read_b64_tr_b16 a[152:153], v20 offset:4096
  ds_read_b64_tr_b16 a[154:155], v20 offset:4608
  ds_read_b64_tr_b16 a[156:157], v21 offset:4096
  ds_read_b64_tr_b16 a[158:159], v21 offset:4608
  v_mfma_f32_32x32x16_bf16 v[64:79], a[120:123], v[228:231], v[64:79]
  ds_read_b64_tr_b16 a[160:161], v20 offset:8192
  ds_read_b64_tr_b16 a[162:163], v20 offset:8704
  ds_read_b64_tr_b16 a[164:165], v21 offset:8192
  ds_read_b64_tr_b16 a[166:167], v21 offset:8704
  v_mfma_f32_32x32x16_bf16 v[80:95], a[124:127], v[228:231], v[80:95]
  ds_read_b64_tr_b16 a[168:169], v20 offset:12288
  ds_read_b64_tr_b16 a[170:171], v20 offset:12800
  ds_read_b64_tr_b16 a[172:173], v21 offset:12288
  ds_read_b64_tr_b16 a[174:175], v21 offset:12800
  v_mfma_f32_32x32x16_bf16 v[64:79], a[128:131], v[232:235], v[64:79]
  s_add_u32 s82, s48, 4096
  ds_write_b128 v24, a[100:103] offset:17408
  buffer_load_dwordx4 v[160:163], v2, s[20:23], s82 offen offset:0 sc1
  ds_write_b128 v25, a[104:107] offset:49152
  v_mfma_f32_32x32x16_bf16 v[80:95], a[132:135], v[232:235], v[80:95]
  buffer_load_dwordx4 v[164:167], v2, s[20:23], s82 offen offset:1024 sc1
  ds_write_b128 v25, a[108:111] offset:50176
  v_mfma_f32_32x32x16_bf16 v[64:79], a[136:139], v[236:239], v[64:79]
  buffer_load_dwordx4 v[168:171], v2, s[20:23], s82 offen offset:2048 sc1
  v_mfma_f32_32x32x16_bf16 v[80:95], a[140:143], v[236:239], v[80:95]
  buffer_load_dwordx4 v[172:175], v2, s[20:23], s82 offen offset:3072 sc1
  s_waitcnt vmcnt(8) lgkmcnt(0)
  s_barrier
  v_mfma_f32_32x32x16_bf16 v[64:79], a[144:147], v[240:243], v[64:79]
  ds_read_b64_tr_b16 a[112:113], v20 offset:40960
  ds_read_b64_tr_b16 a[114:115], v20 offset:41472
  ds_read_b64_tr_b16 a[116:117], v21 offset:40960
  ds_read_b64_tr_b16 a[118:119], v21 offset:41472
  v_mfma_f32_32x32x16_bf16 v[80:95], a[148:151], v[240:243], v[80:95]
  ds_read_b64_tr_b16 a[120:121], v20 offset:45056
  ds_read_b64_tr_b16 a[122:123], v20 offset:45568
  ds_read_b64_tr_b16 a[124:125], v21 offset:45056
  ds_read_b64_tr_b16 a[126:127], v21 offset:45568
  v_mfma_f32_32x32x16_bf16 v[64:79], a[152:155], v[244:247], v[64:79]
  ds_read_b64_tr_b16 a[128:129], v20 offset:16384
  ds_read_b64_tr_b16 a[130:131], v20 offset:16896
  ds_read_b64_tr_b16 a[132:133], v21 offset:16384
  ds_read_b64_tr_b16 a[134:135], v21 offset:16896
  v_mfma_f32_32x32x16_bf16 v[80:95], a[156:159], v[244:247], v[80:95]
  ds_read_b64_tr_b16 a[136:137], v20 offset:20480
  ds_read_b64_tr_b16 a[138:139], v20 offset:20992
  ds_read_b64_tr_b16 a[140:141], v21 offset:20480
  ds_read_b64_tr_b16 a[142:143], v21 offset:20992
  v_mfma_f32_32x32x16_bf16 v[64:79], a[160:163], v[248:251], v[64:79]
  s_add_u32 s82, s48, 8192
  buffer_load_dwordx4 v[176:179], v2, s[20:23], s82 offen offset:0 sc1
  buffer_load_dwordx4 v[180:183], v2, s[20:23], s82 offen offset:1024 sc1
  buffer_load_dwordx4 v[184:187], v2, s[20:23], s82 offen offset:2048 sc1
  v_mfma_f32_32x32x16_bf16 v[80:95], a[164:167], v[248:251], v[80:95]
  v_mfma_f32_32x32x16_bf16 v[64:79], a[168:171], v[252:255], v[64:79]
  buffer_load_dwordx4 v[188:191], v2, s[20:23], s82 offen offset:3072 sc1
  v_mfma_f32_32x32x16_bf16 v[80:95], a[172:175], v[252:255], v[80:95]
  s_waitcnt vmcnt(8) lgkmcnt(0)
  v_mfma_f32_32x32x16_bf16 v[96:111], a[112:115], v[144:147], 0
  ds_read_b64_tr_b16 a[144:145], v20 offset:24576
  ds_read_b64_tr_b16 a[146:147], v20 offset:25088
  ds_read_b64_tr_b16 a[148:149], v21 offset:24576
  ds_read_b64_tr_b16 a[150:151], v21 offset:25088
  v_mfma_f32_32x32x16_bf16 v[112:127], a[116:119], v[144:147], 0
  ds_read_b64_tr_b16 a[152:153], v20 offset:28672
  ds_read_b64_tr_b16 a[154:155], v20 offset:29184
  ds_read_b64_tr_b16 a[156:157], v21 offset:28672
  ds_read_b64_tr_b16 a[158:159], v21 offset:29184
  v_mfma_f32_32x32x16_bf16 v[96:111], a[120:123], v[148:151], v[96:111]
  ds_read_b64_tr_b16 a[160:161], v20 offset:32768
  ds_read_b64_tr_b16 a[162:163], v20 offset:33280
  ds_read_b64_tr_b16 a[164:165], v21 offset:32768
  ds_read_b64_tr_b16 a[166:167], v21 offset:33280
  v_mfma_f32_32x32x16_bf16 v[112:127], a[124:127], v[148:151], v[112:127]
  ds_read_b64_tr_b16 a[168:169], v20 offset:36864
  ds_read_b64_tr_b16 a[170:171], v20 offset:37376
  ds_read_b64_tr_b16 a[172:173], v21 offset:36864
  ds_read_b64_tr_b16 a[174:175], v21 offset:37376
  v_mfma_f32_32x32x16_bf16 v[96:111], a[128:131], v[152:155], v[96:111]
  s_add_u32 s82, s48, 12288
  ds_write_b128 v24, v[80:83] offset:24576
  buffer_load_dwordx4 v[192:195], v2, s[20:23], s82 offen offset:0 sc1
  ds_write_b128 v24, v[84:87] offset:25600
  v_mfma_f32_32x32x16_bf16 v[112:127], a[132:135], v[152:155], v[112:127]
  buffer_load_dwordx4 v[196:199], v2, s[20:23], s82 offen offset:1024 sc1
  ds_write_b128 v24, v[88:91] offset:32768
  buffer_load_dwordx4 v[200:203], v2, s[20:23], s82 offen offset:2048 sc1
  ds_write_b128 v24, v[92:95] offset:33792
  v_mfma_f32_32x32x16_bf16 v[96:111], a[136:139], v[156:159], v[96:111]
  buffer_load_dwordx4 v[204:207], v2, s[20:23], s82 offen offset:3072 sc1
  v_mul_f32 v44, v44, v44
  v_mfma_f32_32x32x16_bf16 v[112:127], a[140:143], v[156:159], v[112:127]
  v_mul_f32 v45, 0xbfb8aa3b, v44
  v_mov_b32 v62, 1.0
  s_waitcnt vmcnt(8) lgkmcnt(0)
  s_barrier
  v_mfma_f32_32x32x16_bf16 v[96:111], a[144:147], v[160:163], v[96:111]
  ds_read_b128 v[224:227], v27 offset:24576
  ds_read_b128 v[228:231], v27 offset:25600
  ds_read_b128 v[232:235], v27 offset:32768
  ds_read_b128 v[236:239], v27 offset:33792
  v_mfma_f32_32x32x16_bf16 v[112:127], a[148:151], v[160:163], v[112:127]
  ds_read_b64_tr_b16 a[112:113], v18 offset:0
  ds_read_b64_tr_b16 a[114:115], v18 offset:512
  ds_read_b64_tr_b16 a[116:117], v19 offset:0
  ds_read_b64_tr_b16 a[118:119], v19 offset:512
  v_mfma_f32_32x32x16_bf16 v[96:111], a[152:155], v[164:167], v[96:111]
  ds_read_b64_tr_b16 a[120:121], v18 offset:4096
  ds_read_b64_tr_b16 a[122:123], v18 offset:4608
  ds_read_b64_tr_b16 a[124:125], v19 offset:4096
  ds_read_b64_tr_b16 a[126:127], v19 offset:4608
  v_mfma_f32_32x32x16_bf16 v[112:127], a[156:159], v[164:167], v[112:127]
  ds_read_b64_tr_b16 a[128:129], v18 offset:8192
  ds_read_b64_tr_b16 a[130:131], v18 offset:8704
  ds_read_b64_tr_b16 a[132:133], v19 offset:8192
  ds_read_b64_tr_b16 a[134:135], v19 offset:8704
  v_mfma_f32_32x32x16_bf16 v[96:111], a[160:163], v[168:171], v[96:111]
  ds_read_b64_tr_b16 a[136:137], v18 offset:12288
  ds_read_b64_tr_b16 a[138:139], v18 offset:12800
  ds_read_b64_tr_b16 a[140:141], v19 offset:12288
  ds_read_b64_tr_b16 a[142:143], v19 offset:12800
  v_mfma_f32_32x32x16_bf16 v[112:127], a[164:167], v[168:171], v[112:127]
  v_lshlrev_b32 v46, 16, v36
  v_and_b32 v47, 0xffff0000, v36
  v_lshlrev_b32 v48, 16, v37
  v_and_b32 v49, 0xffff0000, v37
  v_mfma_f32_32x32x16_bf16 v[96:111], a[168:171], v[172:175], v[96:111]
  v_lshlrev_b32 v50, 16, v38
  v_and_b32 v51, 0xffff0000, v38
  v_lshlrev_b32 v52, 16, v39
  v_and_b32 v53, 0xffff0000, v39
  v_mfma_f32_32x32x16_bf16 v[112:127], a[172:175], v[172:175], v[112:127]
  v_lshlrev_b32 v54, 16, v40
  v_and_b32 v55, 0xffff0000, v40
  v_lshlrev_b32 v56, 16, v41
  v_and_b32 v57, 0xffff0000, v41
  v_lshlrev_b32 v58, 16, v42
  v_and_b32 v59, 0xffff0000, v42
  v_lshlrev_b32 v60, 16, v43
  v_and_b32 v61, 0xffff0000, v43
  s_waitcnt vmcnt(4) lgkmcnt(0)
  v_mfma_f32_32x32x16_bf16 v[96:111], a[112:115], v[176:179], v[96:111]
  ds_read_b64_tr_b16 a[144:145], v18 offset:16384
  ds_read_b64_tr_b16 a[146:147], v18 offset:16896
  ds_read_b64_tr_b16 a[148:149], v19 offset:16384
  ds_read_b64_tr_b16 a[150:151], v19 offset:16896
  v_add_f32 v64, v64, v224
  v_add_f32 v65, v65, v225
  v_mfma_f32_32x32x16_bf16 v[112:127], a[116:119], v[176:179], v[112:127]
  ds_read_b64_tr_b16 a[152:153], v18 offset:20480
  ds_read_b64_tr_b16 a[154:155], v18 offset:20992
  ds_read_b64_tr_b16 a[156:157], v19 offset:20480
  ds_read_b64_tr_b16 a[158:159], v19 offset:20992
  v_add_f32 v66, v66, v226
  v_add_f32 v67, v67, v227
  v_mfma_f32_32x32x16_bf16 v[96:111], a[120:123], v[180:183], v[96:111]
  ds_read_b64_tr_b16 a[160:161], v20 offset:49152
  ds_read_b64_tr_b16 a[162:163], v20 offset:49664
  ds_read_b64_tr_b16 a[164:165], v21 offset:49152
  ds_read_b64_tr_b16 a[166:167], v21 offset:49664
  v_add_f32 v68, v68, v228
  v_add_f32 v69, v69, v229
  v_mfma_f32_32x32x16_bf16 v[112:127], a[124:127], v[180:183], v[112:127]
  ds_read_b64_tr_b16 a[168:169], v20 offset:53248
  ds_read_b64_tr_b16 a[170:171], v20 offset:53760
  ds_read_b64_tr_b16 a[172:173], v21 offset:53248
  ds_read_b64_tr_b16 a[174:175], v21 offset:53760
  v_add_f32 v70, v70, v230
  v_add_f32 v71, v71, v231
  v_mfma_f32_32x32x16_bf16 v[96:111], a[128:131], v[184:187], v[96:111]
  v_add_f32 v72, v72, v232
  v_add_f32 v73, v73, v233
  v_add_f32 v74, v74, v234
  v_add_f32 v75, v75, v235
  v_add_f32 v76, v76, v236
  v_add_f32 v77, v77, v237
  v_mfma_f32_32x32x16_bf16 v[112:127], a[132:135], v[184:187], v[112:127]
  v_add_f32 v78, v78, v238
  v_add_f32 v79, v79, v239
  v_mul_f32 v240, v45, v64
  v_mul_f32 v241, v45, v65
  v_mul_f32 v242, v45, v66
  v_mul_f32 v243, v45, v67
  v_mfma_f32_32x32x16_bf16 v[96:111], a[136:139], v[188:191], v[96:111]
  v_mul_f32 v244, v45, v68
  v_mul_f32 v245, v45, v69
  v_mul_f32 v246, v45, v70
  v_mul_f32 v247, v45, v71
  v_mul_f32 v248, v45, v72
  v_mfma_f32_32x32x16_bf16 v[112:127], a[140:143], v[188:191], v[112:127]
  v_mul_f32 v249, v45, v73
  v_mul_f32 v250, v45, v74
  v_mul_f32 v251, v45, v75
  s_waitcnt vmcnt(0) lgkmcnt(0)
  v_mfma_f32_32x32x16_bf16 v[96:111], a[144:147], v[192:195], v[96:111]
  v_mul_f32 v252, v45, v76
  v_mul_f32 v253, v45, v77
  v_mul_f32 v254, v45, v78
  v_mul_f32 v255, v45, v79
  v_exp_f32 v240, v240
  v_mfma_f32_32x32x16_bf16 v[112:127], a[148:151], v[192:195], v[112:127]
  v_exp_f32 v241, v241
  v_exp_f32 v242, v242
  v_exp_f32 v243, v243
  v_exp_f32 v244, v244
  v_exp_f32 v245, v245
  v_mfma_f32_32x32x16_bf16 v[96:111], a[152:155], v[196:199], v[96:111]
  v_exp_f32 v246, v246
  v_exp_f32 v247, v247
  v_exp_f32 v248, v248
  v_exp_f32 v249, v249
  v_exp_f32 v250, v250
  v_mfma_f32_32x32x16_bf16 v[112:127], a[156:159], v[196:199], v[112:127]
  v_exp_f32 v251, v251
  v_exp_f32 v252, v252
  v_exp_f32 v253, v253
  v_exp_f32 v254, v254
  v_exp_f32 v255, v255
  v_mfma_f32_32x32x16_bf16 v[96:111], a[160:163], v[200:203], v[96:111]
  v_mul_f32 v64, v44, v64
  v_mul_f32 v65, v44, v65
  v_mul_f32 v66, v44, v66
  v_mul_f32 v67, v44, v67
  v_mul_f32 v68, v44, v68
  v_mfma_f32_32x32x16_bf16 v[112:127], a[164:167], v[200:203], v[112:127]
  v_mul_f32 v69, v44, v69
  v_mul_f32 v70, v44, v70
  v_mul_f32 v71, v44, v71
  v_mul_f32 v72, v44, v72
  v_mul_f32 v73, v44, v73
  v_mfma_f32_32x32x16_bf16 v[96:111], a[168:171], v[204:207], v[96:111]
  v_mul_f32 v74, v44, v74
  v_mul_f32 v75, v44, v75
  v_mul_f32 v76, v44, v76
  v_mul_f32 v77, v44, v77
  v_mul_f32 v78, v44, v78
  v_mfma_f32_32x32x16_bf16 v[112:127], a[172:175], v[204:207], v[112:127]
  v_mul_f32 v79, v44, v79
  v_add_f32 v240, 1.0, v240
  v_add_f32 v241, 1.0, v241
  v_add_f32 v242, 1.0, v242
  v_add_f32 v243, 1.0, v243
  v_pk_add_f32 v[244:245], v[244:245], v[62:63] op_sel_hi:[1,0]
  v_pk_add_f32 v[246:247], v[246:247], v[62:63] op_sel_hi:[1,0]
  v_pk_add_f32 v[248:249], v[248:249], v[62:63] op_sel_hi:[1,0]
  v_pk_add_f32 v[250:251], v[250:251], v[62:63] op_sel_hi:[1,0]
  v_pk_add_f32 v[252:253], v[252:253], v[62:63] op_sel_hi:[1,0]
  v_pk_add_f32 v[254:255], v[254:255], v[62:63] op_sel_hi:[1,0]
  v_rcp_f32 v240, v240
  v_rcp_f32 v241, v241
  ds_write_b128 v24, v[112:115] offset:40960
  v_rcp_f32 v242, v242
  v_rcp_f32 v243, v243
  v_rcp_f32 v244, v244
  ds_write_b128 v24, v[116:119] offset:41984
  v_rcp_f32 v245, v245
  v_rcp_f32 v246, v246
  v_rcp_f32 v247, v247
  ds_write_b128 v24, v[120:123] offset:49152
  v_rcp_f32 v248, v248
  v_rcp_f32 v249, v249
  v_rcp_f32 v250, v250
  ds_write_b128 v24, v[124:127] offset:50176
  v_rcp_f32 v251, v251
  v_rcp_f32 v252, v252
  v_rcp_f32 v253, v253
  s_waitcnt lgkmcnt(0)
  s_barrier
  ds_read_b128 v[224:227], v27 offset:40960
  ds_read_b128 v[228:231], v27 offset:41984
  ds_read_b128 v[232:235], v27 offset:49152
  ds_read_b128 v[236:239], v27 offset:50176
  v_rcp_f32 v254, v254
  v_rcp_f32 v255, v255
  v_pk_mul_f32 v[64:65], v[64:65], v[240:241]
  v_pk_mul_f32 v[66:67], v[66:67], v[242:243]
  v_pk_mul_f32 v[68:69], v[68:69], v[244:245]
  v_pk_mul_f32 v[70:71], v[70:71], v[246:247]
  v_pk_mul_f32 v[72:73], v[72:73], v[248:249]
  v_pk_mul_f32 v[74:75], v[74:75], v[250:251]
  v_pk_mul_f32 v[76:77], v[76:77], v[252:253]
  v_pk_mul_f32 v[78:79], v[78:79], v[254:255]
  s_waitcnt lgkmcnt(0)
  v_pk_add_f32 v[96:97], v[96:97], v[224:225]
  v_pk_add_f32 v[98:99], v[98:99], v[226:227]
  v_pk_add_f32 v[100:101], v[100:101], v[228:229]
  v_pk_add_f32 v[102:103], v[102:103], v[230:231]
  v_pk_add_f32 v[104:105], v[104:105], v[232:233]
  v_pk_add_f32 v[106:107], v[106:107], v[234:235]
  v_pk_add_f32 v[108:109], v[108:109], v[236:237]
  v_pk_add_f32 v[110:111], v[110:111], v[238:239]
  v_pk_mul_f32 v[96:97], v[96:97], v[64:65]
  v_pk_mul_f32 v[98:99], v[98:99], v[66:67]
  v_pk_mul_f32 v[100:101], v[100:101], v[68:69]
  v_pk_mul_f32 v[102:103], v[102:103], v[70:71]
  v_pk_mul_f32 v[104:105], v[104:105], v[72:73]
  v_pk_mul_f32 v[106:107], v[106:107], v[74:75]
  v_pk_mul_f32 v[108:109], v[108:109], v[76:77]
  v_pk_mul_f32 v[110:111], v[110:111], v[78:79]
  v_cvt_pk_bf16_f32 v8, v96, v97
  v_cvt_pk_bf16_f32 v9, v98, v99
  v_cvt_pk_bf16_f32 v10, v100, v101
  v_cvt_pk_bf16_f32 v11, v102, v103
  v_cvt_pk_bf16_f32 v12, v104, v105
  v_cvt_pk_bf16_f32 v13, v106, v107
  v_cvt_pk_bf16_f32 v14, v108, v109
  v_cvt_pk_bf16_f32 v15, v110, v111
  ds_write_b128 v29, v[8:11]
  ds_write_b128 v30, v[12:15]
  ds_read_b128 v[112:115], v31
  ds_read_b128 v[116:119], v31 offset:1024
  s_waitcnt lgkmcnt(1)
  v_lshlrev_b32 v96, 16, v112
  v_and_b32 v97, 0xffff0000, v112
  v_lshlrev_b32 v98, 16, v113
  v_and_b32 v99, 0xffff0000, v113
  v_lshlrev_b32 v100, 16, v114
  v_and_b32 v101, 0xffff0000, v114
  v_lshlrev_b32 v102, 16, v115
  v_and_b32 v103, 0xffff0000, v115
  v_pk_add_f32 v[96:97], v[96:97], v[46:47]
  v_pk_add_f32 v[98:99], v[98:99], v[48:49]
  v_pk_add_f32 v[100:101], v[100:101], v[50:51]
  v_pk_add_f32 v[102:103], v[102:103], v[52:53]
  v_cvt_pk_bf16_f32 v120, v96, v97
  v_cvt_pk_bf16_f32 v121, v98, v99
  v_cvt_pk_bf16_f32 v122, v100, v101
  v_cvt_pk_bf16_f32 v123, v102, v103
  buffer_store_dwordx4 v[120:123], v34, s[16:19], 0 offen sc1
  s_waitcnt lgkmcnt(0)
  v_lshlrev_b32 v104, 16, v116
  v_and_b32 v105, 0xffff0000, v116
  v_lshlrev_b32 v106, 16, v117
  v_and_b32 v107, 0xffff0000, v117
  v_lshlrev_b32 v108, 16, v118
  v_and_b32 v109, 0xffff0000, v118
  v_lshlrev_b32 v110, 16, v119
  v_and_b32 v111, 0xffff0000, v119
  v_pk_add_f32 v[104:105], v[104:105], v[54:55]
  v_pk_add_f32 v[106:107], v[106:107], v[56:57]
  v_pk_add_f32 v[108:109], v[108:109], v[58:59]
  v_pk_add_f32 v[110:111], v[110:111], v[60:61]
  v_cvt_pk_bf16_f32 v124, v104, v105
  v_cvt_pk_bf16_f32 v125, v106, v107
  v_cvt_pk_bf16_f32 v126, v108, v109
  v_cvt_pk_bf16_f32 v127, v110, v111
  buffer_store_dwordx4 v[124:127], v35, s[16:19], 0 offen sc1
L_end:
  s_endpgm
L_slow_nonce00:
  s_mov_b32 s58, 0
L_sn00:
  v_mov_b32 v56, 0
  buffer_load_dwordx2 v[56:57], v56, s[24:27], 0 offen sc1
  s_waitcnt vmcnt(0)
  v_readfirstlane_b32 s86, v56
  v_readfirstlane_b32 s87, v57
  s_add_u32 s58, s58, 1
  s_cmp_gt_u32 s58, 20000
  s_cbranch_scc1 L_back_nonce00
  s_cmp_eq_u32 s86, 0
  s_cbranch_scc1 L_sn00
  s_branch L_back_nonce00
L_slow_gat00:
  s_mov_b32 s58, 0
L_sg00:
  s_mov_b32 s83, 9437184
  buffer_load_dwordx4 v[76:79], v58, s[20:23], s83 offen sc1
  buffer_load_dwordx4 v[80:83], v59, s[20:23], s83 offen sc1
  buffer_load_dwordx4 v[84:87], v42, s[20:23], s83 offen sc1
  s_waitcnt vmcnt(0)
  v_cmp_ne_u64 vcc, s[86:87], v[78:79]
  v_cmp_ne_u64 s[94:95], s[86:87], v[82:83]
  v_cmp_ne_u64 s[92:93], s[86:87], v[86:87]
  s_or_b64 vcc, vcc, s[94:95]
  s_or_b64 vcc, vcc, s[92:93]
  s_add_u32 s58, s58, 1
  s_cmp_gt_u32 s58, 20000
  s_cbranch_scc1 L_back_gat00
  s_cbranch_vccnz L_sg00
  s_branch L_back_gat00
L_slow_nonce10:
  s_mov_b32 s58, 0
L_sn10:
  v_mov_b32 v56, 0
  buffer_load_dwordx2 v[56:57], v56, s[24:27], 0 offen sc1
  s_waitcnt vmcnt(0)
  v_readfirstlane_b32 s86, v56
  v_readfirstlane_b32 s87, v57
  s_add_u32 s58, s58, 1
  s_cmp_gt_u32 s58, 20000
  s_cbranch_scc1 L_back_nonce10
  s_cmp_eq_u32 s86, 0
  s_cbranch_scc1 L_sn10
  s_branch L_back_nonce10
L_slow_gat10:
  s_mov_b32 s58, 0
L_sg10:
  s_mov_b32 s83, 9437184
  buffer_load_dwordx4 v[76:79], v58, s[20:23], s83 offen sc1
  buffer_load_dwordx4 v[80:83], v59, s[20:23], s83 offen sc1
  buffer_load_dwordx4 v[84:87], v42, s[20:23], s83 offen sc1
  s_waitcnt vmcnt(0)
  v_cmp_ne_u64 vcc, s[86:87], v[78:79]
  v_cmp_ne_u64 s[94:95], s[86:87], v[82:83]
  v_cmp_ne_u64 s[92:93], s[86:87], v[86:87]
  s_or_b64 vcc, vcc, s[94:95]
  s_or_b64 vcc, vcc, s[92:93]
  s_add_u32 s58, s58, 1
  s_cmp_gt_u32 s58, 20000
  s_cbranch_scc1 L_back_gat10
  s_cbranch_vccnz L_sg10
  s_branch L_back_gat10
L_slow_e:
  s_mov_b32 s58, 0
  buffer_load_dwordx2 v[58:59], v16, s[20:23], s81 offen offset:0 sc1
  s_sleep 4
L_se:
  buffer_load_dwordx2 v[62:63], v16, s[20:23], s81 offen offset:0 sc1
  s_waitcnt vmcnt(1)
  v_cmp_ne_u64 vcc, s[86:87], v[58:59]
  s_nop 1
  s_and_b32 vcc_lo, vcc_lo, 285217024
  s_cbranch_scc0 L_se_done
  buffer_load_dwordx2 v[58:59], v16, s[20:23], s81 offen offset:0 sc1
  s_waitcnt vmcnt(1)
  v_cmp_ne_u64 vcc, s[86:87], v[62:63]
  s_nop 1
  s_and_b32 vcc_lo, vcc_lo, 285217024
  s_cbranch_scc0 L_se_done
  s_add_u32 s58, s58, 1
  s_cmp_gt_u32 s58, 10000
  s_cbranch_scc0 L_se
L_se_done:
  s_branch L_go
L_slow_o0:
  s_mov_b32 s58, 0
L_so0:
  buffer_load_dwordx2 v[58:59], v16, s[20:23], s81 offen offset:128 sc1
  s_add_u32 s58, s58, 1
  s_waitcnt vmcnt(0)
  v_cmp_ne_u64 vcc, s[86:87], v[58:59]
  s_nop 0
  s_and_b32 vcc_lo, vcc_lo, 1114129
  s_cbranch_scc0 L_back_o0
  s_cmp_gt_u32 s58, 20000
  s_cbranch_scc0 L_so0
  s_branch L_back_o0
s_endpgm
.p2align 6
L_codeend:
.section .rodata,"a"
.p2align 6
.amdhsa_kernel recurrent_scan__sliding_local_dilated__glu_gated_bilinear__prompt_kernel
  .amdhsa_next_free_vgpr 512
  .amdhsa_next_free_sgpr 102
  .amdhsa_accum_offset 256
  .amdhsa_group_segment_fixed_size 0
  .amdhsa_kernarg_size 80
  .amdhsa_user_sgpr_count 2
  .amdhsa_user_sgpr_kernarg_segment_ptr 1
  .amdhsa_system_sgpr_workgroup_id_x 1
  .amdhsa_float_denorm_mode_32 3
.end_amdhsa_kernel
```
